```python
import torch

def _softmax(x, axis=-1):
    return torch.softmax(x, dim=axis)
def _gelu(x):
    return torch.nn.functional.gelu(x, approximate="tanh")
def _silu(x):
    return torch.nn.functional.silu(x)
def _sigmoid(x):
    return torch.sigmoid(x)
def _layernorm(x, axis=-1, eps=1e-5):
    m = x.mean(dim=axis, keepdim=True)
    v = x.var(dim=axis, keepdim=True, unbiased=False)
    return (x - m) / torch.sqrt(v + eps)
def _scatter_add(tgt, idx, src, axis=0):
    return tgt.clone().index_add_(axis, idx, src)
def _segment_sum(src, seg, n):
    out = torch.zeros((n,) + src.shape[1:], dtype=src.dtype)
    return out.index_add_(0, seg, src)
def _pad(x, pw):
    flat = tuple(v for pair in reversed(pw) for v in pair)
    return torch.nn.functional.pad(x, flat)

kernel_name = 'gated_mix__sliding_local_dilated__mixer_token_mlp__prompt'

def setup_inputs():

    _w = (lambda a: (lambda t: t.to(torch.bfloat16) if t.is_floating_point() else t)(torch.as_tensor(a)))
    def _A_setup():
        B, S, D = 1, 2048, 1024
        return {
            "x": _w((lambda *s: torch.randn(*s, dtype=torch.bfloat16) * 0.05)(B, S, D)),
            "wqkv": _w((lambda *s: torch.randn(*s, dtype=torch.bfloat16) * 0.8)(D, 3 * D)),
            "wo": _w((lambda *s: torch.randn(*s, dtype=torch.bfloat16) * 0.05)(D, D)),
        }
    _A_in = _A_setup()

    def _B_setup():
        B, S, D, F = 1, 2048, 1024, 3584
        return {
            "x": _w((lambda *s: torch.randn(*s, dtype=torch.bfloat16) * 0.05)(B, S, D)),
            "w1": _w((lambda *s: torch.randn(*s, dtype=torch.bfloat16) * 3.2)(S, F) * (S ** -0.5)),
            "b1": _w((lambda *s: torch.randn(*s, dtype=torch.bfloat16) * 3.2)(F) * 0.02),
            "w2": _w((lambda *s: torch.randn(*s, dtype=torch.bfloat16) * 0.2)(F, S) * (F ** -0.5)),
            "b2": _w((lambda *s: torch.randn(*s, dtype=torch.bfloat16) * 0.2)(S) * 0.02),
        }
    _B_in = _B_setup()

    return {
        "A_x": _A_in["x"],
        "A_wqkv": _A_in["wqkv"],
        "A_wo": _A_in["wo"],
        "B_x": _B_in["x"],
        "B_w1": _B_in["w1"],
        "B_b1": _B_in["b1"],
        "B_w2": _B_in["w2"],
        "B_b2": _B_in["b2"],
        "gate_w": _w((lambda *s: torch.randn(*s, dtype=torch.bfloat16) * 0.05)(1024) * 16.0),
    }

def reference(A_x, A_wqkv, A_wo, B_x, B_w1, B_b1, B_w2, B_b2, gate_w):
    def _A_ref(x, wqkv, wo):
        B, S, D = x.shape
        H = 32; Dh = D // H
        W, dil = 8, 2
        qkv = (lambda x, *d: x.permute(*d))((x @ wqkv).reshape(B, S, 3, H, Dh), 2, 0, 3, 1, 4)
        q, k, v = qkv[0], qkv[1], qkv[2]
        scale = Dh ** -0.5
        pos = torch.arange(S)
        off = torch.arange(W) * dil
        idx = pos[:, None] - off[None, :]
        mask = idx >= 0
        idx_c = torch.where(mask, idx, 0).reshape(-1)
        kg = k[:, :, idx_c, :].reshape(B, H, S, W, Dh)
        vg = v[:, :, idx_c, :].reshape(B, H, S, W, Dh)
        logits = torch.einsum("bhsd,bhswd->bhsw", q, kg) * scale
        logits = torch.where(mask[None, None, :, :], logits, -1e9)
        attn = _softmax(logits, axis=-1)
        o = torch.einsum("bhsw,bhswd->bhsd", attn, vg)
        return (lambda x, *d: x.permute(*d))(o, 0, 2, 1, 3).reshape(B, S, D) @ wo

    def _B_ref(x, w1, b1, w2, b2):
        B, S, D = x.shape
        h = _layernorm(x, axis=-1)
        u = torch.einsum("bsd,sf->bdf", h, w1) + b1
        u = _gelu(u)
        y = torch.einsum("bdf,fs->bds", u, w2) + b2
        return (lambda x, *d: x.permute(*d))(y, 0, 2, 1)

    x = A_x
    g = _sigmoid((x * gate_w).sum(-1, keepdims=True))
    a = _A_ref(x, A_wqkv, A_wo)
    b = _B_ref(x, B_w1, B_b1, B_w2, B_b2)
    return g * a + (1 - g) * b
```

```asm
; @launch grid=(256,1,1) block=(512,1,1) lds=148480
.amdgcn_target "amdgcn-amd-amdhsa--gfx950"
.text
.globl gated_mix__sliding_local_dilated__mixer_token_mlp__prompt_kernel
.p2align 8
.type gated_mix__sliding_local_dilated__mixer_token_mlp__prompt_kernel,@function
gated_mix__sliding_local_dilated__mixer_token_mlp__prompt_kernel:
    s_cmp_ge_u32 s2, 256
    s_cbranch_scc1 L_end
    s_load_dwordx4 s[36:39], s[0:1], 0
    s_load_dwordx4 s[40:43], s[0:1], 32
    s_load_dwordx2 s[44:45], s[0:1], 64
    s_load_dwordx2 s[34:35], s[0:1], 88
    s_load_dwordx2 s[82:83], s[0:1], 80
    s_load_dwordx2 s[4:5], s[0:1], 16
    s_load_dwordx2 s[6:7], s[0:1], 48
    s_load_dwordx2 s[84:85], s[0:1], 56
    s_load_dwordx2 s[100:101], s[0:1], 72
    v_lshrrev_b32 v1, 6, v0
    v_and_b32 v2, 63, v0
    v_lshrrev_b32 v3, 4, v2
    v_and_b32 v4, 15, v2
    v_readfirstlane_b32 s31, v1
    s_and_b32 s29, s2, 7
    s_lshr_b32 s30, s2, 3
    s_lshr_b32 s28, s29, 1
    s_and_b32 s32, s30, 7
    s_lshl_b32 s33, s28, 2
    s_lshr_b32 s46, s30, 3
    s_add_u32 s33, s33, s46
    s_and_b32 s46, s28, 1
    s_lshl_b32 s46, s46, 2
    s_and_b32 s47, s30, 3
    s_add_u32 s46, s46, s47
    s_lshr_b32 s47, s28, 1
    s_lshl_b32 s47, s47, 3
    s_lshr_b32 s28, s30, 2
    s_add_u32 s47, s47, s28
    s_and_b32 s30, s29, 1
    s_cmp_eq_u32 s30, 1
    s_cselect_b32 s32, s46, s32
    s_cselect_b32 s33, s47, s33
    s_or_b32 s28, s2, s31
    s_cmp_lg_u32 s28, 0
    s_waitcnt lgkmcnt(0)
    s_cbranch_scc1 L_noepoch
    s_memrealtime s[28:29]
    s_mov_b32 s60, s82
    s_and_b32 s61, s83, 0xffff
    s_mov_b32 s62, 0x100
    s_mov_b32 s63, 0x00020000
    v_mov_b32 v5, 0
    s_waitcnt lgkmcnt(0)
    s_or_b32 s28, s28, 1
    v_mov_b32 v6, s28
    s_mov_b64 exec, 1
    buffer_store_dword v6, v5, s[60:63], 0 offen sc1
    s_mov_b64 exec, -1
L_noepoch:
    s_cmp_eq_u32 s30, 1
    s_cbranch_scc1 L_a
    s_mov_b32 s64, s38
    s_and_b32 s65, s39, 0xffff
    s_mov_b32 s66, 0x600000
    s_mov_b32 s67, 0x00020000
    s_lshr_b32 s48, s2, 3
    s_lshl_b32 s48, s48, 2
    s_lshr_b32 s30, s2, 1
    s_and_b32 s30, s30, 3
    s_add_u32 s48, s48, s30
    s_mov_b32 s52, s36
    s_and_b32 s53, s37, 0xffff
    s_mov_b32 s54, 0x400000
    s_mov_b32 s55, 0x00020000
    s_mov_b32 s56, s44
    s_and_b32 s57, s45, 0xffff
    s_mov_b32 s58, 0x800
    s_mov_b32 s59, 0x00020000
    s_lshl_b32 s30, s48, 4
    s_lshl_b32 s38, s31, 1
    s_add_u32 s30, s30, s38
    s_lshl_b32 s38, s30, 11
    v_lshlrev_b32 v5, 4, v2
    buffer_load_dwordx4 v[8:11], v5, s[52:55], s38 offen
    buffer_load_dwordx4 v[12:15], v5, s[52:55], s38 offen offset:1024
    buffer_load_dwordx4 v[16:19], v5, s[52:55], s38 offen offset:2048
    buffer_load_dwordx4 v[20:23], v5, s[52:55], s38 offen offset:3072
    buffer_load_dwordx4 v[24:27], v5, s[56:59], 0 offen
    buffer_load_dwordx4 v[28:31], v5, s[56:59], 0 offen offset:1024
    s_mov_b32 s8, s34
    s_and_b32 s9, s35, 0xffff
    s_mov_b32 s10, 0x400000
    s_mov_b32 s11, 0x00020000
    s_mov_b32 s12, s40
    s_and_b32 s13, s41, 0xffff
    s_mov_b32 s14, 0xe00000
    s_mov_b32 s15, 0x00020000
    s_add_u32 s16, s34, 0x800000
    s_addc_u32 s17, s35, 0
    s_and_b32 s17, s17, 0xffff
    s_mov_b32 s18, 0x700000
    s_mov_b32 s19, 0x00020000
    s_mov_b32 s20, s42
    s_and_b32 s21, s43, 0xffff
    s_mov_b32 s22, 0x1c00
    s_mov_b32 s23, 0x00020000
    s_add_u32 s24, s34, 0x1400000
    s_addc_u32 s25, s35, 0
    s_and_b32 s25, s25, 0xffff
    s_mov_b32 s26, 0x200000
    s_mov_b32 s27, 0x00020000
    s_mov_b32 s60, s82
    s_and_b32 s61, s83, 0xffff
    s_mov_b32 s62, 0x100
    s_mov_b32 s63, 0x00020000
    s_lshl_b32 s46, s32, 11
    s_mul_i32 s47, s33, 448
    s_cmp_lt_u32 s31, 4
    s_cbranch_scc1 L_b_cons
    s_sub_u32 s39, s31, 4
    s_mul_i32 s41, s39, 448
    s_add_u32 s40, s41, 0
    v_add_u32 v116, s40, v2
    v_mul_u32_u24 v117, 2341, v116
    v_lshrrev_b32 v117, 16, v117
    v_mul_u32_u24 v118, 28, v117
    v_sub_u32 v116, v116, v118
    v_lshrrev_b32 v118, 2, v117
    v_and_b32 v118, 2, v118
    v_xor_b32 v116, v116, v118
    v_lshlrev_b32 v116, 4, v116
    v_mul_u32_u24 v117, 7168, v117
    v_add3_u32 v116, v116, v117, s47
    v_subrev_u32 v129, 0, v116
    s_add_u32 s40, s41, 64
    v_add_u32 v116, s40, v2
    v_mul_u32_u24 v117, 2341, v116
    v_lshrrev_b32 v117, 16, v117
    v_mul_u32_u24 v118, 28, v117
    v_sub_u32 v116, v116, v118
    v_lshrrev_b32 v118, 2, v117
    v_and_b32 v118, 2, v118
    v_xor_b32 v116, v116, v118
    v_lshlrev_b32 v116, 4, v116
    v_mul_u32_u24 v117, 7168, v117
    v_add3_u32 v116, v116, v117, s47
    v_subrev_u32 v130, 1024, v116
    s_add_u32 s40, s41, 128
    v_add_u32 v116, s40, v2
    v_mul_u32_u24 v117, 2341, v116
    v_lshrrev_b32 v117, 16, v117
    v_mul_u32_u24 v118, 28, v117
    v_sub_u32 v116, v116, v118
    v_lshrrev_b32 v118, 2, v117
    v_and_b32 v118, 2, v118
    v_xor_b32 v116, v116, v118
    v_lshlrev_b32 v116, 4, v116
    v_mul_u32_u24 v117, 7168, v117
    v_add3_u32 v116, v116, v117, s47
    v_subrev_u32 v131, 2048, v116
    s_add_u32 s40, s41, 192
    v_add_u32 v116, s40, v2
    v_mul_u32_u24 v117, 2341, v116
    v_lshrrev_b32 v117, 16, v117
    v_mul_u32_u24 v118, 28, v117
    v_sub_u32 v116, v116, v118
    v_lshrrev_b32 v118, 2, v117
    v_and_b32 v118, 2, v118
    v_xor_b32 v116, v116, v118
    v_lshlrev_b32 v116, 4, v116
    v_mul_u32_u24 v117, 7168, v117
    v_add3_u32 v116, v116, v117, s47
    v_subrev_u32 v132, 3072, v116
    s_add_u32 s40, s41, 256
    v_add_u32 v116, s40, v2
    v_mul_u32_u24 v117, 2341, v116
    v_lshrrev_b32 v117, 16, v117
    v_mul_u32_u24 v118, 28, v117
    v_sub_u32 v116, v116, v118
    v_lshrrev_b32 v118, 2, v117
    v_and_b32 v118, 2, v118
    v_xor_b32 v116, v116, v118
    v_lshlrev_b32 v116, 4, v116
    v_mul_u32_u24 v117, 7168, v117
    v_add3_u32 v116, v116, v117, s47
    v_subrev_u32 v133, 0, v116
    s_add_u32 s40, s41, 320
    v_add_u32 v116, s40, v2
    v_mul_u32_u24 v117, 2341, v116
    v_lshrrev_b32 v117, 16, v117
    v_mul_u32_u24 v118, 28, v117
    v_sub_u32 v116, v116, v118
    v_lshrrev_b32 v118, 2, v117
    v_and_b32 v118, 2, v118
    v_xor_b32 v116, v116, v118
    v_lshlrev_b32 v116, 4, v116
    v_mul_u32_u24 v117, 7168, v117
    v_add3_u32 v116, v116, v117, s47
    v_subrev_u32 v134, 1024, v116
    s_add_u32 s40, s41, 384
    v_add_u32 v116, s40, v2
    v_mul_u32_u24 v117, 2341, v116
    v_lshrrev_b32 v117, 16, v117
    v_mul_u32_u24 v118, 28, v117
    v_sub_u32 v116, v116, v118
    v_lshrrev_b32 v118, 2, v117
    v_and_b32 v118, 2, v118
    v_xor_b32 v116, v116, v118
    v_lshlrev_b32 v116, 4, v116
    v_mul_u32_u24 v117, 7168, v117
    v_add3_u32 v116, v116, v117, s47
    v_subrev_u32 v135, 2048, v116
    s_lshl_b32 s44, s39, 11
    s_mul_i32 s45, s39, 7168
    s_add_u32 s45, s45, 49152
    s_mov_b32 s28, 0
    s_mov_b32 s29, 0
    s_add_u32 m0, s45, 0
    s_nop 0
    buffer_load_dwordx4 v129, s[12:15], s29 offen offset:0 lds
    buffer_load_dwordx4 v130, s[12:15], s29 offen offset:1024 lds
    buffer_load_dwordx4 v131, s[12:15], s29 offen offset:2048 lds
    buffer_load_dwordx4 v132, s[12:15], s29 offen offset:3072 lds
    s_add_u32 m0, s45, 4096
    s_nop 0
    buffer_load_dwordx4 v133, s[12:15], s29 offen offset:0 lds
    buffer_load_dwordx4 v134, s[12:15], s29 offen offset:1024 lds
    buffer_load_dwordx4 v135, s[12:15], s29 offen offset:2048 lds
    s_add_u32 s29, s29, 458752
    s_add_u32 m0, s45, 28672
    s_nop 0
    buffer_load_dwordx4 v129, s[12:15], s29 offen offset:0 lds
    buffer_load_dwordx4 v130, s[12:15], s29 offen offset:1024 lds
    buffer_load_dwordx4 v131, s[12:15], s29 offen offset:2048 lds
    buffer_load_dwordx4 v132, s[12:15], s29 offen offset:3072 lds
    s_add_u32 m0, s45, 32768
    s_nop 0
    buffer_load_dwordx4 v133, s[12:15], s29 offen offset:0 lds
    buffer_load_dwordx4 v134, s[12:15], s29 offen offset:1024 lds
    buffer_load_dwordx4 v135, s[12:15], s29 offen offset:2048 lds
    s_add_u32 s29, s29, 458752
    s_add_u32 m0, s45, 57344
    s_nop 0
    buffer_load_dwordx4 v129, s[12:15], s29 offen offset:0 lds
    buffer_load_dwordx4 v130, s[12:15], s29 offen offset:1024 lds
    buffer_load_dwordx4 v131, s[12:15], s29 offen offset:2048 lds
    buffer_load_dwordx4 v132, s[12:15], s29 offen offset:3072 lds
    s_add_u32 m0, s45, 61440
    s_nop 0
    buffer_load_dwordx4 v133, s[12:15], s29 offen offset:0 lds
    buffer_load_dwordx4 v134, s[12:15], s29 offen offset:1024 lds
    buffer_load_dwordx4 v135, s[12:15], s29 offen offset:2048 lds
    s_add_u32 s29, s29, 458752
    s_lshl_b32 s38, s39, 14
    s_add_u32 s38, s38, s46
    v_add_u32 v128, s38, v5
    s_mov_b32 s36, 0xffff0000
    s_mov_b32 s37, 0x3f803f80
    v_mov_b32 v96, 0
    v_mov_b32 v97, 0
    v_mov_b32 v98, 0
    v_mov_b32 v99, 0
    s_waitcnt vmcnt(23)
    v_lshlrev_b32 v32, 16, v8
    v_and_b32 v33, s36, v8
    v_lshlrev_b32 v34, 16, v9
    v_and_b32 v35, s36, v9
    v_lshlrev_b32 v36, 16, v10
    v_and_b32 v37, s36, v10
    v_lshlrev_b32 v38, 16, v11
    v_and_b32 v39, s36, v11
    v_lshlrev_b32 v40, 16, v12
    v_and_b32 v41, s36, v12
    v_lshlrev_b32 v42, 16, v13
    v_and_b32 v43, s36, v13
    v_lshlrev_b32 v44, 16, v14
    v_and_b32 v45, s36, v14
    v_lshlrev_b32 v46, 16, v15
    v_and_b32 v47, s36, v15
    v_dot2_f32_bf16 v96, v8, s37, v96
    v_dot2_f32_bf16 v96, v9, s37, v96
    v_dot2_f32_bf16 v96, v10, s37, v96
    v_dot2_f32_bf16 v96, v11, s37, v96
    v_dot2_f32_bf16 v96, v12, s37, v96
    v_dot2_f32_bf16 v96, v13, s37, v96
    v_dot2_f32_bf16 v96, v14, s37, v96
    v_dot2_f32_bf16 v96, v15, s37, v96
    v_lshlrev_b32 v48, 16, v16
    v_and_b32 v49, s36, v16
    v_lshlrev_b32 v50, 16, v17
    v_and_b32 v51, s36, v17
    v_lshlrev_b32 v52, 16, v18
    v_and_b32 v53, s36, v18
    v_lshlrev_b32 v54, 16, v19
    v_and_b32 v55, s36, v19
    v_lshlrev_b32 v56, 16, v20
    v_and_b32 v57, s36, v20
    v_lshlrev_b32 v58, 16, v21
    v_and_b32 v59, s36, v21
    v_lshlrev_b32 v60, 16, v22
    v_and_b32 v61, s36, v22
    v_lshlrev_b32 v62, 16, v23
    v_and_b32 v63, s36, v23
    v_dot2_f32_bf16 v97, v16, s37, v97
    v_dot2_f32_bf16 v97, v17, s37, v97
    v_dot2_f32_bf16 v97, v18, s37, v97
    v_dot2_f32_bf16 v97, v19, s37, v97
    v_dot2_f32_bf16 v97, v20, s37, v97
    v_dot2_f32_bf16 v97, v21, s37, v97
    v_dot2_f32_bf16 v97, v22, s37, v97
    v_dot2_f32_bf16 v97, v23, s37, v97
    s_waitcnt vmcnt(21)
    s_lshl_b32 s38, s48, 2
    s_add_u32 s38, s38, s39
    s_lshl_b32 s38, s38, 13
    v_lshlrev_b32 v116, 7, v2
    v_add_u32 v116, s38, v116
    s_mov_b32 s38, 0x150000
    buffer_load_dword v250, v116, s[12:15], s38 offen
    v_dot2_f32_bf16 v98, v8, v24, v98
    v_dot2_f32_bf16 v99, v16, v24, v99
    v_dot2_f32_bf16 v98, v9, v25, v98
    v_dot2_f32_bf16 v99, v17, v25, v99
    v_dot2_f32_bf16 v98, v10, v26, v98
    v_dot2_f32_bf16 v99, v18, v26, v99
    v_dot2_f32_bf16 v98, v11, v27, v98
    v_dot2_f32_bf16 v99, v19, v27, v99
    v_dot2_f32_bf16 v98, v12, v28, v98
    v_dot2_f32_bf16 v99, v20, v28, v99
    v_dot2_f32_bf16 v98, v13, v29, v98
    v_dot2_f32_bf16 v99, v21, v29, v99
    v_dot2_f32_bf16 v98, v14, v30, v98
    v_dot2_f32_bf16 v99, v22, v30, v99
    v_dot2_f32_bf16 v98, v15, v31, v98
    v_dot2_f32_bf16 v99, v23, v31, v99
    s_nop 2
    v_add_f32_dpp v96, v96, v96 quad_perm:[1,0,3,2] row_mask:0xf bank_mask:0xf
    v_add_f32_dpp v97, v97, v97 quad_perm:[1,0,3,2] row_mask:0xf bank_mask:0xf
    v_add_f32_dpp v98, v98, v98 quad_perm:[1,0,3,2] row_mask:0xf bank_mask:0xf
    v_add_f32_dpp v99, v99, v99 quad_perm:[1,0,3,2] row_mask:0xf bank_mask:0xf
    v_add_f32_dpp v96, v96, v96 quad_perm:[2,3,0,1] row_mask:0xf bank_mask:0xf
    v_add_f32_dpp v97, v97, v97 quad_perm:[2,3,0,1] row_mask:0xf bank_mask:0xf
    v_add_f32_dpp v98, v98, v98 quad_perm:[2,3,0,1] row_mask:0xf bank_mask:0xf
    v_add_f32_dpp v99, v99, v99 quad_perm:[2,3,0,1] row_mask:0xf bank_mask:0xf
    v_add_f32_dpp v96, v96, v96 row_half_mirror row_mask:0xf bank_mask:0xf
    v_add_f32_dpp v97, v97, v97 row_half_mirror row_mask:0xf bank_mask:0xf
    v_add_f32_dpp v98, v98, v98 row_half_mirror row_mask:0xf bank_mask:0xf
    v_add_f32_dpp v99, v99, v99 row_half_mirror row_mask:0xf bank_mask:0xf
    v_add_f32_dpp v96, v96, v96 row_mirror row_mask:0xf bank_mask:0xf
    v_add_f32_dpp v97, v97, v97 row_mirror row_mask:0xf bank_mask:0xf
    v_add_f32_dpp v98, v98, v98 row_mirror row_mask:0xf bank_mask:0xf
    v_add_f32_dpp v99, v99, v99 row_mirror row_mask:0xf bank_mask:0xf
    v_mov_b32 v104, v96
    v_mov_b32 v105, v97
    v_mov_b32 v106, v98
    v_mov_b32 v107, v99
    s_nop 1
    v_permlane16_swap_b32 v96, v104
    v_permlane16_swap_b32 v97, v105
    v_permlane16_swap_b32 v98, v106
    v_permlane16_swap_b32 v99, v107
    v_add_f32 v96, v96, v104
    v_add_f32 v97, v97, v105
    v_add_f32 v98, v98, v106
    v_add_f32 v99, v99, v107
    v_mov_b32 v104, v96
    v_mov_b32 v105, v97
    v_mov_b32 v106, v98
    v_mov_b32 v107, v99
    s_nop 1
    v_permlane32_swap_b32 v96, v104
    v_permlane32_swap_b32 v97, v105
    v_permlane32_swap_b32 v98, v106
    v_permlane32_swap_b32 v99, v107
    v_add_f32 v96, v96, v104
    v_add_f32 v97, v97, v105
    v_add_f32 v98, v98, v106
    v_add_f32 v99, v99, v107
    v_mul_f32 v96, 0x3a800000, v96
    v_sub_f32 v108, 0, v96
    v_mov_b32 v109, v108
    v_mov_b32 v100, 0
    v_mov_b32 v101, 0
    v_mul_f32 v97, 0x3a800000, v97
    v_sub_f32 v110, 0, v97
    v_mov_b32 v111, v110
    v_mov_b32 v102, 0
    v_mov_b32 v103, 0
    v_pk_add_f32 v[64:65], v[32:33], v[108:109]
    v_pk_add_f32 v[66:67], v[34:35], v[108:109]
    v_pk_add_f32 v[68:69], v[36:37], v[108:109]
    v_pk_add_f32 v[70:71], v[38:39], v[108:109]
    v_pk_add_f32 v[72:73], v[40:41], v[108:109]
    v_pk_add_f32 v[74:75], v[42:43], v[108:109]
    v_pk_add_f32 v[76:77], v[44:45], v[108:109]
    v_pk_add_f32 v[78:79], v[46:47], v[108:109]
    v_pk_fma_f32 v[100:101], v[64:65], v[64:65], v[100:101]
    v_pk_fma_f32 v[100:101], v[66:67], v[66:67], v[100:101]
    v_pk_fma_f32 v[100:101], v[68:69], v[68:69], v[100:101]
    v_pk_fma_f32 v[100:101], v[70:71], v[70:71], v[100:101]
    v_pk_fma_f32 v[100:101], v[72:73], v[72:73], v[100:101]
    v_pk_fma_f32 v[100:101], v[74:75], v[74:75], v[100:101]
    v_pk_fma_f32 v[100:101], v[76:77], v[76:77], v[100:101]
    v_pk_fma_f32 v[100:101], v[78:79], v[78:79], v[100:101]
    v_add_f32 v100, v100, v101
    v_pk_add_f32 v[64:65], v[48:49], v[110:111]
    v_pk_add_f32 v[66:67], v[50:51], v[110:111]
    v_pk_add_f32 v[68:69], v[52:53], v[110:111]
    v_pk_add_f32 v[70:71], v[54:55], v[110:111]
    v_pk_add_f32 v[72:73], v[56:57], v[110:111]
    v_pk_add_f32 v[74:75], v[58:59], v[110:111]
    v_pk_add_f32 v[76:77], v[60:61], v[110:111]
    v_pk_add_f32 v[78:79], v[62:63], v[110:111]
    v_pk_fma_f32 v[102:103], v[64:65], v[64:65], v[102:103]
    v_pk_fma_f32 v[102:103], v[66:67], v[66:67], v[102:103]
    v_pk_fma_f32 v[102:103], v[68:69], v[68:69], v[102:103]
    v_pk_fma_f32 v[102:103], v[70:71], v[70:71], v[102:103]
    v_pk_fma_f32 v[102:103], v[72:73], v[72:73], v[102:103]
    v_pk_fma_f32 v[102:103], v[74:75], v[74:75], v[102:103]
    v_pk_fma_f32 v[102:103], v[76:77], v[76:77], v[102:103]
    v_pk_fma_f32 v[102:103], v[78:79], v[78:79], v[102:103]
    v_add_f32 v102, v102, v103
    s_nop 0
    v_add_f32_dpp v100, v100, v100 quad_perm:[1,0,3,2] row_mask:0xf bank_mask:0xf
    v_add_f32_dpp v102, v102, v102 quad_perm:[1,0,3,2] row_mask:0xf bank_mask:0xf
    s_nop 0
    v_add_f32_dpp v100, v100, v100 quad_perm:[2,3,0,1] row_mask:0xf bank_mask:0xf
    v_add_f32_dpp v102, v102, v102 quad_perm:[2,3,0,1] row_mask:0xf bank_mask:0xf
    s_nop 0
    v_add_f32_dpp v100, v100, v100 row_half_mirror row_mask:0xf bank_mask:0xf
    v_add_f32_dpp v102, v102, v102 row_half_mirror row_mask:0xf bank_mask:0xf
    s_nop 0
    v_add_f32_dpp v100, v100, v100 row_mirror row_mask:0xf bank_mask:0xf
    v_add_f32_dpp v102, v102, v102 row_mirror row_mask:0xf bank_mask:0xf
    v_mov_b32 v104, v100
    v_mov_b32 v105, v102
    s_nop 1
    v_permlane16_swap_b32 v100, v104
    v_permlane16_swap_b32 v102, v105
    v_add_f32 v100, v100, v104
    v_add_f32 v102, v102, v105
    v_mov_b32 v104, v100
    v_mov_b32 v105, v102
    s_nop 1
    v_permlane32_swap_b32 v100, v104
    v_permlane32_swap_b32 v102, v105
    v_add_f32 v100, v100, v104
    v_add_f32 v102, v102, v105
    v_cvt_pk_bf16_f32 v96, v96, v98
    v_cvt_pk_bf16_f32 v97, v97, v99
    v_mul_f32 v100, 0x3a800000, v100
    v_mul_f32 v102, 0x3a800000, v102
    v_and_b32 v98, s36, v96
    v_and_b32 v99, s36, v97
    v_lshlrev_b32 v96, 16, v96
    v_lshlrev_b32 v97, 16, v97
    v_cvt_pk_bf16_f32 v100, v100, v100
    v_cvt_pk_bf16_f32 v102, v102, v102
    v_mul_f32 v98, 0xbfb8aa3b, v98
    v_mul_f32 v99, 0xbfb8aa3b, v99
    v_and_b32 v100, s36, v100
    v_and_b32 v102, s36, v102
    v_exp_f32 v98, v98
    v_exp_f32 v99, v99
    v_add_f32 v100, 0x3727c5ac, v100
    v_add_f32 v102, 0x3727c5ac, v102
    v_sub_f32 v108, 0, v96
    v_sub_f32 v110, 0, v97
    v_add_f32 v98, 1.0, v98
    v_add_f32 v99, 1.0, v99
    v_cvt_pk_bf16_f32 v100, v100, v100
    v_cvt_pk_bf16_f32 v102, v102, v102
    v_rcp_f32 v98, v98
    v_rcp_f32 v99, v99
    v_and_b32 v100, s36, v100
    v_and_b32 v102, s36, v102
    v_mov_b32 v109, v108
    v_mov_b32 v111, v110
    v_sqrt_f32 v100, v100
    v_sqrt_f32 v102, v102
    v_cvt_pk_bf16_f32 v98, v98, v98
    v_cvt_pk_bf16_f32 v99, v99, v99
    v_and_b32 v112, s36, v98
    v_and_b32 v114, s36, v99
    v_cvt_pk_bf16_f32 v100, v100, v100
    v_cvt_pk_bf16_f32 v102, v102, v102
    v_sub_f32 v113, 1.0, v112
    v_sub_f32 v115, 1.0, v114
    v_and_b32 v100, s36, v100
    v_and_b32 v102, s36, v102
    v_cvt_pk_bf16_f32 v113, v113, v113
    v_cvt_pk_bf16_f32 v115, v115, v115
    v_rcp_f32 v100, v100
    v_rcp_f32 v102, v102
    v_and_b32 v113, s36, v113
    v_and_b32 v115, s36, v115
    v_mov_b32 v101, v100
    v_mov_b32 v103, v102
    s_mul_i32 s38, s31, 4224
    s_add_u32 s38, s38, 0
    v_lshlrev_b32 v5, 4, v2
    v_add_u32 v6, s38, v5
    v_pk_add_f32 v[64:65], v[32:33], v[108:109]
    v_pk_add_f32 v[66:67], v[34:35], v[108:109]
    v_pk_add_f32 v[68:69], v[36:37], v[108:109]
    v_pk_add_f32 v[70:71], v[38:39], v[108:109]
    v_pk_add_f32 v[72:73], v[40:41], v[108:109]
    v_pk_add_f32 v[74:75], v[42:43], v[108:109]
    v_pk_add_f32 v[76:77], v[44:45], v[108:109]
    v_pk_add_f32 v[78:79], v[46:47], v[108:109]
    v_cvt_pk_bf16_f32 v8, v64, v65
    v_cvt_pk_bf16_f32 v9, v66, v67
    v_cvt_pk_bf16_f32 v10, v68, v69
    v_cvt_pk_bf16_f32 v11, v70, v71
    v_cvt_pk_bf16_f32 v12, v72, v73
    v_cvt_pk_bf16_f32 v13, v74, v75
    v_cvt_pk_bf16_f32 v14, v76, v77
    v_cvt_pk_bf16_f32 v15, v78, v79
    v_lshlrev_b32 v64, 16, v8
    v_and_b32 v65, s36, v8
    v_lshlrev_b32 v66, 16, v9
    v_and_b32 v67, s36, v9
    v_lshlrev_b32 v68, 16, v10
    v_and_b32 v69, s36, v10
    v_lshlrev_b32 v70, 16, v11
    v_and_b32 v71, s36, v11
    v_lshlrev_b32 v72, 16, v12
    v_and_b32 v73, s36, v12
    v_lshlrev_b32 v74, 16, v13
    v_and_b32 v75, s36, v13
    v_lshlrev_b32 v76, 16, v14
    v_and_b32 v77, s36, v14
    v_lshlrev_b32 v78, 16, v15
    v_and_b32 v79, s36, v15
    v_pk_mul_f32 v[64:65], v[64:65], v[100:101]
    v_pk_mul_f32 v[66:67], v[66:67], v[100:101]
    v_pk_mul_f32 v[68:69], v[68:69], v[100:101]
    v_pk_mul_f32 v[70:71], v[70:71], v[100:101]
    v_pk_mul_f32 v[72:73], v[72:73], v[100:101]
    v_pk_mul_f32 v[74:75], v[74:75], v[100:101]
    v_pk_mul_f32 v[76:77], v[76:77], v[100:101]
    v_pk_mul_f32 v[78:79], v[78:79], v[100:101]
    v_cvt_pk_bf16_f32 v8, v64, v65
    v_cvt_pk_bf16_f32 v9, v66, v67
    v_cvt_pk_bf16_f32 v10, v68, v69
    v_cvt_pk_bf16_f32 v11, v70, v71
    v_cvt_pk_bf16_f32 v12, v72, v73
    v_cvt_pk_bf16_f32 v13, v74, v75
    v_cvt_pk_bf16_f32 v14, v76, v77
    v_cvt_pk_bf16_f32 v15, v78, v79
    ds_write_b128 v6, v[8:11] offset:0
    ds_write_b128 v6, v[12:15] offset:1024
    v_pk_add_f32 v[64:65], v[48:49], v[110:111]
    v_pk_add_f32 v[66:67], v[50:51], v[110:111]
    v_pk_add_f32 v[68:69], v[52:53], v[110:111]
    v_pk_add_f32 v[70:71], v[54:55], v[110:111]
    v_pk_add_f32 v[72:73], v[56:57], v[110:111]
    v_pk_add_f32 v[74:75], v[58:59], v[110:111]
    v_pk_add_f32 v[76:77], v[60:61], v[110:111]
    v_pk_add_f32 v[78:79], v[62:63], v[110:111]
    v_cvt_pk_bf16_f32 v16, v64, v65
    v_cvt_pk_bf16_f32 v17, v66, v67
    v_cvt_pk_bf16_f32 v18, v68, v69
    v_cvt_pk_bf16_f32 v19, v70, v71
    v_cvt_pk_bf16_f32 v20, v72, v73
    v_cvt_pk_bf16_f32 v21, v74, v75
    v_cvt_pk_bf16_f32 v22, v76, v77
    v_cvt_pk_bf16_f32 v23, v78, v79
    v_lshlrev_b32 v64, 16, v16
    v_and_b32 v65, s36, v16
    v_lshlrev_b32 v66, 16, v17
    v_and_b32 v67, s36, v17
    v_lshlrev_b32 v68, 16, v18
    v_and_b32 v69, s36, v18
    v_lshlrev_b32 v70, 16, v19
    v_and_b32 v71, s36, v19
    v_lshlrev_b32 v72, 16, v20
    v_and_b32 v73, s36, v20
    v_lshlrev_b32 v74, 16, v21
    v_and_b32 v75, s36, v21
    v_lshlrev_b32 v76, 16, v22
    v_and_b32 v77, s36, v22
    v_lshlrev_b32 v78, 16, v23
    v_and_b32 v79, s36, v23
    v_pk_mul_f32 v[64:65], v[64:65], v[102:103]
    v_pk_mul_f32 v[66:67], v[66:67], v[102:103]
    v_pk_mul_f32 v[68:69], v[68:69], v[102:103]
    v_pk_mul_f32 v[70:71], v[70:71], v[102:103]
    v_pk_mul_f32 v[72:73], v[72:73], v[102:103]
    v_pk_mul_f32 v[74:75], v[74:75], v[102:103]
    v_pk_mul_f32 v[76:77], v[76:77], v[102:103]
    v_pk_mul_f32 v[78:79], v[78:79], v[102:103]
    v_cvt_pk_bf16_f32 v16, v64, v65
    v_cvt_pk_bf16_f32 v17, v66, v67
    v_cvt_pk_bf16_f32 v18, v68, v69
    v_cvt_pk_bf16_f32 v19, v70, v71
    v_cvt_pk_bf16_f32 v20, v72, v73
    v_cvt_pk_bf16_f32 v21, v74, v75
    v_cvt_pk_bf16_f32 v22, v76, v77
    v_cvt_pk_bf16_f32 v23, v78, v79
    ds_write_b128 v6, v[16:19] offset:2112
    ds_write_b128 v6, v[20:23] offset:3136
    s_lshl_b32 s38, s31, 4
    s_add_u32 s38, s38, 33792
    v_mov_b32 v6, s38
    s_mov_b64 exec, 1
    ds_write_b128 v6, v[112:115]
    s_mov_b64 exec, -1
    s_waitcnt lgkmcnt(0)
    s_barrier
    s_mov_b32 s96, s82
    s_and_b32 s97, s83, 0xffff
    s_mov_b32 s98, 0x100
    s_mov_b32 s99, 0x00020000
    buffer_load_dword v1, off, s[96:99], 0 sc1
    s_waitcnt vmcnt(0)
    v_readfirstlane_b32 s3, v1
    s_nop 3
    s_cmp_lg_u32 s3, 0
    s_cbranch_scc1 L_bpepok_1
    s_mov_b32 s96, s82
    s_and_b32 s97, s83, 0xffff
    s_mov_b32 s98, 0x100
    s_mov_b32 s99, 0x00020000
    v_mov_b32 v6, 0
    s_mov_b32 s87, 0x40000
L_bpep_2:
    buffer_load_dword v127, v6, s[96:99], 0 offen sc1
    s_waitcnt vmcnt(0)
    v_cmp_eq_u32 vcc, 0, v127
    s_sub_u32 s87, s87, 1
    s_cbranch_scc1 L_bpepd_3
    s_cbranch_vccz L_bpepd_3
    s_sleep 2
    s_branch L_bpep_2
L_bpepd_3:
    v_readfirstlane_b32 s3, v127
    s_nop 4
L_bpepok_1:
    s_barrier
    v_lshlrev_b32 v119, 7, v2
    s_mov_b32 s40, 0x100000
    s_mov_b32 s41, 0x102000
    v_min_u32 v118, 11, v2
    v_lshlrev_b32 v118, 7, v118
    s_cmp_lg_u32 s39, 0
    s_cbranch_scc1 L_lnpolls_4
    s_mov_b32 s87, 0x40000
L_lnpoll_5:
    buffer_load_dword v126, v118, s[24:27], s40 offen sc1
    s_waitcnt vmcnt(0)
    v_cmp_ne_u32 vcc, s3, v126
    s_sub_u32 s87, s87, 1
    s_cbranch_scc1 L_lnpolld_6
    s_cbranch_vccz L_lnpolld_6
    s_sleep 2
    s_branch L_lnpoll_5
L_lnpolld_6:
L_lnpolls_4:
    s_barrier
    s_add_u32 m0, s44, 0
    s_nop 0
    buffer_load_dwordx4 v128, s[8:11], s28 offen sc1 lds
    buffer_load_dwordx4 v128, s[8:11], s28 offen offset:1024 sc1 lds
    s_add_u32 s28, s28, 65536
    s_add_u32 m0, s44, 8192
    s_nop 0
    buffer_load_dwordx4 v128, s[8:11], s28 offen sc1 lds
    buffer_load_dwordx4 v128, s[8:11], s28 offen offset:1024 sc1 lds
    s_add_u32 s28, s28, 65536
    s_add_u32 m0, s44, 16384
    s_nop 0
    buffer_load_dwordx4 v128, s[8:11], s28 offen sc1 lds
    buffer_load_dwordx4 v128, s[8:11], s28 offen offset:1024 sc1 lds
    s_add_u32 s28, s28, 65536
    s_waitcnt vmcnt(2)
    s_barrier
    s_add_u32 m0, s44, 24576
    s_nop 0
    buffer_load_dwordx4 v128, s[8:11], s28 offen sc1 lds
    buffer_load_dwordx4 v128, s[8:11], s28 offen offset:1024 sc1 lds
    s_add_u32 s28, s28, 65536
    s_add_u32 m0, s44, 32768
    s_nop 0
    buffer_load_dwordx4 v128, s[8:11], s28 offen sc1 lds
    buffer_load_dwordx4 v128, s[8:11], s28 offen offset:1024 sc1 lds
    s_add_u32 s28, s28, 65536
    s_add_u32 m0, s44, 40960
    s_nop 0
    buffer_load_dwordx4 v128, s[8:11], s28 offen sc1 lds
    buffer_load_dwordx4 v128, s[8:11], s28 offen offset:1024 sc1 lds
    s_add_u32 s28, s28, 65536
    buffer_load_dword v124, v119, s[24:27], s40 offen sc1
    buffer_load_dword v125, v119, s[24:27], s41 offen sc1
    s_mov_b32 s52, s6
    s_and_b32 s53, s7, 0xffff
    s_mov_b32 s54, 0xe00000
    s_mov_b32 s55, 0x00020000
    s_lshl_b32 s38, s48, 2
    s_add_u32 s38, s38, s39
    s_lshl_b32 s38, s38, 13
    v_lshlrev_b32 v116, 7, v2
    v_add_u32 v116, s38, v116
    s_waitcnt vmcnt(6)
    s_waitcnt vmcnt(0)
    v_xor_b32 v124, s3, v124
    v_xor_b32 v125, s3, v125
    v_or_b32 v124, v124, v125
    v_cmp_ne_u32 vcc, 0, v124
    s_nop 0
    s_cbranch_vccz L_lnok_7
    s_mov_b32 s87, 0x40000
L_lnpoll2_8:
    buffer_load_dword v126, v119, s[24:27], s40 offen sc1
    buffer_load_dword v127, v119, s[24:27], s41 offen sc1
    s_waitcnt vmcnt(0)
    v_xor_b32 v126, s3, v126
    v_xor_b32 v127, s3, v127
    v_or_b32 v126, v126, v127
    v_cmp_ne_u32 vcc, 0, v126
    s_sub_u32 s87, s87, 1
    s_cbranch_scc1 L_lnpoll2d_9
    s_cbranch_vccz L_lnpoll2d_9
    s_sleep 2
    s_branch L_lnpoll2_8
L_lnpoll2d_9:
L_lnok_7:
    s_barrier
    s_add_u32 m0, s44, 0
    s_nop 0
    buffer_load_dwordx4 v128, s[8:11], s28 offen sc1 lds
    buffer_load_dwordx4 v128, s[8:11], s28 offen offset:1024 sc1 lds
    s_add_u32 s28, s28, 65536
    s_add_u32 m0, s45, 0
    s_nop 0
    buffer_load_dwordx4 v129, s[12:15], s29 offen offset:0 lds
    buffer_load_dwordx4 v130, s[12:15], s29 offen offset:1024 lds
    buffer_load_dwordx4 v131, s[12:15], s29 offen offset:2048 lds
    buffer_load_dwordx4 v132, s[12:15], s29 offen offset:3072 lds
    s_add_u32 m0, s45, 4096
    s_nop 0
    buffer_load_dwordx4 v133, s[12:15], s29 offen offset:0 lds
    buffer_load_dwordx4 v134, s[12:15], s29 offen offset:1024 lds
    buffer_load_dwordx4 v135, s[12:15], s29 offen offset:2048 lds
    s_add_u32 s29, s29, 458752
    s_add_u32 m0, s44, 8192
    s_nop 0
    buffer_load_dwordx4 v128, s[8:11], s28 offen sc1 lds
    buffer_load_dwordx4 v128, s[8:11], s28 offen offset:1024 sc1 lds
    s_add_u32 s28, s28, 65536
    s_waitcnt vmcnt(13)
    s_barrier
    s_add_u32 m0, s44, 16384
    s_nop 0
    buffer_load_dwordx4 v128, s[8:11], s28 offen sc1 lds
    buffer_load_dwordx4 v128, s[8:11], s28 offen offset:1024 sc1 lds
    s_add_u32 s28, s28, 65536
    s_add_u32 m0, s45, 28672
    s_nop 0
    buffer_load_dwordx4 v129, s[12:15], s29 offen offset:0 lds
    buffer_load_dwordx4 v130, s[12:15], s29 offen offset:1024 lds
    buffer_load_dwordx4 v131, s[12:15], s29 offen offset:2048 lds
    buffer_load_dwordx4 v132, s[12:15], s29 offen offset:3072 lds
    s_add_u32 m0, s45, 32768
    s_nop 0
    buffer_load_dwordx4 v133, s[12:15], s29 offen offset:0 lds
    buffer_load_dwordx4 v134, s[12:15], s29 offen offset:1024 lds
    buffer_load_dwordx4 v135, s[12:15], s29 offen offset:2048 lds
    s_add_u32 s29, s29, 458752
    s_add_u32 m0, s44, 24576
    s_nop 0
    buffer_load_dwordx4 v128, s[8:11], s28 offen sc1 lds
    buffer_load_dwordx4 v128, s[8:11], s28 offen offset:1024 sc1 lds
    s_add_u32 s28, s28, 65536
    s_mov_b32 s30, 8
L_w1p_10:
    s_waitcnt vmcnt(11)
    s_barrier
    s_add_u32 m0, s44, 32768
    s_nop 0
    buffer_load_dwordx4 v128, s[8:11], s28 offen sc1 lds
    buffer_load_dwordx4 v128, s[8:11], s28 offen offset:1024 sc1 lds
    s_add_u32 s28, s28, 65536
    s_add_u32 m0, s45, 57344
    s_nop 0
    buffer_load_dwordx4 v129, s[12:15], s29 offen offset:0 lds
    buffer_load_dwordx4 v130, s[12:15], s29 offen offset:1024 lds
    buffer_load_dwordx4 v131, s[12:15], s29 offen offset:2048 lds
    buffer_load_dwordx4 v132, s[12:15], s29 offen offset:3072 lds
    s_add_u32 m0, s45, 61440
    s_nop 0
    buffer_load_dwordx4 v133, s[12:15], s29 offen offset:0 lds
    buffer_load_dwordx4 v134, s[12:15], s29 offen offset:1024 lds
    buffer_load_dwordx4 v135, s[12:15], s29 offen offset:2048 lds
    s_add_u32 s29, s29, 458752
    s_add_u32 m0, s44, 40960
    s_nop 0
    buffer_load_dwordx4 v128, s[8:11], s28 offen sc1 lds
    buffer_load_dwordx4 v128, s[8:11], s28 offen offset:1024 sc1 lds
    s_add_u32 s28, s28, 65536
    s_waitcnt vmcnt(11)
    s_barrier
    s_add_u32 m0, s44, 0
    s_nop 0
    buffer_load_dwordx4 v128, s[8:11], s28 offen sc1 lds
    buffer_load_dwordx4 v128, s[8:11], s28 offen offset:1024 sc1 lds
    s_add_u32 s28, s28, 65536
    s_add_u32 m0, s45, 0
    s_nop 0
    buffer_load_dwordx4 v129, s[12:15], s29 offen offset:0 lds
    buffer_load_dwordx4 v130, s[12:15], s29 offen offset:1024 lds
    buffer_load_dwordx4 v131, s[12:15], s29 offen offset:2048 lds
    buffer_load_dwordx4 v132, s[12:15], s29 offen offset:3072 lds
    s_add_u32 m0, s45, 4096
    s_nop 0
    buffer_load_dwordx4 v133, s[12:15], s29 offen offset:0 lds
    buffer_load_dwordx4 v134, s[12:15], s29 offen offset:1024 lds
    buffer_load_dwordx4 v135, s[12:15], s29 offen offset:2048 lds
    s_add_u32 s29, s29, 458752
    s_add_u32 m0, s44, 8192
    s_nop 0
    buffer_load_dwordx4 v128, s[8:11], s28 offen sc1 lds
    buffer_load_dwordx4 v128, s[8:11], s28 offen offset:1024 sc1 lds
    s_add_u32 s28, s28, 65536
    s_waitcnt vmcnt(11)
    s_barrier
    s_add_u32 m0, s44, 16384
    s_nop 0
    buffer_load_dwordx4 v128, s[8:11], s28 offen sc1 lds
    buffer_load_dwordx4 v128, s[8:11], s28 offen offset:1024 sc1 lds
    s_add_u32 s28, s28, 65536
    s_add_u32 m0, s45, 28672
    s_nop 0
    buffer_load_dwordx4 v129, s[12:15], s29 offen offset:0 lds
    buffer_load_dwordx4 v130, s[12:15], s29 offen offset:1024 lds
    buffer_load_dwordx4 v131, s[12:15], s29 offen offset:2048 lds
    buffer_load_dwordx4 v132, s[12:15], s29 offen offset:3072 lds
    s_add_u32 m0, s45, 32768
    s_nop 0
    buffer_load_dwordx4 v133, s[12:15], s29 offen offset:0 lds
    buffer_load_dwordx4 v134, s[12:15], s29 offen offset:1024 lds
    buffer_load_dwordx4 v135, s[12:15], s29 offen offset:2048 lds
    s_add_u32 s29, s29, 458752
    s_add_u32 m0, s44, 24576
    s_nop 0
    buffer_load_dwordx4 v128, s[8:11], s28 offen sc1 lds
    buffer_load_dwordx4 v128, s[8:11], s28 offen offset:1024 sc1 lds
    s_add_u32 s28, s28, 65536
    s_sub_u32 s30, s30, 1
    s_cmp_lg_u32 s30, 0
    s_cbranch_scc1 L_w1p_10
    s_waitcnt vmcnt(11)
    s_barrier
    s_add_u32 m0, s44, 32768
    s_nop 0
    buffer_load_dwordx4 v128, s[8:11], s28 offen sc1 lds
    buffer_load_dwordx4 v128, s[8:11], s28 offen offset:1024 sc1 lds
    s_add_u32 s28, s28, 65536
    s_add_u32 m0, s45, 57344
    s_nop 0
    buffer_load_dwordx4 v129, s[12:15], s29 offen offset:0 lds
    buffer_load_dwordx4 v130, s[12:15], s29 offen offset:1024 lds
    buffer_load_dwordx4 v131, s[12:15], s29 offen offset:2048 lds
    buffer_load_dwordx4 v132, s[12:15], s29 offen offset:3072 lds
    s_add_u32 m0, s45, 61440
    s_nop 0
    buffer_load_dwordx4 v133, s[12:15], s29 offen offset:0 lds
    buffer_load_dwordx4 v134, s[12:15], s29 offen offset:1024 lds
    buffer_load_dwordx4 v135, s[12:15], s29 offen offset:2048 lds
    s_add_u32 s29, s29, 458752
    s_add_u32 m0, s44, 40960
    s_nop 0
    buffer_load_dwordx4 v128, s[8:11], s28 offen sc1 lds
    buffer_load_dwordx4 v128, s[8:11], s28 offen offset:1024 sc1 lds
    s_add_u32 s28, s28, 65536
    s_waitcnt vmcnt(11)
    s_barrier
    s_add_u32 m0, s44, 0
    s_nop 0
    buffer_load_dwordx4 v128, s[8:11], s28 offen sc1 lds
    buffer_load_dwordx4 v128, s[8:11], s28 offen offset:1024 sc1 lds
    s_add_u32 s28, s28, 65536
    s_add_u32 m0, s45, 0
    s_nop 0
    buffer_load_dwordx4 v129, s[12:15], s29 offen offset:0 lds
    buffer_load_dwordx4 v130, s[12:15], s29 offen offset:1024 lds
    buffer_load_dwordx4 v131, s[12:15], s29 offen offset:2048 lds
    buffer_load_dwordx4 v132, s[12:15], s29 offen offset:3072 lds
    s_add_u32 m0, s45, 4096
    s_nop 0
    buffer_load_dwordx4 v133, s[12:15], s29 offen offset:0 lds
    buffer_load_dwordx4 v134, s[12:15], s29 offen offset:1024 lds
    buffer_load_dwordx4 v135, s[12:15], s29 offen offset:2048 lds
    s_add_u32 s29, s29, 458752
    s_add_u32 m0, s44, 8192
    s_nop 0
    buffer_load_dwordx4 v128, s[8:11], s28 offen sc1 lds
    buffer_load_dwordx4 v128, s[8:11], s28 offen offset:1024 sc1 lds
    s_add_u32 s28, s28, 65536
    s_waitcnt vmcnt(11)
    s_barrier
    s_add_u32 m0, s44, 16384
    s_nop 0
    buffer_load_dwordx4 v128, s[8:11], s28 offen sc1 lds
    buffer_load_dwordx4 v128, s[8:11], s28 offen offset:1024 sc1 lds
    s_add_u32 s28, s28, 65536
    s_add_u32 m0, s45, 28672
    s_nop 0
    buffer_load_dwordx4 v129, s[12:15], s29 offen offset:0 lds
    buffer_load_dwordx4 v130, s[12:15], s29 offen offset:1024 lds
    buffer_load_dwordx4 v131, s[12:15], s29 offen offset:2048 lds
    buffer_load_dwordx4 v132, s[12:15], s29 offen offset:3072 lds
    s_add_u32 m0, s45, 32768
    s_nop 0
    buffer_load_dwordx4 v133, s[12:15], s29 offen offset:0 lds
    buffer_load_dwordx4 v134, s[12:15], s29 offen offset:1024 lds
    buffer_load_dwordx4 v135, s[12:15], s29 offen offset:2048 lds
    s_add_u32 s29, s29, 458752
    s_add_u32 m0, s44, 24576
    s_nop 0
    buffer_load_dwordx4 v128, s[8:11], s28 offen sc1 lds
    buffer_load_dwordx4 v128, s[8:11], s28 offen offset:1024 sc1 lds
    s_add_u32 s28, s28, 65536
    s_mov_b32 s38, 0x0
    buffer_load_dword v250, v116, s[52:55], s38 offen
    s_mov_b32 s38, 0xc00000
    buffer_load_dword v250, v116, s[52:55], s38 offen
    s_waitcnt vmcnt(13)
    s_barrier
    s_waitcnt vmcnt(2)
    s_barrier
    s_barrier
    s_mov_b32 s38, s32
    s_mov_b32 s32, s33
    s_mov_b32 s33, s38
    s_mov_b32 s8, s4
    s_and_b32 s9, s5, 0xffff
    s_mov_b32 s10, 0x200000
    s_mov_b32 s11, 0x00020000
    s_add_u32 s12, s34, 0x1000000
    s_addc_u32 s13, s35, 0
    s_and_b32 s13, s13, 0xffff
    s_mov_b32 s14, 0x400000
    s_mov_b32 s15, 0x00020000
    s_mov_b32 s16, s6
    s_and_b32 s17, s7, 0xffff
    s_mov_b32 s18, 0xe00000
    s_mov_b32 s19, 0x00020000
    s_add_u32 s20, s34, 0x800000
    s_addc_u32 s21, s35, 0
    s_and_b32 s21, s21, 0xffff
    s_mov_b32 s22, 0x700000
    s_mov_b32 s23, 0x00020000
    s_add_u32 s24, s34, 0x1400000
    s_addc_u32 s25, s35, 0
    s_and_b32 s25, s25, 0xffff
    s_mov_b32 s26, 0x200000
    s_mov_b32 s27, 0x00020000
    s_lshl_b32 s49, s32, 3
    s_add_u32 s49, s49, s33
    v_lshlrev_b32 v5, 4, v2
    s_lshl_b32 s38, s39, 14
    s_lshl_b32 s44, s33, 11
    s_add_u32 s38, s38, s44
    v_add_u32 v9, s38, v5
    s_and_b32 s38, s39, 1
    s_lshl_b32 s38, s38, 2
    v_or_b32 v6, s38, v3
    v_lshlrev_b32 v6, 1, v6
    v_xor_b32 v6, v6, v4
    v_lshlrev_b32 v6, 4, v6
    s_lshl_b32 s38, s39, 3
    v_add_u32 v7, s38, v3
    s_lshl_b32 s44, s32, 8
    v_lshl_add_u32 v20, v7, 12, v6
    v_add_u32 v12, s44, v20
    v_add_u32 v13, 15360, v12
    s_lshl_b32 s44, s39, 11
    v_lshlrev_b32 v14, 7, v4
    s_lshl_b32 s46, s33, 11
    s_add_u32 s46, s46, 0x108000
    s_xor_b32 s38, s32, 8
    s_lshl_b32 s38, s38, 8
    v_add_u32 v10, s38, v20
    v_add_u32 v11, 15360, v10
    s_lshr_b32 s42, s32, 3
    s_mul_i32 s42, s42, 56
    s_lshl_b32 s43, s42, 17
    s_lshl_b32 s42, s42, 16
    s_add_u32 m0, s44, 49152
    s_nop 0
    buffer_load_dwordx4 v12, s[16:19], s43 offen lds
    buffer_load_dwordx4 v13, s[16:19], s43 offen offset:1024 lds
    s_add_u32 m0, s44, 98304
    s_nop 0
    buffer_load_dwordx4 v10, s[16:19], s43 offen lds
    buffer_load_dwordx4 v11, s[16:19], s43 offen offset:1024 lds
    s_add_u32 s43, s43, 131072
    s_cmp_eq_u32 s43, 0xe00000
    s_cselect_b32 s43, 0, s43
    s_add_u32 m0, s44, 57344
    s_nop 0
    buffer_load_dwordx4 v12, s[16:19], s43 offen lds
    buffer_load_dwordx4 v13, s[16:19], s43 offen offset:1024 lds
    s_add_u32 m0, s44, 106496
    s_nop 0
    buffer_load_dwordx4 v10, s[16:19], s43 offen lds
    buffer_load_dwordx4 v11, s[16:19], s43 offen offset:1024 lds
    s_add_u32 s43, s43, 131072
    s_cmp_eq_u32 s43, 0xe00000
    s_cselect_b32 s43, 0, s43
    s_add_u32 m0, s44, 65536
    s_nop 0
    buffer_load_dwordx4 v12, s[16:19], s43 offen lds
    buffer_load_dwordx4 v13, s[16:19], s43 offen offset:1024 lds
    s_add_u32 m0, s44, 114688
    s_nop 0
    buffer_load_dwordx4 v10, s[16:19], s43 offen lds
    buffer_load_dwordx4 v11, s[16:19], s43 offen offset:1024 lds
    s_add_u32 s43, s43, 131072
    s_cmp_eq_u32 s43, 0xe00000
    s_cselect_b32 s43, 0, s43
    s_add_u32 m0, s44, 73728
    s_nop 0
    buffer_load_dwordx4 v12, s[16:19], s43 offen lds
    buffer_load_dwordx4 v13, s[16:19], s43 offen offset:1024 lds
    s_add_u32 m0, s44, 122880
    s_nop 0
    buffer_load_dwordx4 v10, s[16:19], s43 offen lds
    buffer_load_dwordx4 v11, s[16:19], s43 offen offset:1024 lds
    s_add_u32 s43, s43, 131072
    s_cmp_eq_u32 s43, 0xe00000
    s_cselect_b32 s43, 0, s43
    s_add_u32 m0, s44, 81920
    s_nop 0
    buffer_load_dwordx4 v12, s[16:19], s43 offen lds
    buffer_load_dwordx4 v13, s[16:19], s43 offen offset:1024 lds
    s_add_u32 m0, s44, 131072
    s_nop 0
    buffer_load_dwordx4 v10, s[16:19], s43 offen lds
    buffer_load_dwordx4 v11, s[16:19], s43 offen offset:1024 lds
    s_add_u32 s43, s43, 131072
    s_cmp_eq_u32 s43, 0xe00000
    s_cselect_b32 s43, 0, s43
    s_add_u32 m0, s44, 90112
    s_nop 0
    buffer_load_dwordx4 v12, s[16:19], s43 offen lds
    buffer_load_dwordx4 v13, s[16:19], s43 offen offset:1024 lds
    s_add_u32 m0, s44, 139264
    s_nop 0
    buffer_load_dwordx4 v10, s[16:19], s43 offen lds
    buffer_load_dwordx4 v11, s[16:19], s43 offen offset:1024 lds
    s_add_u32 s43, s43, 131072
    s_cmp_eq_u32 s43, 0xe00000
    s_cselect_b32 s43, 0, s43
    s_barrier
    s_cmp_lg_u32 s39, 0
    s_cbranch_scc1 L_fpollb0s_11
    s_mov_b32 s87, 0x40000
L_fpollb0_12:
    buffer_load_dword v15, v14, s[24:27], s46 offen sc1
    s_waitcnt vmcnt(0)
    v_cmp_ne_u32 vcc, s3, v15
    s_sub_u32 s87, s87, 1
    s_cbranch_scc1 L_fpollb0d_13
    s_cbranch_vccz L_fpollb0d_13
    s_sleep 2
    s_branch L_fpollb0_12
L_fpollb0d_13:
L_fpollb0s_11:
    s_barrier
    s_add_u32 m0, s44, 0
    s_nop 0
    buffer_load_dwordx4 v9, s[20:23], s42 offen sc1 lds
    buffer_load_dwordx4 v9, s[20:23], s42 offen offset:1024 sc1 lds
    s_add_u32 s42, s42, 65536
    s_cmp_eq_u32 s42, 0x700000
    s_cselect_b32 s42, 0, s42
    s_add_u32 m0, s44, 8192
    s_nop 0
    buffer_load_dwordx4 v9, s[20:23], s42 offen sc1 lds
    buffer_load_dwordx4 v9, s[20:23], s42 offen offset:1024 sc1 lds
    s_add_u32 s42, s42, 65536
    s_cmp_eq_u32 s42, 0x700000
    s_cselect_b32 s42, 0, s42
    s_waitcnt vmcnt(2)
    s_barrier
    s_add_u32 m0, s44, 16384
    s_nop 0
    buffer_load_dwordx4 v9, s[20:23], s42 offen sc1 lds
    buffer_load_dwordx4 v9, s[20:23], s42 offen offset:1024 sc1 lds
    s_add_u32 s42, s42, 65536
    s_cmp_eq_u32 s42, 0x700000
    s_cselect_b32 s42, 0, s42
    s_add_u32 m0, s44, 24576
    s_nop 0
    buffer_load_dwordx4 v9, s[20:23], s42 offen sc1 lds
    buffer_load_dwordx4 v9, s[20:23], s42 offen offset:1024 sc1 lds
    s_add_u32 s42, s42, 65536
    s_cmp_eq_u32 s42, 0x700000
    s_cselect_b32 s42, 0, s42
    s_add_u32 m0, s44, 32768
    s_nop 0
    buffer_load_dwordx4 v9, s[20:23], s42 offen sc1 lds
    buffer_load_dwordx4 v9, s[20:23], s42 offen offset:1024 sc1 lds
    s_add_u32 s42, s42, 65536
    s_cmp_eq_u32 s42, 0x700000
    s_cselect_b32 s42, 0, s42
    s_add_u32 m0, s44, 40960
    s_nop 0
    buffer_load_dwordx4 v9, s[20:23], s42 offen sc1 lds
    buffer_load_dwordx4 v9, s[20:23], s42 offen offset:1024 sc1 lds
    s_add_u32 s42, s42, 65536
    s_cmp_eq_u32 s42, 0x700000
    s_cselect_b32 s42, 0, s42
    s_waitcnt vmcnt(6)
    s_barrier
    s_add_u32 m0, s44, 0
    s_nop 0
    buffer_load_dwordx4 v9, s[20:23], s42 offen sc1 lds
    buffer_load_dwordx4 v9, s[20:23], s42 offen offset:1024 sc1 lds
    s_add_u32 s42, s42, 65536
    s_cmp_eq_u32 s42, 0x700000
    s_cselect_b32 s42, 0, s42
    s_add_u32 m0, s44, 49152
    s_nop 0
    buffer_load_dwordx4 v12, s[16:19], s43 offen lds
    buffer_load_dwordx4 v13, s[16:19], s43 offen offset:1024 lds
    s_add_u32 m0, s44, 98304
    s_nop 0
    buffer_load_dwordx4 v10, s[16:19], s43 offen lds
    buffer_load_dwordx4 v11, s[16:19], s43 offen offset:1024 lds
    s_add_u32 s43, s43, 131072
    s_cmp_eq_u32 s43, 0xe00000
    s_cselect_b32 s43, 0, s43
    s_waitcnt vmcnt(8)
    s_barrier
    s_add_u32 m0, s44, 8192
    s_nop 0
    buffer_load_dwordx4 v9, s[20:23], s42 offen sc1 lds
    buffer_load_dwordx4 v9, s[20:23], s42 offen offset:1024 sc1 lds
    s_add_u32 s42, s42, 65536
    s_cmp_eq_u32 s42, 0x700000
    s_cselect_b32 s42, 0, s42
    s_add_u32 m0, s44, 57344
    s_nop 0
    buffer_load_dwordx4 v12, s[16:19], s43 offen lds
    buffer_load_dwordx4 v13, s[16:19], s43 offen offset:1024 lds
    s_add_u32 m0, s44, 106496
    s_nop 0
    buffer_load_dwordx4 v10, s[16:19], s43 offen lds
    buffer_load_dwordx4 v11, s[16:19], s43 offen offset:1024 lds
    s_add_u32 s43, s43, 131072
    s_cmp_eq_u32 s43, 0xe00000
    s_cselect_b32 s43, 0, s43
    s_add_u32 m0, s44, 16384
    s_nop 0
    buffer_load_dwordx4 v9, s[20:23], s42 offen sc1 lds
    buffer_load_dwordx4 v9, s[20:23], s42 offen offset:1024 sc1 lds
    s_add_u32 s42, s42, 65536
    s_cmp_eq_u32 s42, 0x700000
    s_cselect_b32 s42, 0, s42
    s_add_u32 m0, s44, 65536
    s_nop 0
    buffer_load_dwordx4 v12, s[16:19], s43 offen lds
    buffer_load_dwordx4 v13, s[16:19], s43 offen offset:1024 lds
    s_add_u32 m0, s44, 114688
    s_nop 0
    buffer_load_dwordx4 v10, s[16:19], s43 offen lds
    buffer_load_dwordx4 v11, s[16:19], s43 offen offset:1024 lds
    s_add_u32 s43, s43, 131072
    s_cmp_eq_u32 s43, 0xe00000
    s_cselect_b32 s43, 0, s43
    s_mov_b32 s30, 4
L_fp1_14:
    s_waitcnt vmcnt(12)
    s_barrier
    s_add_u32 m0, s44, 24576
    s_nop 0
    buffer_load_dwordx4 v9, s[20:23], s42 offen sc1 lds
    buffer_load_dwordx4 v9, s[20:23], s42 offen offset:1024 sc1 lds
    s_add_u32 s42, s42, 65536
    s_cmp_eq_u32 s42, 0x700000
    s_cselect_b32 s42, 0, s42
    s_add_u32 m0, s44, 73728
    s_nop 0
    buffer_load_dwordx4 v12, s[16:19], s43 offen lds
    buffer_load_dwordx4 v13, s[16:19], s43 offen offset:1024 lds
    s_add_u32 m0, s44, 122880
    s_nop 0
    buffer_load_dwordx4 v10, s[16:19], s43 offen lds
    buffer_load_dwordx4 v11, s[16:19], s43 offen offset:1024 lds
    s_add_u32 s43, s43, 131072
    s_cmp_eq_u32 s43, 0xe00000
    s_cselect_b32 s43, 0, s43
    s_add_u32 m0, s44, 32768
    s_nop 0
    buffer_load_dwordx4 v9, s[20:23], s42 offen sc1 lds
    buffer_load_dwordx4 v9, s[20:23], s42 offen offset:1024 sc1 lds
    s_add_u32 s42, s42, 65536
    s_cmp_eq_u32 s42, 0x700000
    s_cselect_b32 s42, 0, s42
    s_add_u32 m0, s44, 81920
    s_nop 0
    buffer_load_dwordx4 v12, s[16:19], s43 offen lds
    buffer_load_dwordx4 v13, s[16:19], s43 offen offset:1024 lds
    s_add_u32 m0, s44, 131072
    s_nop 0
    buffer_load_dwordx4 v10, s[16:19], s43 offen lds
    buffer_load_dwordx4 v11, s[16:19], s43 offen offset:1024 lds
    s_add_u32 s43, s43, 131072
    s_cmp_eq_u32 s43, 0xe00000
    s_cselect_b32 s43, 0, s43
    s_waitcnt vmcnt(12)
    s_barrier
    s_add_u32 m0, s44, 40960
    s_nop 0
    buffer_load_dwordx4 v9, s[20:23], s42 offen sc1 lds
    buffer_load_dwordx4 v9, s[20:23], s42 offen offset:1024 sc1 lds
    s_add_u32 s42, s42, 65536
    s_cmp_eq_u32 s42, 0x700000
    s_cselect_b32 s42, 0, s42
    s_add_u32 m0, s44, 90112
    s_nop 0
    buffer_load_dwordx4 v12, s[16:19], s43 offen lds
    buffer_load_dwordx4 v13, s[16:19], s43 offen offset:1024 lds
    s_add_u32 m0, s44, 139264
    s_nop 0
    buffer_load_dwordx4 v10, s[16:19], s43 offen lds
    buffer_load_dwordx4 v11, s[16:19], s43 offen offset:1024 lds
    s_add_u32 s43, s43, 131072
    s_cmp_eq_u32 s43, 0xe00000
    s_cselect_b32 s43, 0, s43
    s_add_u32 m0, s44, 0
    s_nop 0
    buffer_load_dwordx4 v9, s[20:23], s42 offen sc1 lds
    buffer_load_dwordx4 v9, s[20:23], s42 offen offset:1024 sc1 lds
    s_add_u32 s42, s42, 65536
    s_cmp_eq_u32 s42, 0x700000
    s_cselect_b32 s42, 0, s42
    s_add_u32 m0, s44, 49152
    s_nop 0
    buffer_load_dwordx4 v12, s[16:19], s43 offen lds
    buffer_load_dwordx4 v13, s[16:19], s43 offen offset:1024 lds
    s_add_u32 m0, s44, 98304
    s_nop 0
    buffer_load_dwordx4 v10, s[16:19], s43 offen lds
    buffer_load_dwordx4 v11, s[16:19], s43 offen offset:1024 lds
    s_add_u32 s43, s43, 131072
    s_cmp_eq_u32 s43, 0xe00000
    s_cselect_b32 s43, 0, s43
    s_waitcnt vmcnt(12)
    s_barrier
    s_add_u32 m0, s44, 8192
    s_nop 0
    buffer_load_dwordx4 v9, s[20:23], s42 offen sc1 lds
    buffer_load_dwordx4 v9, s[20:23], s42 offen offset:1024 sc1 lds
    s_add_u32 s42, s42, 65536
    s_cmp_eq_u32 s42, 0x700000
    s_cselect_b32 s42, 0, s42
    s_add_u32 m0, s44, 57344
    s_nop 0
    buffer_load_dwordx4 v12, s[16:19], s43 offen lds
    buffer_load_dwordx4 v13, s[16:19], s43 offen offset:1024 lds
    s_add_u32 m0, s44, 106496
    s_nop 0
    buffer_load_dwordx4 v10, s[16:19], s43 offen lds
    buffer_load_dwordx4 v11, s[16:19], s43 offen offset:1024 lds
    s_add_u32 s43, s43, 131072
    s_cmp_eq_u32 s43, 0xe00000
    s_cselect_b32 s43, 0, s43
    s_add_u32 m0, s44, 16384
    s_nop 0
    buffer_load_dwordx4 v9, s[20:23], s42 offen sc1 lds
    buffer_load_dwordx4 v9, s[20:23], s42 offen offset:1024 sc1 lds
    s_add_u32 s42, s42, 65536
    s_cmp_eq_u32 s42, 0x700000
    s_cselect_b32 s42, 0, s42
    s_add_u32 m0, s44, 65536
    s_nop 0
    buffer_load_dwordx4 v12, s[16:19], s43 offen lds
    buffer_load_dwordx4 v13, s[16:19], s43 offen offset:1024 lds
    s_add_u32 m0, s44, 114688
    s_nop 0
    buffer_load_dwordx4 v10, s[16:19], s43 offen lds
    buffer_load_dwordx4 v11, s[16:19], s43 offen offset:1024 lds
    s_add_u32 s43, s43, 131072
    s_cmp_eq_u32 s43, 0xe00000
    s_cselect_b32 s43, 0, s43
    s_sub_u32 s30, s30, 1
    s_cmp_lg_u32 s30, 0
    s_cbranch_scc1 L_fp1_14
    s_waitcnt vmcnt(12)
    s_barrier
    s_add_u32 m0, s44, 24576
    s_nop 0
    buffer_load_dwordx4 v9, s[20:23], s42 offen sc1 lds
    buffer_load_dwordx4 v9, s[20:23], s42 offen offset:1024 sc1 lds
    s_add_u32 s42, s42, 65536
    s_cmp_eq_u32 s42, 0x700000
    s_cselect_b32 s42, 0, s42
    s_add_u32 m0, s44, 73728
    s_nop 0
    buffer_load_dwordx4 v12, s[16:19], s43 offen lds
    buffer_load_dwordx4 v13, s[16:19], s43 offen offset:1024 lds
    s_add_u32 m0, s44, 122880
    s_nop 0
    buffer_load_dwordx4 v10, s[16:19], s43 offen lds
    buffer_load_dwordx4 v11, s[16:19], s43 offen offset:1024 lds
    s_add_u32 s43, s43, 131072
    s_cmp_eq_u32 s43, 0xe00000
    s_cselect_b32 s43, 0, s43
    s_waitcnt vmcnt(6)
    s_barrier
    s_waitcnt vmcnt(0)
    s_barrier
    s_endpgm
L_b_cons:
    s_mov_b32 s36, 0xffff0000
    s_mov_b32 s37, 0x3f803f80
    v_mov_b32 v96, 0
    v_mov_b32 v97, 0
    v_mov_b32 v98, 0
    v_mov_b32 v99, 0
    s_waitcnt vmcnt(2)
    v_lshlrev_b32 v32, 16, v8
    v_and_b32 v33, s36, v8
    v_lshlrev_b32 v34, 16, v9
    v_and_b32 v35, s36, v9
    v_lshlrev_b32 v36, 16, v10
    v_and_b32 v37, s36, v10
    v_lshlrev_b32 v38, 16, v11
    v_and_b32 v39, s36, v11
    v_lshlrev_b32 v40, 16, v12
    v_and_b32 v41, s36, v12
    v_lshlrev_b32 v42, 16, v13
    v_and_b32 v43, s36, v13
    v_lshlrev_b32 v44, 16, v14
    v_and_b32 v45, s36, v14
    v_lshlrev_b32 v46, 16, v15
    v_and_b32 v47, s36, v15
    v_dot2_f32_bf16 v96, v8, s37, v96
    v_dot2_f32_bf16 v96, v9, s37, v96
    v_dot2_f32_bf16 v96, v10, s37, v96
    v_dot2_f32_bf16 v96, v11, s37, v96
    v_dot2_f32_bf16 v96, v12, s37, v96
    v_dot2_f32_bf16 v96, v13, s37, v96
    v_dot2_f32_bf16 v96, v14, s37, v96
    v_dot2_f32_bf16 v96, v15, s37, v96
    v_lshlrev_b32 v48, 16, v16
    v_and_b32 v49, s36, v16
    v_lshlrev_b32 v50, 16, v17
    v_and_b32 v51, s36, v17
    v_lshlrev_b32 v52, 16, v18
    v_and_b32 v53, s36, v18
    v_lshlrev_b32 v54, 16, v19
    v_and_b32 v55, s36, v19
    v_lshlrev_b32 v56, 16, v20
    v_and_b32 v57, s36, v20
    v_lshlrev_b32 v58, 16, v21
    v_and_b32 v59, s36, v21
    v_lshlrev_b32 v60, 16, v22
    v_and_b32 v61, s36, v22
    v_lshlrev_b32 v62, 16, v23
    v_and_b32 v63, s36, v23
    v_dot2_f32_bf16 v97, v16, s37, v97
    v_dot2_f32_bf16 v97, v17, s37, v97
    v_dot2_f32_bf16 v97, v18, s37, v97
    v_dot2_f32_bf16 v97, v19, s37, v97
    v_dot2_f32_bf16 v97, v20, s37, v97
    v_dot2_f32_bf16 v97, v21, s37, v97
    v_dot2_f32_bf16 v97, v22, s37, v97
    v_dot2_f32_bf16 v97, v23, s37, v97
    s_waitcnt vmcnt(0)
    v_dot2_f32_bf16 v98, v8, v24, v98
    v_dot2_f32_bf16 v99, v16, v24, v99
    v_dot2_f32_bf16 v98, v9, v25, v98
    v_dot2_f32_bf16 v99, v17, v25, v99
    v_dot2_f32_bf16 v98, v10, v26, v98
    v_dot2_f32_bf16 v99, v18, v26, v99
    v_dot2_f32_bf16 v98, v11, v27, v98
    v_dot2_f32_bf16 v99, v19, v27, v99
    v_dot2_f32_bf16 v98, v12, v28, v98
    v_dot2_f32_bf16 v99, v20, v28, v99
    v_dot2_f32_bf16 v98, v13, v29, v98
    v_dot2_f32_bf16 v99, v21, v29, v99
    v_dot2_f32_bf16 v98, v14, v30, v98
    v_dot2_f32_bf16 v99, v22, v30, v99
    v_dot2_f32_bf16 v98, v15, v31, v98
    v_dot2_f32_bf16 v99, v23, v31, v99
    s_nop 2
    v_add_f32_dpp v96, v96, v96 quad_perm:[1,0,3,2] row_mask:0xf bank_mask:0xf
    v_add_f32_dpp v97, v97, v97 quad_perm:[1,0,3,2] row_mask:0xf bank_mask:0xf
    v_add_f32_dpp v98, v98, v98 quad_perm:[1,0,3,2] row_mask:0xf bank_mask:0xf
    v_add_f32_dpp v99, v99, v99 quad_perm:[1,0,3,2] row_mask:0xf bank_mask:0xf
    v_add_f32_dpp v96, v96, v96 quad_perm:[2,3,0,1] row_mask:0xf bank_mask:0xf
    v_add_f32_dpp v97, v97, v97 quad_perm:[2,3,0,1] row_mask:0xf bank_mask:0xf
    v_add_f32_dpp v98, v98, v98 quad_perm:[2,3,0,1] row_mask:0xf bank_mask:0xf
    v_add_f32_dpp v99, v99, v99 quad_perm:[2,3,0,1] row_mask:0xf bank_mask:0xf
    v_add_f32_dpp v96, v96, v96 row_half_mirror row_mask:0xf bank_mask:0xf
    v_add_f32_dpp v97, v97, v97 row_half_mirror row_mask:0xf bank_mask:0xf
    v_add_f32_dpp v98, v98, v98 row_half_mirror row_mask:0xf bank_mask:0xf
    v_add_f32_dpp v99, v99, v99 row_half_mirror row_mask:0xf bank_mask:0xf
    v_add_f32_dpp v96, v96, v96 row_mirror row_mask:0xf bank_mask:0xf
    v_add_f32_dpp v97, v97, v97 row_mirror row_mask:0xf bank_mask:0xf
    v_add_f32_dpp v98, v98, v98 row_mirror row_mask:0xf bank_mask:0xf
    v_add_f32_dpp v99, v99, v99 row_mirror row_mask:0xf bank_mask:0xf
    v_mov_b32 v104, v96
    v_mov_b32 v105, v97
    v_mov_b32 v106, v98
    v_mov_b32 v107, v99
    s_nop 1
    v_permlane16_swap_b32 v96, v104
    v_permlane16_swap_b32 v97, v105
    v_permlane16_swap_b32 v98, v106
    v_permlane16_swap_b32 v99, v107
    v_add_f32 v96, v96, v104
    v_add_f32 v97, v97, v105
    v_add_f32 v98, v98, v106
    v_add_f32 v99, v99, v107
    v_mov_b32 v104, v96
    v_mov_b32 v105, v97
    v_mov_b32 v106, v98
    v_mov_b32 v107, v99
    s_nop 1
    v_permlane32_swap_b32 v96, v104
    v_permlane32_swap_b32 v97, v105
    v_permlane32_swap_b32 v98, v106
    v_permlane32_swap_b32 v99, v107
    v_add_f32 v96, v96, v104
    v_add_f32 v97, v97, v105
    v_add_f32 v98, v98, v106
    v_add_f32 v99, v99, v107
    v_mul_f32 v96, 0x3a800000, v96
    v_sub_f32 v108, 0, v96
    v_mov_b32 v109, v108
    v_mov_b32 v100, 0
    v_mov_b32 v101, 0
    v_mul_f32 v97, 0x3a800000, v97
    v_sub_f32 v110, 0, v97
    v_mov_b32 v111, v110
    v_mov_b32 v102, 0
    v_mov_b32 v103, 0
    v_pk_add_f32 v[64:65], v[32:33], v[108:109]
    v_pk_add_f32 v[66:67], v[34:35], v[108:109]
    v_pk_add_f32 v[68:69], v[36:37], v[108:109]
    v_pk_add_f32 v[70:71], v[38:39], v[108:109]
    v_pk_add_f32 v[72:73], v[40:41], v[108:109]
    v_pk_add_f32 v[74:75], v[42:43], v[108:109]
    v_pk_add_f32 v[76:77], v[44:45], v[108:109]
    v_pk_add_f32 v[78:79], v[46:47], v[108:109]
    v_pk_fma_f32 v[100:101], v[64:65], v[64:65], v[100:101]
    v_pk_fma_f32 v[100:101], v[66:67], v[66:67], v[100:101]
    v_pk_fma_f32 v[100:101], v[68:69], v[68:69], v[100:101]
    v_pk_fma_f32 v[100:101], v[70:71], v[70:71], v[100:101]
    v_pk_fma_f32 v[100:101], v[72:73], v[72:73], v[100:101]
    v_pk_fma_f32 v[100:101], v[74:75], v[74:75], v[100:101]
    v_pk_fma_f32 v[100:101], v[76:77], v[76:77], v[100:101]
    v_pk_fma_f32 v[100:101], v[78:79], v[78:79], v[100:101]
    v_add_f32 v100, v100, v101
    v_pk_add_f32 v[64:65], v[48:49], v[110:111]
    v_pk_add_f32 v[66:67], v[50:51], v[110:111]
    v_pk_add_f32 v[68:69], v[52:53], v[110:111]
    v_pk_add_f32 v[70:71], v[54:55], v[110:111]
    v_pk_add_f32 v[72:73], v[56:57], v[110:111]
    v_pk_add_f32 v[74:75], v[58:59], v[110:111]
    v_pk_add_f32 v[76:77], v[60:61], v[110:111]
    v_pk_add_f32 v[78:79], v[62:63], v[110:111]
    v_pk_fma_f32 v[102:103], v[64:65], v[64:65], v[102:103]
    v_pk_fma_f32 v[102:103], v[66:67], v[66:67], v[102:103]
    v_pk_fma_f32 v[102:103], v[68:69], v[68:69], v[102:103]
    v_pk_fma_f32 v[102:103], v[70:71], v[70:71], v[102:103]
    v_pk_fma_f32 v[102:103], v[72:73], v[72:73], v[102:103]
    v_pk_fma_f32 v[102:103], v[74:75], v[74:75], v[102:103]
    v_pk_fma_f32 v[102:103], v[76:77], v[76:77], v[102:103]
    v_pk_fma_f32 v[102:103], v[78:79], v[78:79], v[102:103]
    v_add_f32 v102, v102, v103
    s_nop 0
    v_add_f32_dpp v100, v100, v100 quad_perm:[1,0,3,2] row_mask:0xf bank_mask:0xf
    v_add_f32_dpp v102, v102, v102 quad_perm:[1,0,3,2] row_mask:0xf bank_mask:0xf
    s_nop 0
    v_add_f32_dpp v100, v100, v100 quad_perm:[2,3,0,1] row_mask:0xf bank_mask:0xf
    v_add_f32_dpp v102, v102, v102 quad_perm:[2,3,0,1] row_mask:0xf bank_mask:0xf
    s_nop 0
    v_add_f32_dpp v100, v100, v100 row_half_mirror row_mask:0xf bank_mask:0xf
    v_add_f32_dpp v102, v102, v102 row_half_mirror row_mask:0xf bank_mask:0xf
    s_nop 0
    v_add_f32_dpp v100, v100, v100 row_mirror row_mask:0xf bank_mask:0xf
    v_add_f32_dpp v102, v102, v102 row_mirror row_mask:0xf bank_mask:0xf
    v_mov_b32 v104, v100
    v_mov_b32 v105, v102
    s_nop 1
    v_permlane16_swap_b32 v100, v104
    v_permlane16_swap_b32 v102, v105
    v_add_f32 v100, v100, v104
    v_add_f32 v102, v102, v105
    v_mov_b32 v104, v100
    v_mov_b32 v105, v102
    s_nop 1
    v_permlane32_swap_b32 v100, v104
    v_permlane32_swap_b32 v102, v105
    v_add_f32 v100, v100, v104
    v_add_f32 v102, v102, v105
    v_cvt_pk_bf16_f32 v96, v96, v98
    v_cvt_pk_bf16_f32 v97, v97, v99
    v_mul_f32 v100, 0x3a800000, v100
    v_mul_f32 v102, 0x3a800000, v102
    v_and_b32 v98, s36, v96
    v_and_b32 v99, s36, v97
    v_lshlrev_b32 v96, 16, v96
    v_lshlrev_b32 v97, 16, v97
    v_cvt_pk_bf16_f32 v100, v100, v100
    v_cvt_pk_bf16_f32 v102, v102, v102
    v_mul_f32 v98, 0xbfb8aa3b, v98
    v_mul_f32 v99, 0xbfb8aa3b, v99
    v_and_b32 v100, s36, v100
    v_and_b32 v102, s36, v102
    v_exp_f32 v98, v98
    v_exp_f32 v99, v99
    v_add_f32 v100, 0x3727c5ac, v100
    v_add_f32 v102, 0x3727c5ac, v102
    v_sub_f32 v108, 0, v96
    v_sub_f32 v110, 0, v97
    v_add_f32 v98, 1.0, v98
    v_add_f32 v99, 1.0, v99
    v_cvt_pk_bf16_f32 v100, v100, v100
    v_cvt_pk_bf16_f32 v102, v102, v102
    v_rcp_f32 v98, v98
    v_rcp_f32 v99, v99
    v_and_b32 v100, s36, v100
    v_and_b32 v102, s36, v102
    v_mov_b32 v109, v108
    v_mov_b32 v111, v110
    v_sqrt_f32 v100, v100
    v_sqrt_f32 v102, v102
    v_cvt_pk_bf16_f32 v98, v98, v98
    v_cvt_pk_bf16_f32 v99, v99, v99
    v_and_b32 v112, s36, v98
    v_and_b32 v114, s36, v99
    v_cvt_pk_bf16_f32 v100, v100, v100
    v_cvt_pk_bf16_f32 v102, v102, v102
    v_sub_f32 v113, 1.0, v112
    v_sub_f32 v115, 1.0, v114
    v_and_b32 v100, s36, v100
    v_and_b32 v102, s36, v102
    v_cvt_pk_bf16_f32 v113, v113, v113
    v_cvt_pk_bf16_f32 v115, v115, v115
    v_rcp_f32 v100, v100
    v_rcp_f32 v102, v102
    v_and_b32 v113, s36, v113
    v_and_b32 v115, s36, v115
    v_mov_b32 v101, v100
    v_mov_b32 v103, v102
    s_mul_i32 s38, s31, 4224
    s_add_u32 s38, s38, 0
    v_lshlrev_b32 v5, 4, v2
    v_add_u32 v6, s38, v5
    v_pk_add_f32 v[64:65], v[32:33], v[108:109]
    v_pk_add_f32 v[66:67], v[34:35], v[108:109]
    v_pk_add_f32 v[68:69], v[36:37], v[108:109]
    v_pk_add_f32 v[70:71], v[38:39], v[108:109]
    v_pk_add_f32 v[72:73], v[40:41], v[108:109]
    v_pk_add_f32 v[74:75], v[42:43], v[108:109]
    v_pk_add_f32 v[76:77], v[44:45], v[108:109]
    v_pk_add_f32 v[78:79], v[46:47], v[108:109]
    v_cvt_pk_bf16_f32 v8, v64, v65
    v_cvt_pk_bf16_f32 v9, v66, v67
    v_cvt_pk_bf16_f32 v10, v68, v69
    v_cvt_pk_bf16_f32 v11, v70, v71
    v_cvt_pk_bf16_f32 v12, v72, v73
    v_cvt_pk_bf16_f32 v13, v74, v75
    v_cvt_pk_bf16_f32 v14, v76, v77
    v_cvt_pk_bf16_f32 v15, v78, v79
    v_lshlrev_b32 v64, 16, v8
    v_and_b32 v65, s36, v8
    v_lshlrev_b32 v66, 16, v9
    v_and_b32 v67, s36, v9
    v_lshlrev_b32 v68, 16, v10
    v_and_b32 v69, s36, v10
    v_lshlrev_b32 v70, 16, v11
    v_and_b32 v71, s36, v11
    v_lshlrev_b32 v72, 16, v12
    v_and_b32 v73, s36, v12
    v_lshlrev_b32 v74, 16, v13
    v_and_b32 v75, s36, v13
    v_lshlrev_b32 v76, 16, v14
    v_and_b32 v77, s36, v14
    v_lshlrev_b32 v78, 16, v15
    v_and_b32 v79, s36, v15
    v_pk_mul_f32 v[64:65], v[64:65], v[100:101]
    v_pk_mul_f32 v[66:67], v[66:67], v[100:101]
    v_pk_mul_f32 v[68:69], v[68:69], v[100:101]
    v_pk_mul_f32 v[70:71], v[70:71], v[100:101]
    v_pk_mul_f32 v[72:73], v[72:73], v[100:101]
    v_pk_mul_f32 v[74:75], v[74:75], v[100:101]
    v_pk_mul_f32 v[76:77], v[76:77], v[100:101]
    v_pk_mul_f32 v[78:79], v[78:79], v[100:101]
    v_cvt_pk_bf16_f32 v8, v64, v65
    v_cvt_pk_bf16_f32 v9, v66, v67
    v_cvt_pk_bf16_f32 v10, v68, v69
    v_cvt_pk_bf16_f32 v11, v70, v71
    v_cvt_pk_bf16_f32 v12, v72, v73
    v_cvt_pk_bf16_f32 v13, v74, v75
    v_cvt_pk_bf16_f32 v14, v76, v77
    v_cvt_pk_bf16_f32 v15, v78, v79
    ds_write_b128 v6, v[8:11] offset:0
    ds_write_b128 v6, v[12:15] offset:1024
    v_pk_add_f32 v[64:65], v[48:49], v[110:111]
    v_pk_add_f32 v[66:67], v[50:51], v[110:111]
    v_pk_add_f32 v[68:69], v[52:53], v[110:111]
    v_pk_add_f32 v[70:71], v[54:55], v[110:111]
    v_pk_add_f32 v[72:73], v[56:57], v[110:111]
    v_pk_add_f32 v[74:75], v[58:59], v[110:111]
    v_pk_add_f32 v[76:77], v[60:61], v[110:111]
    v_pk_add_f32 v[78:79], v[62:63], v[110:111]
    v_cvt_pk_bf16_f32 v16, v64, v65
    v_cvt_pk_bf16_f32 v17, v66, v67
    v_cvt_pk_bf16_f32 v18, v68, v69
    v_cvt_pk_bf16_f32 v19, v70, v71
    v_cvt_pk_bf16_f32 v20, v72, v73
    v_cvt_pk_bf16_f32 v21, v74, v75
    v_cvt_pk_bf16_f32 v22, v76, v77
    v_cvt_pk_bf16_f32 v23, v78, v79
    v_lshlrev_b32 v64, 16, v16
    v_and_b32 v65, s36, v16
    v_lshlrev_b32 v66, 16, v17
    v_and_b32 v67, s36, v17
    v_lshlrev_b32 v68, 16, v18
    v_and_b32 v69, s36, v18
    v_lshlrev_b32 v70, 16, v19
    v_and_b32 v71, s36, v19
    v_lshlrev_b32 v72, 16, v20
    v_and_b32 v73, s36, v20
    v_lshlrev_b32 v74, 16, v21
    v_and_b32 v75, s36, v21
    v_lshlrev_b32 v76, 16, v22
    v_and_b32 v77, s36, v22
    v_lshlrev_b32 v78, 16, v23
    v_and_b32 v79, s36, v23
    v_pk_mul_f32 v[64:65], v[64:65], v[102:103]
    v_pk_mul_f32 v[66:67], v[66:67], v[102:103]
    v_pk_mul_f32 v[68:69], v[68:69], v[102:103]
    v_pk_mul_f32 v[70:71], v[70:71], v[102:103]
    v_pk_mul_f32 v[72:73], v[72:73], v[102:103]
    v_pk_mul_f32 v[74:75], v[74:75], v[102:103]
    v_pk_mul_f32 v[76:77], v[76:77], v[102:103]
    v_pk_mul_f32 v[78:79], v[78:79], v[102:103]
    v_cvt_pk_bf16_f32 v16, v64, v65
    v_cvt_pk_bf16_f32 v17, v66, v67
    v_cvt_pk_bf16_f32 v18, v68, v69
    v_cvt_pk_bf16_f32 v19, v70, v71
    v_cvt_pk_bf16_f32 v20, v72, v73
    v_cvt_pk_bf16_f32 v21, v74, v75
    v_cvt_pk_bf16_f32 v22, v76, v77
    v_cvt_pk_bf16_f32 v23, v78, v79
    ds_write_b128 v6, v[16:19] offset:2112
    ds_write_b128 v6, v[20:23] offset:3136
    s_lshl_b32 s38, s31, 4
    s_add_u32 s38, s38, 33792
    v_mov_b32 v6, s38
    s_mov_b64 exec, 1
    ds_write_b128 v6, v[112:115]
    s_mov_b64 exec, -1
    s_waitcnt lgkmcnt(0)
    s_barrier
    s_mov_b32 s96, s82
    s_and_b32 s97, s83, 0xffff
    s_mov_b32 s98, 0x100
    s_mov_b32 s99, 0x00020000
    buffer_load_dword v1, off, s[96:99], 0 sc1
    v_lshrrev_b32 v7, 2, v4
    v_mul_u32_u24 v7, 2112, v7
    v_lshl_add_u32 v7, v3, 5, v7
    v_and_b32 v6, 3, v4
    v_lshl_add_u32 v7, v6, 3, v7
    s_lshl_b32 s38, s31, 9
    s_add_u32 s38, s38, 0
    v_add_u32 v7, s38, v7
    ds_read_b64_tr_b16 v[8:9], v7 offset:0
    ds_read_b64_tr_b16 v[10:11], v7 offset:8448
    ds_read_b64_tr_b16 v[12:13], v7 offset:128
    ds_read_b64_tr_b16 v[14:15], v7 offset:8576
    ds_read_b64_tr_b16 v[16:17], v7 offset:256
    ds_read_b64_tr_b16 v[18:19], v7 offset:8704
    ds_read_b64_tr_b16 v[20:21], v7 offset:384
    ds_read_b64_tr_b16 v[22:23], v7 offset:8832
    ds_read_b64_tr_b16 v[24:25], v7 offset:16896
    ds_read_b64_tr_b16 v[26:27], v7 offset:25344
    ds_read_b64_tr_b16 v[28:29], v7 offset:17024
    ds_read_b64_tr_b16 v[30:31], v7 offset:25472
    ds_read_b64_tr_b16 v[32:33], v7 offset:17152
    ds_read_b64_tr_b16 v[34:35], v7 offset:25600
    ds_read_b64_tr_b16 v[36:37], v7 offset:17280
    ds_read_b64_tr_b16 v[38:39], v7 offset:25728
    v_lshlrev_b32 v6, 2, v2
    v_and_b32 v6, 31, v6
    s_lshl_b32 s38, s31, 5
    v_add_u32 v6, s38, v6
    v_add_u32 v41, 33792, v6
    ds_read_b32 v40, v41
    s_lshl_b32 s38, s48, 15
    s_lshl_b32 s40, s31, 12
    s_add_u32 s38, s38, s40
    s_add_u32 s40, s38, 16384
    s_lshl_b32 s41, s48, 7
    s_waitcnt lgkmcnt(0)
    buffer_store_dwordx4 v[8:11], v5, s[8:11], s38 offen offset:0 sc1
    buffer_store_dwordx4 v[12:15], v5, s[8:11], s38 offen offset:1024 sc1
    buffer_store_dwordx4 v[16:19], v5, s[8:11], s38 offen offset:2048 sc1
    buffer_store_dwordx4 v[20:23], v5, s[8:11], s38 offen offset:3072 sc1
    buffer_store_dwordx4 v[24:27], v5, s[8:11], s40 offen offset:0 sc1
    buffer_store_dwordx4 v[28:31], v5, s[8:11], s40 offen offset:1024 sc1
    buffer_store_dwordx4 v[32:35], v5, s[8:11], s40 offen offset:2048 sc1
    buffer_store_dwordx4 v[36:39], v5, s[8:11], s40 offen offset:3072 sc1
    s_mov_b64 exec, 0xff
    buffer_store_dword v40, v6, s[24:27], s41 offen sc1
    s_mov_b64 exec, -1
    s_waitcnt vmcnt(0)
    v_readfirstlane_b32 s3, v1
    s_nop 3
    s_cmp_lg_u32 s3, 0
    s_cbranch_scc1 L_bepok_15
    s_mov_b32 s96, s82
    s_and_b32 s97, s83, 0xffff
    s_mov_b32 s98, 0x100
    s_mov_b32 s99, 0x00020000
    v_mov_b32 v6, 0
    s_mov_b32 s87, 0x40000
L_bep_16:
    buffer_load_dword v127, v6, s[96:99], 0 offen sc1
    s_waitcnt vmcnt(0)
    v_cmp_eq_u32 vcc, 0, v127
    s_sub_u32 s87, s87, 1
    s_cbranch_scc1 L_bepd_17
    s_cbranch_vccz L_bepd_17
    s_sleep 2
    s_branch L_bep_16
L_bepd_17:
    v_readfirstlane_b32 s3, v127
    s_nop 4
L_bepok_15:
    v_mov_b32 v6, 0
    s_waitcnt vmcnt(0)
    s_barrier
    s_cmp_lg_u32 s31, 0
    s_cbranch_scc1 L_b_noflag
    s_lshl_b32 s38, s48, 7
    s_add_u32 s38, s38, 0x100000
    v_mov_b32 v5, s3
    s_mov_b64 exec, 1
    buffer_store_dword v5, v6, s[24:27], s38 offen sc1
    s_mov_b64 exec, -1
L_b_noflag:
    s_mov_b32 s36, s46
    s_mov_b32 s37, s47
    s_and_b32 s46, s31, 1
    s_lshr_b32 s47, s31, 1
    s_mul_i32 s38, s47, 224
    s_add_u32 s38, s38, s37
    v_lshlrev_b32 v5, 3, v3
    v_add_u32 v5, s38, v5
    buffer_load_dwordx2 v[240:241], v5, s[20:23], 0 offen offset:0
    buffer_load_dwordx2 v[242:243], v5, s[20:23], 0 offen offset:32
    buffer_load_dwordx2 v[244:245], v5, s[20:23], 0 offen offset:64
    buffer_load_dwordx2 v[246:247], v5, s[20:23], 0 offen offset:96
    buffer_load_dwordx2 v[248:249], v5, s[20:23], 0 offen offset:128
    buffer_load_dwordx2 v[250:251], v5, s[20:23], 0 offen offset:160
    buffer_load_dwordx2 v[252:253], v5, s[20:23], 0 offen offset:192
    s_lshl_b32 s38, s46, 10
    v_lshlrev_b32 v5, 11, v3
    v_lshl_add_u32 v5, v4, 4, v5
    v_add_u32 v96, s38, v5
    v_lshrrev_b32 v5, 2, v4
    v_lshl_add_u32 v6, v3, 3, v5
    v_and_b32 v7, 1, v3
    v_and_b32 v1, 3, v4
    v_lshlrev_b32 v1, 3, v1
    v_mul_u32_u24 v117, 448, v6
    v_add_u32 v117, v117, v1
    s_mul_i32 s38, s47, 224
    s_add_u32 s38, s38, 49152
    v_add_u32 v117, s38, v117
    v_lshlrev_b32 v118, 5, v7
    v_sub_u32 v119, 0, v118
    s_cmp_eq_u32 s47, 0
    s_cselect_b64 vcc, -1, 0
    v_cndmask_b32 v120, v119, v118, vcc
    v_cndmask_b32 v121, v118, v119, vcc
    v_add_u32 v122, 0, v117
    v_add_u32 v100, v122, v120
    v_add_u32 v101, v122, v121
    v_add_u32 v122, 57344, v117
    v_add_u32 v102, v122, v120
    v_add_u32 v103, v122, v121
    s_mov_b32 s52, 0xffff0000
    s_waitcnt vmcnt(0)
    v_lshlrev_b32 v128, 16, v240
    v_and_b32 v129, s52, v240
    v_lshlrev_b32 v130, 16, v241
    v_and_b32 v131, s52, v241
    v_mov_b32 v132, v128
    v_mov_b32 v133, v129
    v_mov_b32 v134, v130
    v_mov_b32 v135, v131
    v_mov_b32 v136, v128
    v_mov_b32 v137, v129
    v_mov_b32 v138, v130
    v_mov_b32 v139, v131
    v_mov_b32 v140, v128
    v_mov_b32 v141, v129
    v_mov_b32 v142, v130
    v_mov_b32 v143, v131
    v_lshlrev_b32 v144, 16, v242
    v_and_b32 v145, s52, v242
    v_lshlrev_b32 v146, 16, v243
    v_and_b32 v147, s52, v243
    v_mov_b32 v148, v144
    v_mov_b32 v149, v145
    v_mov_b32 v150, v146
    v_mov_b32 v151, v147
    v_mov_b32 v152, v144
    v_mov_b32 v153, v145
    v_mov_b32 v154, v146
    v_mov_b32 v155, v147
    v_mov_b32 v156, v144
    v_mov_b32 v157, v145
    v_mov_b32 v158, v146
    v_mov_b32 v159, v147
    v_lshlrev_b32 v160, 16, v244
    v_and_b32 v161, s52, v244
    v_lshlrev_b32 v162, 16, v245
    v_and_b32 v163, s52, v245
    v_mov_b32 v164, v160
    v_mov_b32 v165, v161
    v_mov_b32 v166, v162
    v_mov_b32 v167, v163
    v_mov_b32 v168, v160
    v_mov_b32 v169, v161
    v_mov_b32 v170, v162
    v_mov_b32 v171, v163
    v_mov_b32 v172, v160
    v_mov_b32 v173, v161
    v_mov_b32 v174, v162
    v_mov_b32 v175, v163
    v_lshlrev_b32 v176, 16, v246
    v_and_b32 v177, s52, v246
    v_lshlrev_b32 v178, 16, v247
    v_and_b32 v179, s52, v247
    v_mov_b32 v180, v176
    v_mov_b32 v181, v177
    v_mov_b32 v182, v178
    v_mov_b32 v183, v179
    v_mov_b32 v184, v176
    v_mov_b32 v185, v177
    v_mov_b32 v186, v178
    v_mov_b32 v187, v179
    v_mov_b32 v188, v176
    v_mov_b32 v189, v177
    v_mov_b32 v190, v178
    v_mov_b32 v191, v179
    v_lshlrev_b32 v192, 16, v248
    v_and_b32 v193, s52, v248
    v_lshlrev_b32 v194, 16, v249
    v_and_b32 v195, s52, v249
    v_mov_b32 v196, v192
    v_mov_b32 v197, v193
    v_mov_b32 v198, v194
    v_mov_b32 v199, v195
    v_mov_b32 v200, v192
    v_mov_b32 v201, v193
    v_mov_b32 v202, v194
    v_mov_b32 v203, v195
    v_mov_b32 v204, v192
    v_mov_b32 v205, v193
    v_mov_b32 v206, v194
    v_mov_b32 v207, v195
    v_lshlrev_b32 v208, 16, v250
    v_and_b32 v209, s52, v250
    v_lshlrev_b32 v210, 16, v251
    v_and_b32 v211, s52, v251
    v_mov_b32 v212, v208
    v_mov_b32 v213, v209
    v_mov_b32 v214, v210
    v_mov_b32 v215, v211
    v_mov_b32 v216, v208
    v_mov_b32 v217, v209
    v_mov_b32 v218, v210
    v_mov_b32 v219, v211
    v_mov_b32 v220, v208
    v_mov_b32 v221, v209
    v_mov_b32 v222, v210
    v_mov_b32 v223, v211
    v_lshlrev_b32 v224, 16, v252
    v_and_b32 v225, s52, v252
    v_lshlrev_b32 v226, 16, v253
    v_and_b32 v227, s52, v253
    v_mov_b32 v228, v224
    v_mov_b32 v229, v225
    v_mov_b32 v230, v226
    v_mov_b32 v231, v227
    v_mov_b32 v232, v224
    v_mov_b32 v233, v225
    v_mov_b32 v234, v226
    v_mov_b32 v235, v227
    v_mov_b32 v236, v224
    v_mov_b32 v237, v225
    v_mov_b32 v238, v226
    v_mov_b32 v239, v227
    s_setprio 1
    s_barrier
    s_barrier
    .p2align 6
    ds_read_b128 v[36:39], v96 offset:0
    ds_read_b64_tr_b16 v[8:9], v100 offset:0
    ds_read_b64_tr_b16 v[10:11], v100 offset:1792
    ds_read_b128 v[40:43], v96 offset:256
    ds_read_b128 v[44:47], v96 offset:512
    ds_read_b128 v[48:51], v96 offset:768
    ds_read_b64_tr_b16 v[12:13], v101 offset:32
    ds_read_b64_tr_b16 v[14:15], v101 offset:1824
    ds_read_b64_tr_b16 v[16:17], v100 offset:64
    ds_read_b64_tr_b16 v[18:19], v100 offset:1856
    ds_read_b64_tr_b16 v[20:21], v101 offset:96
    ds_read_b64_tr_b16 v[22:23], v101 offset:1888
    ds_read_b64_tr_b16 v[24:25], v100 offset:128
    ds_read_b64_tr_b16 v[26:27], v100 offset:1920
    ds_read_b64_tr_b16 v[28:29], v101 offset:160
    ds_read_b64_tr_b16 v[30:31], v101 offset:1952
    ds_read_b64_tr_b16 v[32:33], v100 offset:192
    ds_read_b64_tr_b16 v[34:35], v100 offset:1984
    s_mov_b32 s30, 10
    s_nop 0
L_w1c_18:
    s_waitcnt lgkmcnt(0)
    s_nop 0
    v_mfma_f32_16x16x32_bf16 v[128:131], v[8:11], v[36:39], v[128:131]
    ds_read_b128 v[80:83], v96 offset:8192
    v_mfma_f32_16x16x32_bf16 v[132:135], v[8:11], v[40:43], v[132:135]
    ds_read_b64_tr_b16 v[52:53], v100 offset:14336
    v_mfma_f32_16x16x32_bf16 v[136:139], v[8:11], v[44:47], v[136:139]
    ds_read_b64_tr_b16 v[54:55], v100 offset:16128
    v_mfma_f32_16x16x32_bf16 v[140:143], v[8:11], v[48:51], v[140:143]
    ds_read_b128 v[84:87], v96 offset:8448
    v_mfma_f32_16x16x32_bf16 v[156:159], v[12:15], v[48:51], v[156:159]
    ds_read_b128 v[88:91], v96 offset:8704
    v_mfma_f32_16x16x32_bf16 v[152:155], v[12:15], v[44:47], v[152:155]
    ds_read_b128 v[92:95], v96 offset:8960
    v_mfma_f32_16x16x32_bf16 v[148:151], v[12:15], v[40:43], v[148:151]
    ds_read_b64_tr_b16 v[56:57], v101 offset:14368
    v_mfma_f32_16x16x32_bf16 v[144:147], v[12:15], v[36:39], v[144:147]
    ds_read_b64_tr_b16 v[58:59], v101 offset:16160
    v_mfma_f32_16x16x32_bf16 v[160:163], v[16:19], v[36:39], v[160:163]
    ds_read_b64_tr_b16 v[60:61], v100 offset:14400
    v_mfma_f32_16x16x32_bf16 v[164:167], v[16:19], v[40:43], v[164:167]
    v_mfma_f32_16x16x32_bf16 v[168:171], v[16:19], v[44:47], v[168:171]
    ds_read_b64_tr_b16 v[62:63], v100 offset:16192
    v_mfma_f32_16x16x32_bf16 v[172:175], v[16:19], v[48:51], v[172:175]
    ds_read_b64_tr_b16 v[64:65], v101 offset:14432
    v_mfma_f32_16x16x32_bf16 v[188:191], v[20:23], v[48:51], v[188:191]
    ds_read_b64_tr_b16 v[66:67], v101 offset:16224
    v_mfma_f32_16x16x32_bf16 v[184:187], v[20:23], v[44:47], v[184:187]
    ds_read_b64_tr_b16 v[68:69], v100 offset:14464
    v_mfma_f32_16x16x32_bf16 v[180:183], v[20:23], v[40:43], v[180:183]
    ds_read_b64_tr_b16 v[70:71], v100 offset:16256
    v_mfma_f32_16x16x32_bf16 v[176:179], v[20:23], v[36:39], v[176:179]
    ds_read_b64_tr_b16 v[72:73], v101 offset:14496
    v_mfma_f32_16x16x32_bf16 v[192:195], v[24:27], v[36:39], v[192:195]
    ds_read_b64_tr_b16 v[74:75], v101 offset:16288
    v_mfma_f32_16x16x32_bf16 v[196:199], v[24:27], v[40:43], v[196:199]
    ds_read_b64_tr_b16 v[76:77], v100 offset:14528
    v_mfma_f32_16x16x32_bf16 v[200:203], v[24:27], v[44:47], v[200:203]
    ds_read_b64_tr_b16 v[78:79], v100 offset:16320
    v_mfma_f32_16x16x32_bf16 v[204:207], v[24:27], v[48:51], v[204:207]
    v_mfma_f32_16x16x32_bf16 v[220:223], v[28:31], v[48:51], v[220:223]
    v_mfma_f32_16x16x32_bf16 v[216:219], v[28:31], v[44:47], v[216:219]
    v_mfma_f32_16x16x32_bf16 v[212:215], v[28:31], v[40:43], v[212:215]
    v_mfma_f32_16x16x32_bf16 v[208:211], v[28:31], v[36:39], v[208:211]
    v_mfma_f32_16x16x32_bf16 v[224:227], v[32:35], v[36:39], v[224:227]
    v_mfma_f32_16x16x32_bf16 v[228:231], v[32:35], v[40:43], v[228:231]
    v_mfma_f32_16x16x32_bf16 v[232:235], v[32:35], v[44:47], v[232:235]
    v_mfma_f32_16x16x32_bf16 v[236:239], v[32:35], v[48:51], v[236:239]
    s_waitcnt lgkmcnt(0)
    s_barrier
    v_mfma_f32_16x16x32_bf16 v[128:131], v[52:55], v[80:83], v[128:131]
    ds_read_b128 v[36:39], v96 offset:16384
    v_mfma_f32_16x16x32_bf16 v[132:135], v[52:55], v[84:87], v[132:135]
    ds_read_b64_tr_b16 v[8:9], v100 offset:28672
    v_mfma_f32_16x16x32_bf16 v[136:139], v[52:55], v[88:91], v[136:139]
    ds_read_b64_tr_b16 v[10:11], v100 offset:30464
    v_mfma_f32_16x16x32_bf16 v[140:143], v[52:55], v[92:95], v[140:143]
    ds_read_b128 v[40:43], v96 offset:16640
    v_mfma_f32_16x16x32_bf16 v[156:159], v[56:59], v[92:95], v[156:159]
    ds_read_b128 v[44:47], v96 offset:16896
    v_mfma_f32_16x16x32_bf16 v[152:155], v[56:59], v[88:91], v[152:155]
    ds_read_b128 v[48:51], v96 offset:17152
    v_mfma_f32_16x16x32_bf16 v[148:151], v[56:59], v[84:87], v[148:151]
    ds_read_b64_tr_b16 v[12:13], v101 offset:28704
    v_mfma_f32_16x16x32_bf16 v[144:147], v[56:59], v[80:83], v[144:147]
    ds_read_b64_tr_b16 v[14:15], v101 offset:30496
    v_mfma_f32_16x16x32_bf16 v[160:163], v[60:63], v[80:83], v[160:163]
    ds_read_b64_tr_b16 v[16:17], v100 offset:28736
    v_mfma_f32_16x16x32_bf16 v[164:167], v[60:63], v[84:87], v[164:167]
    v_mfma_f32_16x16x32_bf16 v[168:171], v[60:63], v[88:91], v[168:171]
    ds_read_b64_tr_b16 v[18:19], v100 offset:30528
    v_mfma_f32_16x16x32_bf16 v[172:175], v[60:63], v[92:95], v[172:175]
    ds_read_b64_tr_b16 v[20:21], v101 offset:28768
    v_mfma_f32_16x16x32_bf16 v[188:191], v[64:67], v[92:95], v[188:191]
    ds_read_b64_tr_b16 v[22:23], v101 offset:30560
    v_mfma_f32_16x16x32_bf16 v[184:187], v[64:67], v[88:91], v[184:187]
    ds_read_b64_tr_b16 v[24:25], v100 offset:28800
    v_mfma_f32_16x16x32_bf16 v[180:183], v[64:67], v[84:87], v[180:183]
    ds_read_b64_tr_b16 v[26:27], v100 offset:30592
    v_mfma_f32_16x16x32_bf16 v[176:179], v[64:67], v[80:83], v[176:179]
    ds_read_b64_tr_b16 v[28:29], v101 offset:28832
    v_mfma_f32_16x16x32_bf16 v[192:195], v[68:71], v[80:83], v[192:195]
    ds_read_b64_tr_b16 v[30:31], v101 offset:30624
    v_mfma_f32_16x16x32_bf16 v[196:199], v[68:71], v[84:87], v[196:199]
    ds_read_b64_tr_b16 v[32:33], v100 offset:28864
    v_mfma_f32_16x16x32_bf16 v[200:203], v[68:71], v[88:91], v[200:203]
    ds_read_b64_tr_b16 v[34:35], v100 offset:30656
    v_mfma_f32_16x16x32_bf16 v[204:207], v[68:71], v[92:95], v[204:207]
    v_mfma_f32_16x16x32_bf16 v[220:223], v[72:75], v[92:95], v[220:223]
    v_mfma_f32_16x16x32_bf16 v[216:219], v[72:75], v[88:91], v[216:219]
    v_mfma_f32_16x16x32_bf16 v[212:215], v[72:75], v[84:87], v[212:215]
    v_mfma_f32_16x16x32_bf16 v[208:211], v[72:75], v[80:83], v[208:211]
    v_mfma_f32_16x16x32_bf16 v[224:227], v[76:79], v[80:83], v[224:227]
    v_mfma_f32_16x16x32_bf16 v[228:231], v[76:79], v[84:87], v[228:231]
    v_mfma_f32_16x16x32_bf16 v[232:235], v[76:79], v[88:91], v[232:235]
    v_mfma_f32_16x16x32_bf16 v[236:239], v[76:79], v[92:95], v[236:239]
    s_waitcnt lgkmcnt(0)
    s_nop 0
    v_mfma_f32_16x16x32_bf16 v[128:131], v[8:11], v[36:39], v[128:131]
    ds_read_b128 v[80:83], v96 offset:24576
    v_mfma_f32_16x16x32_bf16 v[132:135], v[8:11], v[40:43], v[132:135]
    ds_read_b64_tr_b16 v[52:53], v100 offset:43008
    v_mfma_f32_16x16x32_bf16 v[136:139], v[8:11], v[44:47], v[136:139]
    ds_read_b64_tr_b16 v[54:55], v100 offset:44800
    v_mfma_f32_16x16x32_bf16 v[140:143], v[8:11], v[48:51], v[140:143]
    ds_read_b128 v[84:87], v96 offset:24832
    v_mfma_f32_16x16x32_bf16 v[156:159], v[12:15], v[48:51], v[156:159]
    ds_read_b128 v[88:91], v96 offset:25088
    v_mfma_f32_16x16x32_bf16 v[152:155], v[12:15], v[44:47], v[152:155]
    ds_read_b128 v[92:95], v96 offset:25344
    v_mfma_f32_16x16x32_bf16 v[148:151], v[12:15], v[40:43], v[148:151]
    ds_read_b64_tr_b16 v[56:57], v101 offset:43040
    v_mfma_f32_16x16x32_bf16 v[144:147], v[12:15], v[36:39], v[144:147]
    ds_read_b64_tr_b16 v[58:59], v101 offset:44832
    v_mfma_f32_16x16x32_bf16 v[160:163], v[16:19], v[36:39], v[160:163]
    ds_read_b64_tr_b16 v[60:61], v100 offset:43072
    v_mfma_f32_16x16x32_bf16 v[164:167], v[16:19], v[40:43], v[164:167]
    v_mfma_f32_16x16x32_bf16 v[168:171], v[16:19], v[44:47], v[168:171]
    ds_read_b64_tr_b16 v[62:63], v100 offset:44864
    v_mfma_f32_16x16x32_bf16 v[172:175], v[16:19], v[48:51], v[172:175]
    ds_read_b64_tr_b16 v[64:65], v101 offset:43104
    v_mfma_f32_16x16x32_bf16 v[188:191], v[20:23], v[48:51], v[188:191]
    ds_read_b64_tr_b16 v[66:67], v101 offset:44896
    v_mfma_f32_16x16x32_bf16 v[184:187], v[20:23], v[44:47], v[184:187]
    ds_read_b64_tr_b16 v[68:69], v100 offset:43136
    v_mfma_f32_16x16x32_bf16 v[180:183], v[20:23], v[40:43], v[180:183]
    ds_read_b64_tr_b16 v[70:71], v100 offset:44928
    v_mfma_f32_16x16x32_bf16 v[176:179], v[20:23], v[36:39], v[176:179]
    ds_read_b64_tr_b16 v[72:73], v101 offset:43168
    v_mfma_f32_16x16x32_bf16 v[192:195], v[24:27], v[36:39], v[192:195]
    ds_read_b64_tr_b16 v[74:75], v101 offset:44960
    v_mfma_f32_16x16x32_bf16 v[196:199], v[24:27], v[40:43], v[196:199]
    ds_read_b64_tr_b16 v[76:77], v100 offset:43200
    v_mfma_f32_16x16x32_bf16 v[200:203], v[24:27], v[44:47], v[200:203]
    ds_read_b64_tr_b16 v[78:79], v100 offset:44992
    v_mfma_f32_16x16x32_bf16 v[204:207], v[24:27], v[48:51], v[204:207]
    v_mfma_f32_16x16x32_bf16 v[220:223], v[28:31], v[48:51], v[220:223]
    v_mfma_f32_16x16x32_bf16 v[216:219], v[28:31], v[44:47], v[216:219]
    v_mfma_f32_16x16x32_bf16 v[212:215], v[28:31], v[40:43], v[212:215]
    v_mfma_f32_16x16x32_bf16 v[208:211], v[28:31], v[36:39], v[208:211]
    v_mfma_f32_16x16x32_bf16 v[224:227], v[32:35], v[36:39], v[224:227]
    v_mfma_f32_16x16x32_bf16 v[228:231], v[32:35], v[40:43], v[228:231]
    v_mfma_f32_16x16x32_bf16 v[232:235], v[32:35], v[44:47], v[232:235]
    v_mfma_f32_16x16x32_bf16 v[236:239], v[32:35], v[48:51], v[236:239]
    s_waitcnt lgkmcnt(0)
    s_barrier
    v_mfma_f32_16x16x32_bf16 v[128:131], v[52:55], v[80:83], v[128:131]
    ds_read_b128 v[36:39], v96 offset:32768
    v_mfma_f32_16x16x32_bf16 v[132:135], v[52:55], v[84:87], v[132:135]
    ds_read_b64_tr_b16 v[8:9], v102 offset:0
    v_mfma_f32_16x16x32_bf16 v[136:139], v[52:55], v[88:91], v[136:139]
    ds_read_b64_tr_b16 v[10:11], v102 offset:1792
    v_mfma_f32_16x16x32_bf16 v[140:143], v[52:55], v[92:95], v[140:143]
    ds_read_b128 v[40:43], v96 offset:33024
    v_mfma_f32_16x16x32_bf16 v[156:159], v[56:59], v[92:95], v[156:159]
    ds_read_b128 v[44:47], v96 offset:33280
    v_mfma_f32_16x16x32_bf16 v[152:155], v[56:59], v[88:91], v[152:155]
    ds_read_b128 v[48:51], v96 offset:33536
    v_mfma_f32_16x16x32_bf16 v[148:151], v[56:59], v[84:87], v[148:151]
    ds_read_b64_tr_b16 v[12:13], v103 offset:32
    v_mfma_f32_16x16x32_bf16 v[144:147], v[56:59], v[80:83], v[144:147]
    ds_read_b64_tr_b16 v[14:15], v103 offset:1824
    v_mfma_f32_16x16x32_bf16 v[160:163], v[60:63], v[80:83], v[160:163]
    ds_read_b64_tr_b16 v[16:17], v102 offset:64
    v_mfma_f32_16x16x32_bf16 v[164:167], v[60:63], v[84:87], v[164:167]
    v_mfma_f32_16x16x32_bf16 v[168:171], v[60:63], v[88:91], v[168:171]
    ds_read_b64_tr_b16 v[18:19], v102 offset:1856
    v_mfma_f32_16x16x32_bf16 v[172:175], v[60:63], v[92:95], v[172:175]
    ds_read_b64_tr_b16 v[20:21], v103 offset:96
    v_mfma_f32_16x16x32_bf16 v[188:191], v[64:67], v[92:95], v[188:191]
    ds_read_b64_tr_b16 v[22:23], v103 offset:1888
    v_mfma_f32_16x16x32_bf16 v[184:187], v[64:67], v[88:91], v[184:187]
    ds_read_b64_tr_b16 v[24:25], v102 offset:128
    v_mfma_f32_16x16x32_bf16 v[180:183], v[64:67], v[84:87], v[180:183]
    ds_read_b64_tr_b16 v[26:27], v102 offset:1920
    v_mfma_f32_16x16x32_bf16 v[176:179], v[64:67], v[80:83], v[176:179]
    ds_read_b64_tr_b16 v[28:29], v103 offset:160
    v_mfma_f32_16x16x32_bf16 v[192:195], v[68:71], v[80:83], v[192:195]
    ds_read_b64_tr_b16 v[30:31], v103 offset:1952
    v_mfma_f32_16x16x32_bf16 v[196:199], v[68:71], v[84:87], v[196:199]
    ds_read_b64_tr_b16 v[32:33], v102 offset:192
    v_mfma_f32_16x16x32_bf16 v[200:203], v[68:71], v[88:91], v[200:203]
    ds_read_b64_tr_b16 v[34:35], v102 offset:1984
    v_mfma_f32_16x16x32_bf16 v[204:207], v[68:71], v[92:95], v[204:207]
    v_mfma_f32_16x16x32_bf16 v[220:223], v[72:75], v[92:95], v[220:223]
    v_mfma_f32_16x16x32_bf16 v[216:219], v[72:75], v[88:91], v[216:219]
    v_mfma_f32_16x16x32_bf16 v[212:215], v[72:75], v[84:87], v[212:215]
    v_mfma_f32_16x16x32_bf16 v[208:211], v[72:75], v[80:83], v[208:211]
    v_mfma_f32_16x16x32_bf16 v[224:227], v[76:79], v[80:83], v[224:227]
    v_mfma_f32_16x16x32_bf16 v[228:231], v[76:79], v[84:87], v[228:231]
    v_mfma_f32_16x16x32_bf16 v[232:235], v[76:79], v[88:91], v[232:235]
    v_mfma_f32_16x16x32_bf16 v[236:239], v[76:79], v[92:95], v[236:239]
    s_waitcnt lgkmcnt(0)
    s_nop 0
    v_mfma_f32_16x16x32_bf16 v[128:131], v[8:11], v[36:39], v[128:131]
    ds_read_b128 v[80:83], v96 offset:40960
    v_mfma_f32_16x16x32_bf16 v[132:135], v[8:11], v[40:43], v[132:135]
    ds_read_b64_tr_b16 v[52:53], v102 offset:14336
    v_mfma_f32_16x16x32_bf16 v[136:139], v[8:11], v[44:47], v[136:139]
    ds_read_b64_tr_b16 v[54:55], v102 offset:16128
    v_mfma_f32_16x16x32_bf16 v[140:143], v[8:11], v[48:51], v[140:143]
    ds_read_b128 v[84:87], v96 offset:41216
    v_mfma_f32_16x16x32_bf16 v[156:159], v[12:15], v[48:51], v[156:159]
    ds_read_b128 v[88:91], v96 offset:41472
    v_mfma_f32_16x16x32_bf16 v[152:155], v[12:15], v[44:47], v[152:155]
    ds_read_b128 v[92:95], v96 offset:41728
    v_mfma_f32_16x16x32_bf16 v[148:151], v[12:15], v[40:43], v[148:151]
    ds_read_b64_tr_b16 v[56:57], v103 offset:14368
    v_mfma_f32_16x16x32_bf16 v[144:147], v[12:15], v[36:39], v[144:147]
    ds_read_b64_tr_b16 v[58:59], v103 offset:16160
    v_mfma_f32_16x16x32_bf16 v[160:163], v[16:19], v[36:39], v[160:163]
    ds_read_b64_tr_b16 v[60:61], v102 offset:14400
    v_mfma_f32_16x16x32_bf16 v[164:167], v[16:19], v[40:43], v[164:167]
    v_mfma_f32_16x16x32_bf16 v[168:171], v[16:19], v[44:47], v[168:171]
    ds_read_b64_tr_b16 v[62:63], v102 offset:16192
    v_mfma_f32_16x16x32_bf16 v[172:175], v[16:19], v[48:51], v[172:175]
    ds_read_b64_tr_b16 v[64:65], v103 offset:14432
    v_mfma_f32_16x16x32_bf16 v[188:191], v[20:23], v[48:51], v[188:191]
    ds_read_b64_tr_b16 v[66:67], v103 offset:16224
    v_mfma_f32_16x16x32_bf16 v[184:187], v[20:23], v[44:47], v[184:187]
    ds_read_b64_tr_b16 v[68:69], v102 offset:14464
    v_mfma_f32_16x16x32_bf16 v[180:183], v[20:23], v[40:43], v[180:183]
    ds_read_b64_tr_b16 v[70:71], v102 offset:16256
    v_mfma_f32_16x16x32_bf16 v[176:179], v[20:23], v[36:39], v[176:179]
    ds_read_b64_tr_b16 v[72:73], v103 offset:14496
    v_mfma_f32_16x16x32_bf16 v[192:195], v[24:27], v[36:39], v[192:195]
    ds_read_b64_tr_b16 v[74:75], v103 offset:16288
    v_mfma_f32_16x16x32_bf16 v[196:199], v[24:27], v[40:43], v[196:199]
    ds_read_b64_tr_b16 v[76:77], v102 offset:14528
    v_mfma_f32_16x16x32_bf16 v[200:203], v[24:27], v[44:47], v[200:203]
    ds_read_b64_tr_b16 v[78:79], v102 offset:16320
    v_mfma_f32_16x16x32_bf16 v[204:207], v[24:27], v[48:51], v[204:207]
    v_mfma_f32_16x16x32_bf16 v[220:223], v[28:31], v[48:51], v[220:223]
    v_mfma_f32_16x16x32_bf16 v[216:219], v[28:31], v[44:47], v[216:219]
    v_mfma_f32_16x16x32_bf16 v[212:215], v[28:31], v[40:43], v[212:215]
    v_mfma_f32_16x16x32_bf16 v[208:211], v[28:31], v[36:39], v[208:211]
    v_mfma_f32_16x16x32_bf16 v[224:227], v[32:35], v[36:39], v[224:227]
    v_mfma_f32_16x16x32_bf16 v[228:231], v[32:35], v[40:43], v[228:231]
    v_mfma_f32_16x16x32_bf16 v[232:235], v[32:35], v[44:47], v[232:235]
    v_mfma_f32_16x16x32_bf16 v[236:239], v[32:35], v[48:51], v[236:239]
    s_waitcnt lgkmcnt(0)
    s_barrier
    v_mfma_f32_16x16x32_bf16 v[128:131], v[52:55], v[80:83], v[128:131]
    ds_read_b128 v[36:39], v96 offset:0
    v_mfma_f32_16x16x32_bf16 v[132:135], v[52:55], v[84:87], v[132:135]
    ds_read_b64_tr_b16 v[8:9], v100 offset:0
    v_mfma_f32_16x16x32_bf16 v[136:139], v[52:55], v[88:91], v[136:139]
    ds_read_b64_tr_b16 v[10:11], v100 offset:1792
    v_mfma_f32_16x16x32_bf16 v[140:143], v[52:55], v[92:95], v[140:143]
    ds_read_b128 v[40:43], v96 offset:256
    v_mfma_f32_16x16x32_bf16 v[156:159], v[56:59], v[92:95], v[156:159]
    ds_read_b128 v[44:47], v96 offset:512
    v_mfma_f32_16x16x32_bf16 v[152:155], v[56:59], v[88:91], v[152:155]
    ds_read_b128 v[48:51], v96 offset:768
    v_mfma_f32_16x16x32_bf16 v[148:151], v[56:59], v[84:87], v[148:151]
    ds_read_b64_tr_b16 v[12:13], v101 offset:32
    v_mfma_f32_16x16x32_bf16 v[144:147], v[56:59], v[80:83], v[144:147]
    ds_read_b64_tr_b16 v[14:15], v101 offset:1824
    v_mfma_f32_16x16x32_bf16 v[160:163], v[60:63], v[80:83], v[160:163]
    ds_read_b64_tr_b16 v[16:17], v100 offset:64
    v_mfma_f32_16x16x32_bf16 v[164:167], v[60:63], v[84:87], v[164:167]
    v_mfma_f32_16x16x32_bf16 v[168:171], v[60:63], v[88:91], v[168:171]
    ds_read_b64_tr_b16 v[18:19], v100 offset:1856
    v_mfma_f32_16x16x32_bf16 v[172:175], v[60:63], v[92:95], v[172:175]
    ds_read_b64_tr_b16 v[20:21], v101 offset:96
    v_mfma_f32_16x16x32_bf16 v[188:191], v[64:67], v[92:95], v[188:191]
    ds_read_b64_tr_b16 v[22:23], v101 offset:1888
    v_mfma_f32_16x16x32_bf16 v[184:187], v[64:67], v[88:91], v[184:187]
    ds_read_b64_tr_b16 v[24:25], v100 offset:128
    v_mfma_f32_16x16x32_bf16 v[180:183], v[64:67], v[84:87], v[180:183]
    ds_read_b64_tr_b16 v[26:27], v100 offset:1920
    v_mfma_f32_16x16x32_bf16 v[176:179], v[64:67], v[80:83], v[176:179]
    ds_read_b64_tr_b16 v[28:29], v101 offset:160
    v_mfma_f32_16x16x32_bf16 v[192:195], v[68:71], v[80:83], v[192:195]
    ds_read_b64_tr_b16 v[30:31], v101 offset:1952
    v_mfma_f32_16x16x32_bf16 v[196:199], v[68:71], v[84:87], v[196:199]
    ds_read_b64_tr_b16 v[32:33], v100 offset:192
    v_mfma_f32_16x16x32_bf16 v[200:203], v[68:71], v[88:91], v[200:203]
    ds_read_b64_tr_b16 v[34:35], v100 offset:1984
    v_mfma_f32_16x16x32_bf16 v[204:207], v[68:71], v[92:95], v[204:207]
    v_mfma_f32_16x16x32_bf16 v[220:223], v[72:75], v[92:95], v[220:223]
    v_mfma_f32_16x16x32_bf16 v[216:219], v[72:75], v[88:91], v[216:219]
    v_mfma_f32_16x16x32_bf16 v[212:215], v[72:75], v[84:87], v[212:215]
    v_mfma_f32_16x16x32_bf16 v[208:211], v[72:75], v[80:83], v[208:211]
    v_mfma_f32_16x16x32_bf16 v[224:227], v[76:79], v[80:83], v[224:227]
    v_mfma_f32_16x16x32_bf16 v[228:231], v[76:79], v[84:87], v[228:231]
    v_mfma_f32_16x16x32_bf16 v[232:235], v[76:79], v[88:91], v[232:235]
    v_mfma_f32_16x16x32_bf16 v[236:239], v[76:79], v[92:95], v[236:239]
    s_sub_u32 s30, s30, 1
    s_cmp_lg_u32 s30, 0
    s_nop 0
    s_cbranch_scc1 L_w1c_18
    s_waitcnt lgkmcnt(0)
    s_nop 0
    v_mfma_f32_16x16x32_bf16 v[128:131], v[8:11], v[36:39], v[128:131]
    ds_read_b128 v[80:83], v96 offset:8192
    v_mfma_f32_16x16x32_bf16 v[132:135], v[8:11], v[40:43], v[132:135]
    ds_read_b64_tr_b16 v[52:53], v100 offset:14336
    v_mfma_f32_16x16x32_bf16 v[136:139], v[8:11], v[44:47], v[136:139]
    ds_read_b64_tr_b16 v[54:55], v100 offset:16128
    v_mfma_f32_16x16x32_bf16 v[140:143], v[8:11], v[48:51], v[140:143]
    ds_read_b128 v[84:87], v96 offset:8448
    v_mfma_f32_16x16x32_bf16 v[156:159], v[12:15], v[48:51], v[156:159]
    ds_read_b128 v[88:91], v96 offset:8704
    v_mfma_f32_16x16x32_bf16 v[152:155], v[12:15], v[44:47], v[152:155]
    ds_read_b128 v[92:95], v96 offset:8960
    v_mfma_f32_16x16x32_bf16 v[148:151], v[12:15], v[40:43], v[148:151]
    ds_read_b64_tr_b16 v[56:57], v101 offset:14368
    v_mfma_f32_16x16x32_bf16 v[144:147], v[12:15], v[36:39], v[144:147]
    ds_read_b64_tr_b16 v[58:59], v101 offset:16160
    v_mfma_f32_16x16x32_bf16 v[160:163], v[16:19], v[36:39], v[160:163]
    ds_read_b64_tr_b16 v[60:61], v100 offset:14400
    v_mfma_f32_16x16x32_bf16 v[164:167], v[16:19], v[40:43], v[164:167]
    v_mfma_f32_16x16x32_bf16 v[168:171], v[16:19], v[44:47], v[168:171]
    ds_read_b64_tr_b16 v[62:63], v100 offset:16192
    v_mfma_f32_16x16x32_bf16 v[172:175], v[16:19], v[48:51], v[172:175]
    ds_read_b64_tr_b16 v[64:65], v101 offset:14432
    v_mfma_f32_16x16x32_bf16 v[188:191], v[20:23], v[48:51], v[188:191]
    ds_read_b64_tr_b16 v[66:67], v101 offset:16224
    v_mfma_f32_16x16x32_bf16 v[184:187], v[20:23], v[44:47], v[184:187]
    ds_read_b64_tr_b16 v[68:69], v100 offset:14464
    v_mfma_f32_16x16x32_bf16 v[180:183], v[20:23], v[40:43], v[180:183]
    ds_read_b64_tr_b16 v[70:71], v100 offset:16256
    v_mfma_f32_16x16x32_bf16 v[176:179], v[20:23], v[36:39], v[176:179]
    ds_read_b64_tr_b16 v[72:73], v101 offset:14496
    v_mfma_f32_16x16x32_bf16 v[192:195], v[24:27], v[36:39], v[192:195]
    ds_read_b64_tr_b16 v[74:75], v101 offset:16288
    v_mfma_f32_16x16x32_bf16 v[196:199], v[24:27], v[40:43], v[196:199]
    ds_read_b64_tr_b16 v[76:77], v100 offset:14528
    v_mfma_f32_16x16x32_bf16 v[200:203], v[24:27], v[44:47], v[200:203]
    ds_read_b64_tr_b16 v[78:79], v100 offset:16320
    v_mfma_f32_16x16x32_bf16 v[204:207], v[24:27], v[48:51], v[204:207]
    v_mfma_f32_16x16x32_bf16 v[220:223], v[28:31], v[48:51], v[220:223]
    v_mfma_f32_16x16x32_bf16 v[216:219], v[28:31], v[44:47], v[216:219]
    v_mfma_f32_16x16x32_bf16 v[212:215], v[28:31], v[40:43], v[212:215]
    v_mfma_f32_16x16x32_bf16 v[208:211], v[28:31], v[36:39], v[208:211]
    v_mfma_f32_16x16x32_bf16 v[224:227], v[32:35], v[36:39], v[224:227]
    v_mfma_f32_16x16x32_bf16 v[228:231], v[32:35], v[40:43], v[228:231]
    v_mfma_f32_16x16x32_bf16 v[232:235], v[32:35], v[44:47], v[232:235]
    v_mfma_f32_16x16x32_bf16 v[236:239], v[32:35], v[48:51], v[236:239]
    s_waitcnt lgkmcnt(0)
    s_barrier
    v_mfma_f32_16x16x32_bf16 v[128:131], v[52:55], v[80:83], v[128:131]
    ds_read_b128 v[36:39], v96 offset:16384
    v_mfma_f32_16x16x32_bf16 v[132:135], v[52:55], v[84:87], v[132:135]
    ds_read_b64_tr_b16 v[8:9], v100 offset:28672
    v_mfma_f32_16x16x32_bf16 v[136:139], v[52:55], v[88:91], v[136:139]
    ds_read_b64_tr_b16 v[10:11], v100 offset:30464
    v_mfma_f32_16x16x32_bf16 v[140:143], v[52:55], v[92:95], v[140:143]
    ds_read_b128 v[40:43], v96 offset:16640
    v_mfma_f32_16x16x32_bf16 v[156:159], v[56:59], v[92:95], v[156:159]
    ds_read_b128 v[44:47], v96 offset:16896
    v_mfma_f32_16x16x32_bf16 v[152:155], v[56:59], v[88:91], v[152:155]
    ds_read_b128 v[48:51], v96 offset:17152
    v_mfma_f32_16x16x32_bf16 v[148:151], v[56:59], v[84:87], v[148:151]
    ds_read_b64_tr_b16 v[12:13], v101 offset:28704
    v_mfma_f32_16x16x32_bf16 v[144:147], v[56:59], v[80:83], v[144:147]
    ds_read_b64_tr_b16 v[14:15], v101 offset:30496
    v_mfma_f32_16x16x32_bf16 v[160:163], v[60:63], v[80:83], v[160:163]
    ds_read_b64_tr_b16 v[16:17], v100 offset:28736
    v_mfma_f32_16x16x32_bf16 v[164:167], v[60:63], v[84:87], v[164:167]
    v_mfma_f32_16x16x32_bf16 v[168:171], v[60:63], v[88:91], v[168:171]
    ds_read_b64_tr_b16 v[18:19], v100 offset:30528
    v_mfma_f32_16x16x32_bf16 v[172:175], v[60:63], v[92:95], v[172:175]
    ds_read_b64_tr_b16 v[20:21], v101 offset:28768
    v_mfma_f32_16x16x32_bf16 v[188:191], v[64:67], v[92:95], v[188:191]
    ds_read_b64_tr_b16 v[22:23], v101 offset:30560
    v_mfma_f32_16x16x32_bf16 v[184:187], v[64:67], v[88:91], v[184:187]
    ds_read_b64_tr_b16 v[24:25], v100 offset:28800
    v_mfma_f32_16x16x32_bf16 v[180:183], v[64:67], v[84:87], v[180:183]
    ds_read_b64_tr_b16 v[26:27], v100 offset:30592
    v_mfma_f32_16x16x32_bf16 v[176:179], v[64:67], v[80:83], v[176:179]
    ds_read_b64_tr_b16 v[28:29], v101 offset:28832
    v_mfma_f32_16x16x32_bf16 v[192:195], v[68:71], v[80:83], v[192:195]
    ds_read_b64_tr_b16 v[30:31], v101 offset:30624
    v_mfma_f32_16x16x32_bf16 v[196:199], v[68:71], v[84:87], v[196:199]
    ds_read_b64_tr_b16 v[32:33], v100 offset:28864
    v_mfma_f32_16x16x32_bf16 v[200:203], v[68:71], v[88:91], v[200:203]
    ds_read_b64_tr_b16 v[34:35], v100 offset:30656
    v_mfma_f32_16x16x32_bf16 v[204:207], v[68:71], v[92:95], v[204:207]
    v_mfma_f32_16x16x32_bf16 v[220:223], v[72:75], v[92:95], v[220:223]
    v_mfma_f32_16x16x32_bf16 v[216:219], v[72:75], v[88:91], v[216:219]
    v_mfma_f32_16x16x32_bf16 v[212:215], v[72:75], v[84:87], v[212:215]
    v_mfma_f32_16x16x32_bf16 v[208:211], v[72:75], v[80:83], v[208:211]
    v_mfma_f32_16x16x32_bf16 v[224:227], v[76:79], v[80:83], v[224:227]
    v_mfma_f32_16x16x32_bf16 v[228:231], v[76:79], v[84:87], v[228:231]
    v_mfma_f32_16x16x32_bf16 v[232:235], v[76:79], v[88:91], v[232:235]
    v_mfma_f32_16x16x32_bf16 v[236:239], v[76:79], v[92:95], v[236:239]
    s_waitcnt lgkmcnt(0)
    s_nop 0
    v_mfma_f32_16x16x32_bf16 v[128:131], v[8:11], v[36:39], v[128:131]
    ds_read_b128 v[80:83], v96 offset:24576
    v_mfma_f32_16x16x32_bf16 v[132:135], v[8:11], v[40:43], v[132:135]
    ds_read_b64_tr_b16 v[52:53], v100 offset:43008
    v_mfma_f32_16x16x32_bf16 v[136:139], v[8:11], v[44:47], v[136:139]
    ds_read_b64_tr_b16 v[54:55], v100 offset:44800
    v_mfma_f32_16x16x32_bf16 v[140:143], v[8:11], v[48:51], v[140:143]
    ds_read_b128 v[84:87], v96 offset:24832
    v_mfma_f32_16x16x32_bf16 v[156:159], v[12:15], v[48:51], v[156:159]
    ds_read_b128 v[88:91], v96 offset:25088
    v_mfma_f32_16x16x32_bf16 v[152:155], v[12:15], v[44:47], v[152:155]
    ds_read_b128 v[92:95], v96 offset:25344
    v_mfma_f32_16x16x32_bf16 v[148:151], v[12:15], v[40:43], v[148:151]
    ds_read_b64_tr_b16 v[56:57], v101 offset:43040
    v_mfma_f32_16x16x32_bf16 v[144:147], v[12:15], v[36:39], v[144:147]
    ds_read_b64_tr_b16 v[58:59], v101 offset:44832
    v_mfma_f32_16x16x32_bf16 v[160:163], v[16:19], v[36:39], v[160:163]
    ds_read_b64_tr_b16 v[60:61], v100 offset:43072
    v_mfma_f32_16x16x32_bf16 v[164:167], v[16:19], v[40:43], v[164:167]
    v_mfma_f32_16x16x32_bf16 v[168:171], v[16:19], v[44:47], v[168:171]
    ds_read_b64_tr_b16 v[62:63], v100 offset:44864
    v_mfma_f32_16x16x32_bf16 v[172:175], v[16:19], v[48:51], v[172:175]
    ds_read_b64_tr_b16 v[64:65], v101 offset:43104
    v_mfma_f32_16x16x32_bf16 v[188:191], v[20:23], v[48:51], v[188:191]
    ds_read_b64_tr_b16 v[66:67], v101 offset:44896
    v_mfma_f32_16x16x32_bf16 v[184:187], v[20:23], v[44:47], v[184:187]
    ds_read_b64_tr_b16 v[68:69], v100 offset:43136
    v_mfma_f32_16x16x32_bf16 v[180:183], v[20:23], v[40:43], v[180:183]
    ds_read_b64_tr_b16 v[70:71], v100 offset:44928
    v_mfma_f32_16x16x32_bf16 v[176:179], v[20:23], v[36:39], v[176:179]
    ds_read_b64_tr_b16 v[72:73], v101 offset:43168
    v_mfma_f32_16x16x32_bf16 v[192:195], v[24:27], v[36:39], v[192:195]
    ds_read_b64_tr_b16 v[74:75], v101 offset:44960
    v_mfma_f32_16x16x32_bf16 v[196:199], v[24:27], v[40:43], v[196:199]
    ds_read_b64_tr_b16 v[76:77], v100 offset:43200
    v_mfma_f32_16x16x32_bf16 v[200:203], v[24:27], v[44:47], v[200:203]
    ds_read_b64_tr_b16 v[78:79], v100 offset:44992
    v_mfma_f32_16x16x32_bf16 v[204:207], v[24:27], v[48:51], v[204:207]
    v_mfma_f32_16x16x32_bf16 v[220:223], v[28:31], v[48:51], v[220:223]
    v_mfma_f32_16x16x32_bf16 v[216:219], v[28:31], v[44:47], v[216:219]
    v_mfma_f32_16x16x32_bf16 v[212:215], v[28:31], v[40:43], v[212:215]
    v_mfma_f32_16x16x32_bf16 v[208:211], v[28:31], v[36:39], v[208:211]
    v_mfma_f32_16x16x32_bf16 v[224:227], v[32:35], v[36:39], v[224:227]
    v_mfma_f32_16x16x32_bf16 v[228:231], v[32:35], v[40:43], v[228:231]
    v_mfma_f32_16x16x32_bf16 v[232:235], v[32:35], v[44:47], v[232:235]
    v_mfma_f32_16x16x32_bf16 v[236:239], v[32:35], v[48:51], v[236:239]
    s_waitcnt lgkmcnt(0)
    s_barrier
    v_mfma_f32_16x16x32_bf16 v[128:131], v[52:55], v[80:83], v[128:131]
    v_mfma_f32_16x16x32_bf16 v[132:135], v[52:55], v[84:87], v[132:135]
    v_mfma_f32_16x16x32_bf16 v[136:139], v[52:55], v[88:91], v[136:139]
    v_mfma_f32_16x16x32_bf16 v[140:143], v[52:55], v[92:95], v[140:143]
    v_mfma_f32_16x16x32_bf16 v[156:159], v[56:59], v[92:95], v[156:159]
    v_mfma_f32_16x16x32_bf16 v[152:155], v[56:59], v[88:91], v[152:155]
    v_mfma_f32_16x16x32_bf16 v[148:151], v[56:59], v[84:87], v[148:151]
    v_mfma_f32_16x16x32_bf16 v[144:147], v[56:59], v[80:83], v[144:147]
    v_mfma_f32_16x16x32_bf16 v[160:163], v[60:63], v[80:83], v[160:163]
    v_mfma_f32_16x16x32_bf16 v[164:167], v[60:63], v[84:87], v[164:167]
    v_mfma_f32_16x16x32_bf16 v[168:171], v[60:63], v[88:91], v[168:171]
    v_mfma_f32_16x16x32_bf16 v[172:175], v[60:63], v[92:95], v[172:175]
    v_mfma_f32_16x16x32_bf16 v[188:191], v[64:67], v[92:95], v[188:191]
    v_mfma_f32_16x16x32_bf16 v[184:187], v[64:67], v[88:91], v[184:187]
    v_mfma_f32_16x16x32_bf16 v[180:183], v[64:67], v[84:87], v[180:183]
    v_mfma_f32_16x16x32_bf16 v[176:179], v[64:67], v[80:83], v[176:179]
    v_mfma_f32_16x16x32_bf16 v[192:195], v[68:71], v[80:83], v[192:195]
    v_mfma_f32_16x16x32_bf16 v[196:199], v[68:71], v[84:87], v[196:199]
    v_mfma_f32_16x16x32_bf16 v[200:203], v[68:71], v[88:91], v[200:203]
    v_mfma_f32_16x16x32_bf16 v[204:207], v[68:71], v[92:95], v[204:207]
    v_mfma_f32_16x16x32_bf16 v[220:223], v[72:75], v[92:95], v[220:223]
    v_mfma_f32_16x16x32_bf16 v[216:219], v[72:75], v[88:91], v[216:219]
    v_mfma_f32_16x16x32_bf16 v[212:215], v[72:75], v[84:87], v[212:215]
    v_mfma_f32_16x16x32_bf16 v[208:211], v[72:75], v[80:83], v[208:211]
    v_mfma_f32_16x16x32_bf16 v[224:227], v[76:79], v[80:83], v[224:227]
    v_mfma_f32_16x16x32_bf16 v[228:231], v[76:79], v[84:87], v[228:231]
    v_mfma_f32_16x16x32_bf16 v[232:235], v[76:79], v[88:91], v[232:235]
    v_mfma_f32_16x16x32_bf16 v[236:239], v[76:79], v[92:95], v[236:239]
    s_setprio 0
    s_waitcnt vmcnt(0)
    s_mov_b32 s50, 0xc0135761
    s_mov_b32 s51, 0xbdd2d3e8
    s_mov_b32 s52, 0xffff0000
    s_mul_i32 s38, s33, 28
    s_mul_i32 s39, s47, 14
    s_add_u32 s38, s38, s39
    s_lshl_b32 s38, s38, 14
    s_add_u32 s38, s38, s36
    s_lshl_b32 s39, s46, 10
    s_add_u32 s53, s38, s39
    v_and_b32 v5, 1, v3
    v_lshrrev_b32 v6, 1, v3
    v_lshlrev_b32 v7, 4, v4
    v_lshl_add_u32 v7, v6, 14, v7
    v_lshl_add_u32 v1, v5, 15, v7
    v_lshl_add_u32 v7, v5, 8, v7
    v_mov_b32 v30, s50
    v_mov_b32 v31, s50
    v_mov_b32 v28, s51
    v_mov_b32 v29, s51
    v_mov_b32 v26, 1.0
    v_mov_b32 v27, 1.0
    v_pk_mul_f32 v[16:17], v[128:129], v[128:129]
    v_pk_mul_f32 v[18:19], v[130:131], v[130:131]
    v_pk_mul_f32 v[60:61], v[144:145], v[144:145]
    v_pk_mul_f32 v[62:63], v[146:147], v[146:147]
    v_pk_fma_f32 v[16:17], v[16:17], v[28:29], v[30:31]
    v_pk_fma_f32 v[18:19], v[18:19], v[28:29], v[30:31]
    v_pk_fma_f32 v[60:61], v[60:61], v[28:29], v[30:31]
    v_pk_fma_f32 v[62:63], v[62:63], v[28:29], v[30:31]
    v_pk_mul_f32 v[16:17], v[16:17], v[128:129]
    v_pk_mul_f32 v[18:19], v[18:19], v[130:131]
    v_pk_mul_f32 v[60:61], v[60:61], v[144:145]
    v_pk_mul_f32 v[62:63], v[62:63], v[146:147]
    v_exp_f32 v16, v16
    v_exp_f32 v17, v17
    v_exp_f32 v18, v18
    v_exp_f32 v19, v19
    v_exp_f32 v60, v60
    v_exp_f32 v61, v61
    v_exp_f32 v62, v62
    v_exp_f32 v63, v63
    v_pk_add_f32 v[16:17], v[16:17], v[26:27]
    v_pk_add_f32 v[18:19], v[18:19], v[26:27]
    s_nop 0
    v_pk_add_f32 v[60:61], v[60:61], v[26:27]
    v_pk_add_f32 v[62:63], v[62:63], v[26:27]
    v_rcp_f32 v16, v16
    v_rcp_f32 v17, v17
    v_rcp_f32 v18, v18
    v_rcp_f32 v19, v19
    v_rcp_f32 v60, v60
    v_rcp_f32 v61, v61
    v_rcp_f32 v62, v62
    v_rcp_f32 v63, v63
    v_pk_mul_f32 v[16:17], v[16:17], v[128:129]
    v_pk_mul_f32 v[18:19], v[18:19], v[130:131]
    v_pk_mul_f32 v[60:61], v[60:61], v[144:145]
    v_pk_mul_f32 v[62:63], v[62:63], v[146:147]
    v_cvt_pk_bf16_f32 v40, v16, v17
    v_cvt_pk_bf16_f32 v41, v18, v19
    v_cvt_pk_bf16_f32 v42, v60, v61
    v_cvt_pk_bf16_f32 v43, v62, v63
    s_nop 1
    v_permlane16_swap_b32 v40, v42
    v_permlane16_swap_b32 v41, v43
    s_add_u32 s38, s53, 0
    buffer_store_dwordx4 v[40:43], v1, s[16:19], s38 offen offset:0 sc1
    v_pk_mul_f32 v[16:17], v[132:133], v[132:133]
    v_pk_mul_f32 v[18:19], v[134:135], v[134:135]
    v_pk_mul_f32 v[60:61], v[148:149], v[148:149]
    v_pk_mul_f32 v[62:63], v[150:151], v[150:151]
    v_pk_fma_f32 v[16:17], v[16:17], v[28:29], v[30:31]
    v_pk_fma_f32 v[18:19], v[18:19], v[28:29], v[30:31]
    v_pk_fma_f32 v[60:61], v[60:61], v[28:29], v[30:31]
    v_pk_fma_f32 v[62:63], v[62:63], v[28:29], v[30:31]
    v_pk_mul_f32 v[16:17], v[16:17], v[132:133]
    v_pk_mul_f32 v[18:19], v[18:19], v[134:135]
    v_pk_mul_f32 v[60:61], v[60:61], v[148:149]
    v_pk_mul_f32 v[62:63], v[62:63], v[150:151]
    v_exp_f32 v16, v16
    v_exp_f32 v17, v17
    v_exp_f32 v18, v18
    v_exp_f32 v19, v19
    v_exp_f32 v60, v60
    v_exp_f32 v61, v61
    v_exp_f32 v62, v62
    v_exp_f32 v63, v63
    v_pk_add_f32 v[16:17], v[16:17], v[26:27]
    v_pk_add_f32 v[18:19], v[18:19], v[26:27]
    s_nop 0
    v_pk_add_f32 v[60:61], v[60:61], v[26:27]
    v_pk_add_f32 v[62:63], v[62:63], v[26:27]
    v_rcp_f32 v16, v16
    v_rcp_f32 v17, v17
    v_rcp_f32 v18, v18
    v_rcp_f32 v19, v19
    v_rcp_f32 v60, v60
    v_rcp_f32 v61, v61
    v_rcp_f32 v62, v62
    v_rcp_f32 v63, v63
    v_pk_mul_f32 v[16:17], v[16:17], v[132:133]
    v_pk_mul_f32 v[18:19], v[18:19], v[134:135]
    v_pk_mul_f32 v[60:61], v[60:61], v[148:149]
    v_pk_mul_f32 v[62:63], v[62:63], v[150:151]
    v_cvt_pk_bf16_f32 v44, v16, v17
    v_cvt_pk_bf16_f32 v45, v18, v19
    v_cvt_pk_bf16_f32 v46, v60, v61
    v_cvt_pk_bf16_f32 v47, v62, v63
    s_nop 1
    v_permlane16_swap_b32 v44, v46
    v_permlane16_swap_b32 v45, v47
    s_add_u32 s38, s53, 0
    buffer_store_dwordx4 v[44:47], v1, s[16:19], s38 offen offset:256 sc1
    v_pk_mul_f32 v[16:17], v[136:137], v[136:137]
    v_pk_mul_f32 v[18:19], v[138:139], v[138:139]
    v_pk_mul_f32 v[60:61], v[152:153], v[152:153]
    v_pk_mul_f32 v[62:63], v[154:155], v[154:155]
    v_pk_fma_f32 v[16:17], v[16:17], v[28:29], v[30:31]
    v_pk_fma_f32 v[18:19], v[18:19], v[28:29], v[30:31]
    v_pk_fma_f32 v[60:61], v[60:61], v[28:29], v[30:31]
    v_pk_fma_f32 v[62:63], v[62:63], v[28:29], v[30:31]
    v_pk_mul_f32 v[16:17], v[16:17], v[136:137]
    v_pk_mul_f32 v[18:19], v[18:19], v[138:139]
    v_pk_mul_f32 v[60:61], v[60:61], v[152:153]
    v_pk_mul_f32 v[62:63], v[62:63], v[154:155]
    v_exp_f32 v16, v16
    v_exp_f32 v17, v17
    v_exp_f32 v18, v18
    v_exp_f32 v19, v19
    v_exp_f32 v60, v60
    v_exp_f32 v61, v61
    v_exp_f32 v62, v62
    v_exp_f32 v63, v63
    v_pk_add_f32 v[16:17], v[16:17], v[26:27]
    v_pk_add_f32 v[18:19], v[18:19], v[26:27]
    s_nop 0
    v_pk_add_f32 v[60:61], v[60:61], v[26:27]
    v_pk_add_f32 v[62:63], v[62:63], v[26:27]
    v_rcp_f32 v16, v16
    v_rcp_f32 v17, v17
    v_rcp_f32 v18, v18
    v_rcp_f32 v19, v19
    v_rcp_f32 v60, v60
    v_rcp_f32 v61, v61
    v_rcp_f32 v62, v62
    v_rcp_f32 v63, v63
    v_pk_mul_f32 v[16:17], v[16:17], v[136:137]
    v_pk_mul_f32 v[18:19], v[18:19], v[138:139]
    v_pk_mul_f32 v[60:61], v[60:61], v[152:153]
    v_pk_mul_f32 v[62:63], v[62:63], v[154:155]
    v_cvt_pk_bf16_f32 v48, v16, v17
    v_cvt_pk_bf16_f32 v49, v18, v19
    v_cvt_pk_bf16_f32 v50, v60, v61
    v_cvt_pk_bf16_f32 v51, v62, v63
    s_nop 1
    v_permlane16_swap_b32 v48, v50
    v_permlane16_swap_b32 v49, v51
    s_add_u32 s38, s53, 0
    buffer_store_dwordx4 v[48:51], v1, s[16:19], s38 offen offset:512 sc1
    v_pk_mul_f32 v[16:17], v[140:141], v[140:141]
    v_pk_mul_f32 v[18:19], v[142:143], v[142:143]
    v_pk_mul_f32 v[60:61], v[156:157], v[156:157]
    v_pk_mul_f32 v[62:63], v[158:159], v[158:159]
    v_pk_fma_f32 v[16:17], v[16:17], v[28:29], v[30:31]
    v_pk_fma_f32 v[18:19], v[18:19], v[28:29], v[30:31]
    v_pk_fma_f32 v[60:61], v[60:61], v[28:29], v[30:31]
    v_pk_fma_f32 v[62:63], v[62:63], v[28:29], v[30:31]
    v_pk_mul_f32 v[16:17], v[16:17], v[140:141]
    v_pk_mul_f32 v[18:19], v[18:19], v[142:143]
    v_pk_mul_f32 v[60:61], v[60:61], v[156:157]
    v_pk_mul_f32 v[62:63], v[62:63], v[158:159]
    v_exp_f32 v16, v16
    v_exp_f32 v17, v17
    v_exp_f32 v18, v18
    v_exp_f32 v19, v19
    v_exp_f32 v60, v60
    v_exp_f32 v61, v61
    v_exp_f32 v62, v62
    v_exp_f32 v63, v63
    v_pk_add_f32 v[16:17], v[16:17], v[26:27]
    v_pk_add_f32 v[18:19], v[18:19], v[26:27]
    s_nop 0
    v_pk_add_f32 v[60:61], v[60:61], v[26:27]
    v_pk_add_f32 v[62:63], v[62:63], v[26:27]
    v_rcp_f32 v16, v16
    v_rcp_f32 v17, v17
    v_rcp_f32 v18, v18
    v_rcp_f32 v19, v19
    v_rcp_f32 v60, v60
    v_rcp_f32 v61, v61
    v_rcp_f32 v62, v62
    v_rcp_f32 v63, v63
    v_pk_mul_f32 v[16:17], v[16:17], v[140:141]
    v_pk_mul_f32 v[18:19], v[18:19], v[142:143]
    v_pk_mul_f32 v[60:61], v[60:61], v[156:157]
    v_pk_mul_f32 v[62:63], v[62:63], v[158:159]
    v_cvt_pk_bf16_f32 v52, v16, v17
    v_cvt_pk_bf16_f32 v53, v18, v19
    v_cvt_pk_bf16_f32 v54, v60, v61
    v_cvt_pk_bf16_f32 v55, v62, v63
    s_nop 1
    v_permlane16_swap_b32 v52, v54
    v_permlane16_swap_b32 v53, v55
    s_add_u32 s38, s53, 0
    buffer_store_dwordx4 v[52:55], v1, s[16:19], s38 offen offset:768 sc1
    v_pk_mul_f32 v[16:17], v[160:161], v[160:161]
    v_pk_mul_f32 v[18:19], v[162:163], v[162:163]
    v_pk_mul_f32 v[60:61], v[176:177], v[176:177]
    v_pk_mul_f32 v[62:63], v[178:179], v[178:179]
    v_pk_fma_f32 v[16:17], v[16:17], v[28:29], v[30:31]
    v_pk_fma_f32 v[18:19], v[18:19], v[28:29], v[30:31]
    v_pk_fma_f32 v[60:61], v[60:61], v[28:29], v[30:31]
    v_pk_fma_f32 v[62:63], v[62:63], v[28:29], v[30:31]
    v_pk_mul_f32 v[16:17], v[16:17], v[160:161]
    v_pk_mul_f32 v[18:19], v[18:19], v[162:163]
    v_pk_mul_f32 v[60:61], v[60:61], v[176:177]
    v_pk_mul_f32 v[62:63], v[62:63], v[178:179]
    v_exp_f32 v16, v16
    v_exp_f32 v17, v17
    v_exp_f32 v18, v18
    v_exp_f32 v19, v19
    v_exp_f32 v60, v60
    v_exp_f32 v61, v61
    v_exp_f32 v62, v62
    v_exp_f32 v63, v63
    v_pk_add_f32 v[16:17], v[16:17], v[26:27]
    v_pk_add_f32 v[18:19], v[18:19], v[26:27]
    s_nop 0
    v_pk_add_f32 v[60:61], v[60:61], v[26:27]
    v_pk_add_f32 v[62:63], v[62:63], v[26:27]
    v_rcp_f32 v16, v16
    v_rcp_f32 v17, v17
    v_rcp_f32 v18, v18
    v_rcp_f32 v19, v19
    v_rcp_f32 v60, v60
    v_rcp_f32 v61, v61
    v_rcp_f32 v62, v62
    v_rcp_f32 v63, v63
    v_pk_mul_f32 v[16:17], v[16:17], v[160:161]
    v_pk_mul_f32 v[18:19], v[18:19], v[162:163]
    v_pk_mul_f32 v[60:61], v[60:61], v[176:177]
    v_pk_mul_f32 v[62:63], v[62:63], v[178:179]
    v_cvt_pk_bf16_f32 v40, v16, v17
    v_cvt_pk_bf16_f32 v41, v18, v19
    v_cvt_pk_bf16_f32 v42, v60, v61
    v_cvt_pk_bf16_f32 v43, v62, v63
    s_nop 1
    v_permlane16_swap_b32 v40, v42
    v_permlane16_swap_b32 v41, v43
    s_add_u32 s38, s53, 65536
    buffer_store_dwordx4 v[40:43], v1, s[16:19], s38 offen offset:0 sc1
    v_pk_mul_f32 v[16:17], v[164:165], v[164:165]
    v_pk_mul_f32 v[18:19], v[166:167], v[166:167]
    v_pk_mul_f32 v[60:61], v[180:181], v[180:181]
    v_pk_mul_f32 v[62:63], v[182:183], v[182:183]
    v_pk_fma_f32 v[16:17], v[16:17], v[28:29], v[30:31]
    v_pk_fma_f32 v[18:19], v[18:19], v[28:29], v[30:31]
    v_pk_fma_f32 v[60:61], v[60:61], v[28:29], v[30:31]
    v_pk_fma_f32 v[62:63], v[62:63], v[28:29], v[30:31]
    v_pk_mul_f32 v[16:17], v[16:17], v[164:165]
    v_pk_mul_f32 v[18:19], v[18:19], v[166:167]
    v_pk_mul_f32 v[60:61], v[60:61], v[180:181]
    v_pk_mul_f32 v[62:63], v[62:63], v[182:183]
    v_exp_f32 v16, v16
    v_exp_f32 v17, v17
    v_exp_f32 v18, v18
    v_exp_f32 v19, v19
    v_exp_f32 v60, v60
    v_exp_f32 v61, v61
    v_exp_f32 v62, v62
    v_exp_f32 v63, v63
    v_pk_add_f32 v[16:17], v[16:17], v[26:27]
    v_pk_add_f32 v[18:19], v[18:19], v[26:27]
    s_nop 0
    v_pk_add_f32 v[60:61], v[60:61], v[26:27]
    v_pk_add_f32 v[62:63], v[62:63], v[26:27]
    v_rcp_f32 v16, v16
    v_rcp_f32 v17, v17
    v_rcp_f32 v18, v18
    v_rcp_f32 v19, v19
    v_rcp_f32 v60, v60
    v_rcp_f32 v61, v61
    v_rcp_f32 v62, v62
    v_rcp_f32 v63, v63
    v_pk_mul_f32 v[16:17], v[16:17], v[164:165]
    v_pk_mul_f32 v[18:19], v[18:19], v[166:167]
    v_pk_mul_f32 v[60:61], v[60:61], v[180:181]
    v_pk_mul_f32 v[62:63], v[62:63], v[182:183]
    v_cvt_pk_bf16_f32 v44, v16, v17
    v_cvt_pk_bf16_f32 v45, v18, v19
    v_cvt_pk_bf16_f32 v46, v60, v61
    v_cvt_pk_bf16_f32 v47, v62, v63
    s_nop 1
    v_permlane16_swap_b32 v44, v46
    v_permlane16_swap_b32 v45, v47
    s_add_u32 s38, s53, 65536
    buffer_store_dwordx4 v[44:47], v1, s[16:19], s38 offen offset:256 sc1
    v_pk_mul_f32 v[16:17], v[168:169], v[168:169]
    v_pk_mul_f32 v[18:19], v[170:171], v[170:171]
    v_pk_mul_f32 v[60:61], v[184:185], v[184:185]
    v_pk_mul_f32 v[62:63], v[186:187], v[186:187]
    v_pk_fma_f32 v[16:17], v[16:17], v[28:29], v[30:31]
    v_pk_fma_f32 v[18:19], v[18:19], v[28:29], v[30:31]
    v_pk_fma_f32 v[60:61], v[60:61], v[28:29], v[30:31]
    v_pk_fma_f32 v[62:63], v[62:63], v[28:29], v[30:31]
    v_pk_mul_f32 v[16:17], v[16:17], v[168:169]
    v_pk_mul_f32 v[18:19], v[18:19], v[170:171]
    v_pk_mul_f32 v[60:61], v[60:61], v[184:185]
    v_pk_mul_f32 v[62:63], v[62:63], v[186:187]
    v_exp_f32 v16, v16
    v_exp_f32 v17, v17
    v_exp_f32 v18, v18
    v_exp_f32 v19, v19
    v_exp_f32 v60, v60
    v_exp_f32 v61, v61
    v_exp_f32 v62, v62
    v_exp_f32 v63, v63
    v_pk_add_f32 v[16:17], v[16:17], v[26:27]
    v_pk_add_f32 v[18:19], v[18:19], v[26:27]
    s_nop 0
    v_pk_add_f32 v[60:61], v[60:61], v[26:27]
    v_pk_add_f32 v[62:63], v[62:63], v[26:27]
    v_rcp_f32 v16, v16
    v_rcp_f32 v17, v17
    v_rcp_f32 v18, v18
    v_rcp_f32 v19, v19
    v_rcp_f32 v60, v60
    v_rcp_f32 v61, v61
    v_rcp_f32 v62, v62
    v_rcp_f32 v63, v63
    v_pk_mul_f32 v[16:17], v[16:17], v[168:169]
    v_pk_mul_f32 v[18:19], v[18:19], v[170:171]
    v_pk_mul_f32 v[60:61], v[60:61], v[184:185]
    v_pk_mul_f32 v[62:63], v[62:63], v[186:187]
    v_cvt_pk_bf16_f32 v48, v16, v17
    v_cvt_pk_bf16_f32 v49, v18, v19
    v_cvt_pk_bf16_f32 v50, v60, v61
    v_cvt_pk_bf16_f32 v51, v62, v63
    s_nop 1
    v_permlane16_swap_b32 v48, v50
    v_permlane16_swap_b32 v49, v51
    s_add_u32 s38, s53, 65536
    buffer_store_dwordx4 v[48:51], v1, s[16:19], s38 offen offset:512 sc1
    v_pk_mul_f32 v[16:17], v[172:173], v[172:173]
    v_pk_mul_f32 v[18:19], v[174:175], v[174:175]
    v_pk_mul_f32 v[60:61], v[188:189], v[188:189]
    v_pk_mul_f32 v[62:63], v[190:191], v[190:191]
    v_pk_fma_f32 v[16:17], v[16:17], v[28:29], v[30:31]
    v_pk_fma_f32 v[18:19], v[18:19], v[28:29], v[30:31]
    v_pk_fma_f32 v[60:61], v[60:61], v[28:29], v[30:31]
    v_pk_fma_f32 v[62:63], v[62:63], v[28:29], v[30:31]
    v_pk_mul_f32 v[16:17], v[16:17], v[172:173]
    v_pk_mul_f32 v[18:19], v[18:19], v[174:175]
    v_pk_mul_f32 v[60:61], v[60:61], v[188:189]
    v_pk_mul_f32 v[62:63], v[62:63], v[190:191]
    v_exp_f32 v16, v16
    v_exp_f32 v17, v17
    v_exp_f32 v18, v18
    v_exp_f32 v19, v19
    v_exp_f32 v60, v60
    v_exp_f32 v61, v61
    v_exp_f32 v62, v62
    v_exp_f32 v63, v63
    v_pk_add_f32 v[16:17], v[16:17], v[26:27]
    v_pk_add_f32 v[18:19], v[18:19], v[26:27]
    s_nop 0
    v_pk_add_f32 v[60:61], v[60:61], v[26:27]
    v_pk_add_f32 v[62:63], v[62:63], v[26:27]
    v_rcp_f32 v16, v16
    v_rcp_f32 v17, v17
    v_rcp_f32 v18, v18
    v_rcp_f32 v19, v19
    v_rcp_f32 v60, v60
    v_rcp_f32 v61, v61
    v_rcp_f32 v62, v62
    v_rcp_f32 v63, v63
    v_pk_mul_f32 v[16:17], v[16:17], v[172:173]
    v_pk_mul_f32 v[18:19], v[18:19], v[174:175]
    v_pk_mul_f32 v[60:61], v[60:61], v[188:189]
    v_pk_mul_f32 v[62:63], v[62:63], v[190:191]
    v_cvt_pk_bf16_f32 v52, v16, v17
    v_cvt_pk_bf16_f32 v53, v18, v19
    v_cvt_pk_bf16_f32 v54, v60, v61
    v_cvt_pk_bf16_f32 v55, v62, v63
    s_nop 1
    v_permlane16_swap_b32 v52, v54
    v_permlane16_swap_b32 v53, v55
    s_add_u32 s38, s53, 65536
    buffer_store_dwordx4 v[52:55], v1, s[16:19], s38 offen offset:768 sc1
    v_pk_mul_f32 v[16:17], v[192:193], v[192:193]
    v_pk_mul_f32 v[18:19], v[194:195], v[194:195]
    v_pk_mul_f32 v[60:61], v[208:209], v[208:209]
    v_pk_mul_f32 v[62:63], v[210:211], v[210:211]
    v_pk_fma_f32 v[16:17], v[16:17], v[28:29], v[30:31]
    v_pk_fma_f32 v[18:19], v[18:19], v[28:29], v[30:31]
    v_pk_fma_f32 v[60:61], v[60:61], v[28:29], v[30:31]
    v_pk_fma_f32 v[62:63], v[62:63], v[28:29], v[30:31]
    v_pk_mul_f32 v[16:17], v[16:17], v[192:193]
    v_pk_mul_f32 v[18:19], v[18:19], v[194:195]
    v_pk_mul_f32 v[60:61], v[60:61], v[208:209]
    v_pk_mul_f32 v[62:63], v[62:63], v[210:211]
    v_exp_f32 v16, v16
    v_exp_f32 v17, v17
    v_exp_f32 v18, v18
    v_exp_f32 v19, v19
    v_exp_f32 v60, v60
    v_exp_f32 v61, v61
    v_exp_f32 v62, v62
    v_exp_f32 v63, v63
    v_pk_add_f32 v[16:17], v[16:17], v[26:27]
    v_pk_add_f32 v[18:19], v[18:19], v[26:27]
    s_nop 0
    v_pk_add_f32 v[60:61], v[60:61], v[26:27]
    v_pk_add_f32 v[62:63], v[62:63], v[26:27]
    v_rcp_f32 v16, v16
    v_rcp_f32 v17, v17
    v_rcp_f32 v18, v18
    v_rcp_f32 v19, v19
    v_rcp_f32 v60, v60
    v_rcp_f32 v61, v61
    v_rcp_f32 v62, v62
    v_rcp_f32 v63, v63
    v_pk_mul_f32 v[16:17], v[16:17], v[192:193]
    v_pk_mul_f32 v[18:19], v[18:19], v[194:195]
    v_pk_mul_f32 v[60:61], v[60:61], v[208:209]
    v_pk_mul_f32 v[62:63], v[62:63], v[210:211]
    v_cvt_pk_bf16_f32 v40, v16, v17
    v_cvt_pk_bf16_f32 v41, v18, v19
    v_cvt_pk_bf16_f32 v42, v60, v61
    v_cvt_pk_bf16_f32 v43, v62, v63
    s_nop 1
    v_permlane16_swap_b32 v40, v42
    v_permlane16_swap_b32 v41, v43
    s_add_u32 s38, s53, 131072
    buffer_store_dwordx4 v[40:43], v1, s[16:19], s38 offen offset:0 sc1
    v_pk_mul_f32 v[16:17], v[196:197], v[196:197]
    v_pk_mul_f32 v[18:19], v[198:199], v[198:199]
    v_pk_mul_f32 v[60:61], v[212:213], v[212:213]
    v_pk_mul_f32 v[62:63], v[214:215], v[214:215]
    v_pk_fma_f32 v[16:17], v[16:17], v[28:29], v[30:31]
    v_pk_fma_f32 v[18:19], v[18:19], v[28:29], v[30:31]
    v_pk_fma_f32 v[60:61], v[60:61], v[28:29], v[30:31]
    v_pk_fma_f32 v[62:63], v[62:63], v[28:29], v[30:31]
    v_pk_mul_f32 v[16:17], v[16:17], v[196:197]
    v_pk_mul_f32 v[18:19], v[18:19], v[198:199]
    v_pk_mul_f32 v[60:61], v[60:61], v[212:213]
    v_pk_mul_f32 v[62:63], v[62:63], v[214:215]
    v_exp_f32 v16, v16
    v_exp_f32 v17, v17
    v_exp_f32 v18, v18
    v_exp_f32 v19, v19
    v_exp_f32 v60, v60
    v_exp_f32 v61, v61
    v_exp_f32 v62, v62
    v_exp_f32 v63, v63
    v_pk_add_f32 v[16:17], v[16:17], v[26:27]
    v_pk_add_f32 v[18:19], v[18:19], v[26:27]
    s_nop 0
    v_pk_add_f32 v[60:61], v[60:61], v[26:27]
    v_pk_add_f32 v[62:63], v[62:63], v[26:27]
    v_rcp_f32 v16, v16
    v_rcp_f32 v17, v17
    v_rcp_f32 v18, v18
    v_rcp_f32 v19, v19
    v_rcp_f32 v60, v60
    v_rcp_f32 v61, v61
    v_rcp_f32 v62, v62
    v_rcp_f32 v63, v63
    v_pk_mul_f32 v[16:17], v[16:17], v[196:197]
    v_pk_mul_f32 v[18:19], v[18:19], v[198:199]
    v_pk_mul_f32 v[60:61], v[60:61], v[212:213]
    v_pk_mul_f32 v[62:63], v[62:63], v[214:215]
    v_cvt_pk_bf16_f32 v44, v16, v17
    v_cvt_pk_bf16_f32 v45, v18, v19
    v_cvt_pk_bf16_f32 v46, v60, v61
    v_cvt_pk_bf16_f32 v47, v62, v63
    s_nop 1
    v_permlane16_swap_b32 v44, v46
    v_permlane16_swap_b32 v45, v47
    s_add_u32 s38, s53, 131072
    buffer_store_dwordx4 v[44:47], v1, s[16:19], s38 offen offset:256 sc1
    v_pk_mul_f32 v[16:17], v[200:201], v[200:201]
    v_pk_mul_f32 v[18:19], v[202:203], v[202:203]
    v_pk_mul_f32 v[60:61], v[216:217], v[216:217]
    v_pk_mul_f32 v[62:63], v[218:219], v[218:219]
    v_pk_fma_f32 v[16:17], v[16:17], v[28:29], v[30:31]
    v_pk_fma_f32 v[18:19], v[18:19], v[28:29], v[30:31]
    v_pk_fma_f32 v[60:61], v[60:61], v[28:29], v[30:31]
    v_pk_fma_f32 v[62:63], v[62:63], v[28:29], v[30:31]
    v_pk_mul_f32 v[16:17], v[16:17], v[200:201]
    v_pk_mul_f32 v[18:19], v[18:19], v[202:203]
    v_pk_mul_f32 v[60:61], v[60:61], v[216:217]
    v_pk_mul_f32 v[62:63], v[62:63], v[218:219]
    v_exp_f32 v16, v16
    v_exp_f32 v17, v17
    v_exp_f32 v18, v18
    v_exp_f32 v19, v19
    v_exp_f32 v60, v60
    v_exp_f32 v61, v61
    v_exp_f32 v62, v62
    v_exp_f32 v63, v63
    v_pk_add_f32 v[16:17], v[16:17], v[26:27]
    v_pk_add_f32 v[18:19], v[18:19], v[26:27]
    s_nop 0
    v_pk_add_f32 v[60:61], v[60:61], v[26:27]
    v_pk_add_f32 v[62:63], v[62:63], v[26:27]
    v_rcp_f32 v16, v16
    v_rcp_f32 v17, v17
    v_rcp_f32 v18, v18
    v_rcp_f32 v19, v19
    v_rcp_f32 v60, v60
    v_rcp_f32 v61, v61
    v_rcp_f32 v62, v62
    v_rcp_f32 v63, v63
    v_pk_mul_f32 v[16:17], v[16:17], v[200:201]
    v_pk_mul_f32 v[18:19], v[18:19], v[202:203]
    v_pk_mul_f32 v[60:61], v[60:61], v[216:217]
    v_pk_mul_f32 v[62:63], v[62:63], v[218:219]
    v_cvt_pk_bf16_f32 v48, v16, v17
    v_cvt_pk_bf16_f32 v49, v18, v19
    v_cvt_pk_bf16_f32 v50, v60, v61
    v_cvt_pk_bf16_f32 v51, v62, v63
    s_nop 1
    v_permlane16_swap_b32 v48, v50
    v_permlane16_swap_b32 v49, v51
    s_add_u32 s38, s53, 131072
    buffer_store_dwordx4 v[48:51], v1, s[16:19], s38 offen offset:512 sc1
    v_pk_mul_f32 v[16:17], v[204:205], v[204:205]
    v_pk_mul_f32 v[18:19], v[206:207], v[206:207]
    v_pk_mul_f32 v[60:61], v[220:221], v[220:221]
    v_pk_mul_f32 v[62:63], v[222:223], v[222:223]
    v_pk_fma_f32 v[16:17], v[16:17], v[28:29], v[30:31]
    v_pk_fma_f32 v[18:19], v[18:19], v[28:29], v[30:31]
    v_pk_fma_f32 v[60:61], v[60:61], v[28:29], v[30:31]
    v_pk_fma_f32 v[62:63], v[62:63], v[28:29], v[30:31]
    v_pk_mul_f32 v[16:17], v[16:17], v[204:205]
    v_pk_mul_f32 v[18:19], v[18:19], v[206:207]
    v_pk_mul_f32 v[60:61], v[60:61], v[220:221]
    v_pk_mul_f32 v[62:63], v[62:63], v[222:223]
    v_exp_f32 v16, v16
    v_exp_f32 v17, v17
    v_exp_f32 v18, v18
    v_exp_f32 v19, v19
    v_exp_f32 v60, v60
    v_exp_f32 v61, v61
    v_exp_f32 v62, v62
    v_exp_f32 v63, v63
    v_pk_add_f32 v[16:17], v[16:17], v[26:27]
    v_pk_add_f32 v[18:19], v[18:19], v[26:27]
    s_nop 0
    v_pk_add_f32 v[60:61], v[60:61], v[26:27]
    v_pk_add_f32 v[62:63], v[62:63], v[26:27]
    v_rcp_f32 v16, v16
    v_rcp_f32 v17, v17
    v_rcp_f32 v18, v18
    v_rcp_f32 v19, v19
    v_rcp_f32 v60, v60
    v_rcp_f32 v61, v61
    v_rcp_f32 v62, v62
    v_rcp_f32 v63, v63
    v_pk_mul_f32 v[16:17], v[16:17], v[204:205]
    v_pk_mul_f32 v[18:19], v[18:19], v[206:207]
    v_pk_mul_f32 v[60:61], v[60:61], v[220:221]
    v_pk_mul_f32 v[62:63], v[62:63], v[222:223]
    v_cvt_pk_bf16_f32 v52, v16, v17
    v_cvt_pk_bf16_f32 v53, v18, v19
    v_cvt_pk_bf16_f32 v54, v60, v61
    v_cvt_pk_bf16_f32 v55, v62, v63
    s_nop 1
    v_permlane16_swap_b32 v52, v54
    v_permlane16_swap_b32 v53, v55
    s_add_u32 s38, s53, 131072
    buffer_store_dwordx4 v[52:55], v1, s[16:19], s38 offen offset:768 sc1
    v_pk_mul_f32 v[16:17], v[224:225], v[224:225]
    v_pk_mul_f32 v[18:19], v[226:227], v[226:227]
    v_pk_mul_f32 v[60:61], v[228:229], v[228:229]
    v_pk_mul_f32 v[62:63], v[230:231], v[230:231]
    v_pk_fma_f32 v[16:17], v[16:17], v[28:29], v[30:31]
    v_pk_fma_f32 v[18:19], v[18:19], v[28:29], v[30:31]
    v_pk_fma_f32 v[60:61], v[60:61], v[28:29], v[30:31]
    v_pk_fma_f32 v[62:63], v[62:63], v[28:29], v[30:31]
    v_pk_mul_f32 v[16:17], v[16:17], v[224:225]
    v_pk_mul_f32 v[18:19], v[18:19], v[226:227]
    v_pk_mul_f32 v[60:61], v[60:61], v[228:229]
    v_pk_mul_f32 v[62:63], v[62:63], v[230:231]
    v_exp_f32 v16, v16
    v_exp_f32 v17, v17
    v_exp_f32 v18, v18
    v_exp_f32 v19, v19
    v_exp_f32 v60, v60
    v_exp_f32 v61, v61
    v_exp_f32 v62, v62
    v_exp_f32 v63, v63
    v_pk_add_f32 v[16:17], v[16:17], v[26:27]
    v_pk_add_f32 v[18:19], v[18:19], v[26:27]
    s_nop 0
    v_pk_add_f32 v[60:61], v[60:61], v[26:27]
    v_pk_add_f32 v[62:63], v[62:63], v[26:27]
    v_rcp_f32 v16, v16
    v_rcp_f32 v17, v17
    v_rcp_f32 v18, v18
    v_rcp_f32 v19, v19
    v_rcp_f32 v60, v60
    v_rcp_f32 v61, v61
    v_rcp_f32 v62, v62
    v_rcp_f32 v63, v63
    v_pk_mul_f32 v[16:17], v[16:17], v[224:225]
    v_pk_mul_f32 v[18:19], v[18:19], v[226:227]
    v_pk_mul_f32 v[60:61], v[60:61], v[228:229]
    v_pk_mul_f32 v[62:63], v[62:63], v[230:231]
    v_cvt_pk_bf16_f32 v40, v16, v17
    v_cvt_pk_bf16_f32 v41, v18, v19
    v_cvt_pk_bf16_f32 v42, v60, v61
    v_cvt_pk_bf16_f32 v43, v62, v63
    s_nop 1
    v_permlane16_swap_b32 v40, v42
    v_permlane16_swap_b32 v41, v43
    s_add_u32 s38, s53, 196608
    buffer_store_dwordx4 v[40:43], v7, s[16:19], s38 offen offset:0 sc1
    v_pk_mul_f32 v[16:17], v[232:233], v[232:233]
    v_pk_mul_f32 v[18:19], v[234:235], v[234:235]
    v_pk_mul_f32 v[60:61], v[236:237], v[236:237]
    v_pk_mul_f32 v[62:63], v[238:239], v[238:239]
    v_pk_fma_f32 v[16:17], v[16:17], v[28:29], v[30:31]
    v_pk_fma_f32 v[18:19], v[18:19], v[28:29], v[30:31]
    v_pk_fma_f32 v[60:61], v[60:61], v[28:29], v[30:31]
    v_pk_fma_f32 v[62:63], v[62:63], v[28:29], v[30:31]
    v_pk_mul_f32 v[16:17], v[16:17], v[232:233]
    v_pk_mul_f32 v[18:19], v[18:19], v[234:235]
    v_pk_mul_f32 v[60:61], v[60:61], v[236:237]
    v_pk_mul_f32 v[62:63], v[62:63], v[238:239]
    v_exp_f32 v16, v16
    v_exp_f32 v17, v17
    v_exp_f32 v18, v18
    v_exp_f32 v19, v19
    v_exp_f32 v60, v60
    v_exp_f32 v61, v61
    v_exp_f32 v62, v62
    v_exp_f32 v63, v63
    v_pk_add_f32 v[16:17], v[16:17], v[26:27]
    v_pk_add_f32 v[18:19], v[18:19], v[26:27]
    s_nop 0
    v_pk_add_f32 v[60:61], v[60:61], v[26:27]
    v_pk_add_f32 v[62:63], v[62:63], v[26:27]
    v_rcp_f32 v16, v16
    v_rcp_f32 v17, v17
    v_rcp_f32 v18, v18
    v_rcp_f32 v19, v19
    v_rcp_f32 v60, v60
    v_rcp_f32 v61, v61
    v_rcp_f32 v62, v62
    v_rcp_f32 v63, v63
    v_pk_mul_f32 v[16:17], v[16:17], v[232:233]
    v_pk_mul_f32 v[18:19], v[18:19], v[234:235]
    v_pk_mul_f32 v[60:61], v[60:61], v[236:237]
    v_pk_mul_f32 v[62:63], v[62:63], v[238:239]
    v_cvt_pk_bf16_f32 v44, v16, v17
    v_cvt_pk_bf16_f32 v45, v18, v19
    v_cvt_pk_bf16_f32 v46, v60, v61
    v_cvt_pk_bf16_f32 v47, v62, v63
    s_nop 1
    v_permlane16_swap_b32 v44, v46
    v_permlane16_swap_b32 v45, v47
    s_add_u32 s38, s53, 196608
    buffer_store_dwordx4 v[44:47], v7, s[16:19], s38 offen offset:512 sc1
    s_lshl_b32 s38, s32, 4
    s_add_u32 s38, s38, s33
    s_lshl_b32 s38, s38, 7
    s_add_u32 s54, s38, 0x108000
    s_mov_b32 s38, s32
    s_mov_b32 s32, s33
    s_mov_b32 s33, s38
    s_mov_b32 s8, s4
    s_and_b32 s9, s5, 0xffff
    s_mov_b32 s10, 0x200000
    s_mov_b32 s11, 0x00020000
    s_add_u32 s12, s34, 0x1000000
    s_addc_u32 s13, s35, 0
    s_and_b32 s13, s13, 0xffff
    s_mov_b32 s14, 0x400000
    s_mov_b32 s15, 0x00020000
    s_mov_b32 s16, s6
    s_and_b32 s17, s7, 0xffff
    s_mov_b32 s18, 0xe00000
    s_mov_b32 s19, 0x00020000
    s_add_u32 s20, s34, 0x800000
    s_addc_u32 s21, s35, 0
    s_and_b32 s21, s21, 0xffff
    s_mov_b32 s22, 0x700000
    s_mov_b32 s23, 0x00020000
    s_add_u32 s24, s34, 0x1400000
    s_addc_u32 s25, s35, 0
    s_and_b32 s25, s25, 0xffff
    s_mov_b32 s26, 0x200000
    s_mov_b32 s27, 0x00020000
    s_lshl_b32 s49, s32, 3
    s_add_u32 s49, s49, s33
    v_mov_b32 v5, 1
    v_mov_b32 v6, 0
    s_waitcnt vmcnt(0)
    s_barrier
    s_cmp_lg_u32 s31, 0
    s_cbranch_scc1 L_b_noflag2
    v_mov_b32 v5, s3
    s_mov_b64 exec, 1
    buffer_store_dword v5, v6, s[24:27], s54 offen sc1
    s_mov_b64 exec, -1
L_b_noflag2:
    s_and_b32 s46, s31, 1
    s_lshr_b32 s47, s31, 1
    s_add_u32 s60, s34, 0x1600000
    s_addc_u32 s61, s35, 0
    s_and_b32 s61, s61, 0xffff
    s_mov_b32 s62, 0x1000000
    s_mov_b32 s63, 0x00020000
    v_lshlrev_b32 v5, 11, v3
    v_lshl_add_u32 v5, v4, 4, v5
    s_lshl_b32 s38, s46, 10
    v_add_u32 v104, s38, v5
    v_lshrrev_b32 v5, 2, v4
    v_lshl_add_u32 v6, v3, 3, v5
    v_and_b32 v7, 1, v3
    v_lshl_add_u32 v5, v7, 2, v5
    v_and_b32 v7, 3, v4
    v_lshlrev_b32 v7, 3, v7
    v_lshl_add_u32 v6, v6, 8, v7
    s_mul_i32 s38, s47, 49152
    s_add_u32 s38, s38, 49152
    v_add_u32 v6, s38, v6
    v_xor_b32 v7, 0, v5
    v_lshl_add_u32 v105, v7, 5, v6
    v_xor_b32 v7, 1, v5
    v_lshl_add_u32 v106, v7, 5, v6
    v_xor_b32 v7, 2, v5
    v_lshl_add_u32 v107, v7, 5, v6
    v_xor_b32 v7, 3, v5
    v_lshl_add_u32 v108, v7, 5, v6
    v_xor_b32 v7, 4, v5
    v_lshl_add_u32 v109, v7, 5, v6
    v_xor_b32 v7, 5, v5
    v_lshl_add_u32 v110, v7, 5, v6
    v_xor_b32 v7, 6, v5
    v_lshl_add_u32 v111, v7, 5, v6
    v_xor_b32 v7, 7, v5
    v_lshl_add_u32 v112, v7, 5, v6
    v_mov_b32 v128, 0
    v_mov_b32 v129, 0
    v_mov_b32 v130, 0
    v_mov_b32 v131, 0
    v_mov_b32 v132, 0
    v_mov_b32 v133, 0
    v_mov_b32 v134, 0
    v_mov_b32 v135, 0
    v_mov_b32 v136, 0
    v_mov_b32 v137, 0
    v_mov_b32 v138, 0
    v_mov_b32 v139, 0
    v_mov_b32 v140, 0
    v_mov_b32 v141, 0
    v_mov_b32 v142, 0
    v_mov_b32 v143, 0
    v_mov_b32 v144, 0
    v_mov_b32 v145, 0
    v_mov_b32 v146, 0
    v_mov_b32 v147, 0
    v_mov_b32 v148, 0
    v_mov_b32 v149, 0
    v_mov_b32 v150, 0
    v_mov_b32 v151, 0
    v_mov_b32 v152, 0
    v_mov_b32 v153, 0
    v_mov_b32 v154, 0
    v_mov_b32 v155, 0
    v_mov_b32 v156, 0
    v_mov_b32 v157, 0
    v_mov_b32 v158, 0
    v_mov_b32 v159, 0
    v_mov_b32 v160, 0
    v_mov_b32 v161, 0
    v_mov_b32 v162, 0
    v_mov_b32 v163, 0
    v_mov_b32 v164, 0
    v_mov_b32 v165, 0
    v_mov_b32 v166, 0
    v_mov_b32 v167, 0
    v_mov_b32 v168, 0
    v_mov_b32 v169, 0
    v_mov_b32 v170, 0
    v_mov_b32 v171, 0
    v_mov_b32 v172, 0
    v_mov_b32 v173, 0
    v_mov_b32 v174, 0
    v_mov_b32 v175, 0
    v_mov_b32 v176, 0
    v_mov_b32 v177, 0
    v_mov_b32 v178, 0
    v_mov_b32 v179, 0
    v_mov_b32 v180, 0
    v_mov_b32 v181, 0
    v_mov_b32 v182, 0
    v_mov_b32 v183, 0
    v_mov_b32 v184, 0
    v_mov_b32 v185, 0
    v_mov_b32 v186, 0
    v_mov_b32 v187, 0
    v_mov_b32 v188, 0
    v_mov_b32 v189, 0
    v_mov_b32 v190, 0
    v_mov_b32 v191, 0
    v_mov_b32 v192, 0
    v_mov_b32 v193, 0
    v_mov_b32 v194, 0
    v_mov_b32 v195, 0
    v_mov_b32 v196, 0
    v_mov_b32 v197, 0
    v_mov_b32 v198, 0
    v_mov_b32 v199, 0
    v_mov_b32 v200, 0
    v_mov_b32 v201, 0
    v_mov_b32 v202, 0
    v_mov_b32 v203, 0
    v_mov_b32 v204, 0
    v_mov_b32 v205, 0
    v_mov_b32 v206, 0
    v_mov_b32 v207, 0
    v_mov_b32 v208, 0
    v_mov_b32 v209, 0
    v_mov_b32 v210, 0
    v_mov_b32 v211, 0
    v_mov_b32 v212, 0
    v_mov_b32 v213, 0
    v_mov_b32 v214, 0
    v_mov_b32 v215, 0
    v_mov_b32 v216, 0
    v_mov_b32 v217, 0
    v_mov_b32 v218, 0
    v_mov_b32 v219, 0
    v_mov_b32 v220, 0
    v_mov_b32 v221, 0
    v_mov_b32 v222, 0
    v_mov_b32 v223, 0
    v_mov_b32 v224, 0
    v_mov_b32 v225, 0
    v_mov_b32 v226, 0
    v_mov_b32 v227, 0
    v_mov_b32 v228, 0
    v_mov_b32 v229, 0
    v_mov_b32 v230, 0
    v_mov_b32 v231, 0
    v_mov_b32 v232, 0
    v_mov_b32 v233, 0
    v_mov_b32 v234, 0
    v_mov_b32 v235, 0
    v_mov_b32 v236, 0
    v_mov_b32 v237, 0
    v_mov_b32 v238, 0
    v_mov_b32 v239, 0
    v_mov_b32 v240, 0
    v_mov_b32 v241, 0
    v_mov_b32 v242, 0
    v_mov_b32 v243, 0
    v_mov_b32 v244, 0
    v_mov_b32 v245, 0
    v_mov_b32 v246, 0
    v_mov_b32 v247, 0
    v_mov_b32 v248, 0
    v_mov_b32 v249, 0
    v_mov_b32 v250, 0
    v_mov_b32 v251, 0
    v_mov_b32 v252, 0
    v_mov_b32 v253, 0
    v_mov_b32 v254, 0
    v_mov_b32 v255, 0
    s_lshl_b32 s38, s47, 3
    s_xor_b32 s38, s38, s32
    s_lshl_b32 s38, s38, 3
    s_add_u32 s38, s38, s33
    s_lshr_b32 s39, s32, 3
    s_lshl_b32 s50, s38, 2
    s_lshl_b32 s40, s39, 1
    s_add_u32 s50, s50, s40
    s_add_u32 s50, s50, s46
    s_lshl_b32 s50, s50, 7
    s_add_u32 s50, s50, 0x110000
    s_lshl_b32 s51, s38, 16
    s_lshl_b32 s40, s39, 15
    s_add_u32 s51, s51, s40
    s_lshl_b32 s40, s46, 13
    s_add_u32 s51, s51, s40
    s_setprio 1
    s_barrier
    s_barrier
    .p2align 6
    ds_read_b64_tr_b16 v[24:25], v105 offset:0
    ds_read_b64_tr_b16 v[26:27], v105 offset:1024
    ds_read_b128 v[8:11], v104 offset:0
    ds_read_b64_tr_b16 v[28:29], v106 offset:0
    ds_read_b64_tr_b16 v[30:31], v106 offset:1024
    ds_read_b64_tr_b16 v[32:33], v107 offset:0
    ds_read_b64_tr_b16 v[34:35], v107 offset:1024
    ds_read_b128 v[12:15], v104 offset:256
    ds_read_b64_tr_b16 v[36:37], v108 offset:0
    ds_read_b64_tr_b16 v[38:39], v108 offset:1024
    ds_read_b64_tr_b16 v[40:41], v109 offset:0
    ds_read_b64_tr_b16 v[42:43], v109 offset:1024
    ds_read_b128 v[16:19], v104 offset:512
    ds_read_b64_tr_b16 v[44:45], v110 offset:0
    ds_read_b64_tr_b16 v[46:47], v110 offset:1024
    ds_read_b64_tr_b16 v[48:49], v111 offset:0
    ds_read_b64_tr_b16 v[50:51], v111 offset:1024
    ds_read_b128 v[20:23], v104 offset:768
    ds_read_b64_tr_b16 v[52:53], v112 offset:0
    ds_read_b64_tr_b16 v[54:55], v112 offset:1024
    s_mov_b32 s30, 5
    s_nop 0
L_fc1_19:
    s_waitcnt lgkmcnt(0)
    s_barrier
    v_mfma_f32_16x16x32_bf16 v[128:131], v[8:11], v[24:27], v[128:131]
    ds_read_b64_tr_b16 v[72:73], v105 offset:8192
    v_mfma_f32_16x16x32_bf16 v[132:135], v[8:11], v[28:31], v[132:135]
    ds_read_b64_tr_b16 v[74:75], v105 offset:9216
    v_mfma_f32_16x16x32_bf16 v[136:139], v[8:11], v[32:35], v[136:139]
    ds_read_b128 v[56:59], v104 offset:8192
    v_mfma_f32_16x16x32_bf16 v[140:143], v[8:11], v[36:39], v[140:143]
    ds_read_b64_tr_b16 v[76:77], v106 offset:8192
    v_mfma_f32_16x16x32_bf16 v[144:147], v[8:11], v[40:43], v[144:147]
    ds_read_b64_tr_b16 v[78:79], v106 offset:9216
    v_mfma_f32_16x16x32_bf16 v[148:151], v[8:11], v[44:47], v[148:151]
    v_mfma_f32_16x16x32_bf16 v[152:155], v[8:11], v[48:51], v[152:155]
    ds_read_b64_tr_b16 v[80:81], v107 offset:8192
    v_mfma_f32_16x16x32_bf16 v[156:159], v[8:11], v[52:55], v[156:159]
    ds_read_b64_tr_b16 v[82:83], v107 offset:9216
    v_mfma_f32_16x16x32_bf16 v[188:191], v[12:15], v[52:55], v[188:191]
    ds_read_b128 v[60:63], v104 offset:8448
    v_mfma_f32_16x16x32_bf16 v[184:187], v[12:15], v[48:51], v[184:187]
    ds_read_b64_tr_b16 v[84:85], v108 offset:8192
    v_mfma_f32_16x16x32_bf16 v[180:183], v[12:15], v[44:47], v[180:183]
    ds_read_b64_tr_b16 v[86:87], v108 offset:9216
    v_mfma_f32_16x16x32_bf16 v[176:179], v[12:15], v[40:43], v[176:179]
    v_mfma_f32_16x16x32_bf16 v[172:175], v[12:15], v[36:39], v[172:175]
    ds_read_b64_tr_b16 v[88:89], v109 offset:8192
    v_mfma_f32_16x16x32_bf16 v[168:171], v[12:15], v[32:35], v[168:171]
    ds_read_b64_tr_b16 v[90:91], v109 offset:9216
    v_mfma_f32_16x16x32_bf16 v[164:167], v[12:15], v[28:31], v[164:167]
    ds_read_b128 v[64:67], v104 offset:8704
    v_mfma_f32_16x16x32_bf16 v[160:163], v[12:15], v[24:27], v[160:163]
    ds_read_b64_tr_b16 v[92:93], v110 offset:8192
    v_mfma_f32_16x16x32_bf16 v[192:195], v[16:19], v[24:27], v[192:195]
    ds_read_b64_tr_b16 v[94:95], v110 offset:9216
    v_mfma_f32_16x16x32_bf16 v[196:199], v[16:19], v[28:31], v[196:199]
    v_mfma_f32_16x16x32_bf16 v[200:203], v[16:19], v[32:35], v[200:203]
    ds_read_b64_tr_b16 v[96:97], v111 offset:8192
    v_mfma_f32_16x16x32_bf16 v[204:207], v[16:19], v[36:39], v[204:207]
    ds_read_b64_tr_b16 v[98:99], v111 offset:9216
    v_mfma_f32_16x16x32_bf16 v[208:211], v[16:19], v[40:43], v[208:211]
    ds_read_b128 v[68:71], v104 offset:8960
    v_mfma_f32_16x16x32_bf16 v[212:215], v[16:19], v[44:47], v[212:215]
    ds_read_b64_tr_b16 v[100:101], v112 offset:8192
    v_mfma_f32_16x16x32_bf16 v[216:219], v[16:19], v[48:51], v[216:219]
    ds_read_b64_tr_b16 v[102:103], v112 offset:9216
    v_mfma_f32_16x16x32_bf16 v[220:223], v[16:19], v[52:55], v[220:223]
    v_mfma_f32_16x16x32_bf16 v[252:255], v[20:23], v[52:55], v[252:255]
    v_mfma_f32_16x16x32_bf16 v[248:251], v[20:23], v[48:51], v[248:251]
    v_mfma_f32_16x16x32_bf16 v[244:247], v[20:23], v[44:47], v[244:247]
    v_mfma_f32_16x16x32_bf16 v[240:243], v[20:23], v[40:43], v[240:243]
    v_mfma_f32_16x16x32_bf16 v[236:239], v[20:23], v[36:39], v[236:239]
    v_mfma_f32_16x16x32_bf16 v[232:235], v[20:23], v[32:35], v[232:235]
    v_mfma_f32_16x16x32_bf16 v[228:231], v[20:23], v[28:31], v[228:231]
    v_mfma_f32_16x16x32_bf16 v[224:227], v[20:23], v[24:27], v[224:227]
    s_waitcnt lgkmcnt(0)
    s_nop 0
    v_mfma_f32_16x16x32_bf16 v[128:131], v[56:59], v[72:75], v[128:131]
    ds_read_b64_tr_b16 v[24:25], v105 offset:16384
    v_mfma_f32_16x16x32_bf16 v[132:135], v[56:59], v[76:79], v[132:135]
    ds_read_b64_tr_b16 v[26:27], v105 offset:17408
    v_mfma_f32_16x16x32_bf16 v[136:139], v[56:59], v[80:83], v[136:139]
    ds_read_b128 v[8:11], v104 offset:16384
    v_mfma_f32_16x16x32_bf16 v[140:143], v[56:59], v[84:87], v[140:143]
    ds_read_b64_tr_b16 v[28:29], v106 offset:16384
    v_mfma_f32_16x16x32_bf16 v[144:147], v[56:59], v[88:91], v[144:147]
    ds_read_b64_tr_b16 v[30:31], v106 offset:17408
    v_mfma_f32_16x16x32_bf16 v[148:151], v[56:59], v[92:95], v[148:151]
    v_mfma_f32_16x16x32_bf16 v[152:155], v[56:59], v[96:99], v[152:155]
    ds_read_b64_tr_b16 v[32:33], v107 offset:16384
    v_mfma_f32_16x16x32_bf16 v[156:159], v[56:59], v[100:103], v[156:159]
    ds_read_b64_tr_b16 v[34:35], v107 offset:17408
    v_mfma_f32_16x16x32_bf16 v[188:191], v[60:63], v[100:103], v[188:191]
    ds_read_b128 v[12:15], v104 offset:16640
    v_mfma_f32_16x16x32_bf16 v[184:187], v[60:63], v[96:99], v[184:187]
    ds_read_b64_tr_b16 v[36:37], v108 offset:16384
    v_mfma_f32_16x16x32_bf16 v[180:183], v[60:63], v[92:95], v[180:183]
    ds_read_b64_tr_b16 v[38:39], v108 offset:17408
    v_mfma_f32_16x16x32_bf16 v[176:179], v[60:63], v[88:91], v[176:179]
    v_mfma_f32_16x16x32_bf16 v[172:175], v[60:63], v[84:87], v[172:175]
    ds_read_b64_tr_b16 v[40:41], v109 offset:16384
    v_mfma_f32_16x16x32_bf16 v[168:171], v[60:63], v[80:83], v[168:171]
    ds_read_b64_tr_b16 v[42:43], v109 offset:17408
    v_mfma_f32_16x16x32_bf16 v[164:167], v[60:63], v[76:79], v[164:167]
    ds_read_b128 v[16:19], v104 offset:16896
    v_mfma_f32_16x16x32_bf16 v[160:163], v[60:63], v[72:75], v[160:163]
    ds_read_b64_tr_b16 v[44:45], v110 offset:16384
    v_mfma_f32_16x16x32_bf16 v[192:195], v[64:67], v[72:75], v[192:195]
    ds_read_b64_tr_b16 v[46:47], v110 offset:17408
    v_mfma_f32_16x16x32_bf16 v[196:199], v[64:67], v[76:79], v[196:199]
    v_mfma_f32_16x16x32_bf16 v[200:203], v[64:67], v[80:83], v[200:203]
    ds_read_b64_tr_b16 v[48:49], v111 offset:16384
    v_mfma_f32_16x16x32_bf16 v[204:207], v[64:67], v[84:87], v[204:207]
    ds_read_b64_tr_b16 v[50:51], v111 offset:17408
    v_mfma_f32_16x16x32_bf16 v[208:211], v[64:67], v[88:91], v[208:211]
    ds_read_b128 v[20:23], v104 offset:17152
    v_mfma_f32_16x16x32_bf16 v[212:215], v[64:67], v[92:95], v[212:215]
    ds_read_b64_tr_b16 v[52:53], v112 offset:16384
    v_mfma_f32_16x16x32_bf16 v[216:219], v[64:67], v[96:99], v[216:219]
    ds_read_b64_tr_b16 v[54:55], v112 offset:17408
    v_mfma_f32_16x16x32_bf16 v[220:223], v[64:67], v[100:103], v[220:223]
    v_mfma_f32_16x16x32_bf16 v[252:255], v[68:71], v[100:103], v[252:255]
    v_mfma_f32_16x16x32_bf16 v[248:251], v[68:71], v[96:99], v[248:251]
    v_mfma_f32_16x16x32_bf16 v[244:247], v[68:71], v[92:95], v[244:247]
    v_mfma_f32_16x16x32_bf16 v[240:243], v[68:71], v[88:91], v[240:243]
    v_mfma_f32_16x16x32_bf16 v[236:239], v[68:71], v[84:87], v[236:239]
    v_mfma_f32_16x16x32_bf16 v[232:235], v[68:71], v[80:83], v[232:235]
    v_mfma_f32_16x16x32_bf16 v[228:231], v[68:71], v[76:79], v[228:231]
    v_mfma_f32_16x16x32_bf16 v[224:227], v[68:71], v[72:75], v[224:227]
    s_waitcnt lgkmcnt(0)
    s_barrier
    v_mfma_f32_16x16x32_bf16 v[128:131], v[8:11], v[24:27], v[128:131]
    ds_read_b64_tr_b16 v[72:73], v105 offset:24576
    v_mfma_f32_16x16x32_bf16 v[132:135], v[8:11], v[28:31], v[132:135]
    ds_read_b64_tr_b16 v[74:75], v105 offset:25600
    v_mfma_f32_16x16x32_bf16 v[136:139], v[8:11], v[32:35], v[136:139]
    ds_read_b128 v[56:59], v104 offset:24576
    v_mfma_f32_16x16x32_bf16 v[140:143], v[8:11], v[36:39], v[140:143]
    ds_read_b64_tr_b16 v[76:77], v106 offset:24576
    v_mfma_f32_16x16x32_bf16 v[144:147], v[8:11], v[40:43], v[144:147]
    ds_read_b64_tr_b16 v[78:79], v106 offset:25600
    v_mfma_f32_16x16x32_bf16 v[148:151], v[8:11], v[44:47], v[148:151]
    v_mfma_f32_16x16x32_bf16 v[152:155], v[8:11], v[48:51], v[152:155]
    ds_read_b64_tr_b16 v[80:81], v107 offset:24576
    v_mfma_f32_16x16x32_bf16 v[156:159], v[8:11], v[52:55], v[156:159]
    ds_read_b64_tr_b16 v[82:83], v107 offset:25600
    v_mfma_f32_16x16x32_bf16 v[188:191], v[12:15], v[52:55], v[188:191]
    ds_read_b128 v[60:63], v104 offset:24832
    v_mfma_f32_16x16x32_bf16 v[184:187], v[12:15], v[48:51], v[184:187]
    ds_read_b64_tr_b16 v[84:85], v108 offset:24576
    v_mfma_f32_16x16x32_bf16 v[180:183], v[12:15], v[44:47], v[180:183]
    ds_read_b64_tr_b16 v[86:87], v108 offset:25600
    v_mfma_f32_16x16x32_bf16 v[176:179], v[12:15], v[40:43], v[176:179]
    v_mfma_f32_16x16x32_bf16 v[172:175], v[12:15], v[36:39], v[172:175]
    ds_read_b64_tr_b16 v[88:89], v109 offset:24576
    v_mfma_f32_16x16x32_bf16 v[168:171], v[12:15], v[32:35], v[168:171]
    ds_read_b64_tr_b16 v[90:91], v109 offset:25600
    v_mfma_f32_16x16x32_bf16 v[164:167], v[12:15], v[28:31], v[164:167]
    ds_read_b128 v[64:67], v104 offset:25088
    v_mfma_f32_16x16x32_bf16 v[160:163], v[12:15], v[24:27], v[160:163]
    ds_read_b64_tr_b16 v[92:93], v110 offset:24576
    v_mfma_f32_16x16x32_bf16 v[192:195], v[16:19], v[24:27], v[192:195]
    ds_read_b64_tr_b16 v[94:95], v110 offset:25600
    v_mfma_f32_16x16x32_bf16 v[196:199], v[16:19], v[28:31], v[196:199]
    v_mfma_f32_16x16x32_bf16 v[200:203], v[16:19], v[32:35], v[200:203]
    ds_read_b64_tr_b16 v[96:97], v111 offset:24576
    v_mfma_f32_16x16x32_bf16 v[204:207], v[16:19], v[36:39], v[204:207]
    ds_read_b64_tr_b16 v[98:99], v111 offset:25600
    v_mfma_f32_16x16x32_bf16 v[208:211], v[16:19], v[40:43], v[208:211]
    ds_read_b128 v[68:71], v104 offset:25344
    v_mfma_f32_16x16x32_bf16 v[212:215], v[16:19], v[44:47], v[212:215]
    ds_read_b64_tr_b16 v[100:101], v112 offset:24576
    v_mfma_f32_16x16x32_bf16 v[216:219], v[16:19], v[48:51], v[216:219]
    ds_read_b64_tr_b16 v[102:103], v112 offset:25600
    v_mfma_f32_16x16x32_bf16 v[220:223], v[16:19], v[52:55], v[220:223]
    v_mfma_f32_16x16x32_bf16 v[252:255], v[20:23], v[52:55], v[252:255]
    v_mfma_f32_16x16x32_bf16 v[248:251], v[20:23], v[48:51], v[248:251]
    v_mfma_f32_16x16x32_bf16 v[244:247], v[20:23], v[44:47], v[244:247]
    v_mfma_f32_16x16x32_bf16 v[240:243], v[20:23], v[40:43], v[240:243]
    v_mfma_f32_16x16x32_bf16 v[236:239], v[20:23], v[36:39], v[236:239]
    v_mfma_f32_16x16x32_bf16 v[232:235], v[20:23], v[32:35], v[232:235]
    v_mfma_f32_16x16x32_bf16 v[228:231], v[20:23], v[28:31], v[228:231]
    v_mfma_f32_16x16x32_bf16 v[224:227], v[20:23], v[24:27], v[224:227]
    s_waitcnt lgkmcnt(0)
    s_nop 0
    v_mfma_f32_16x16x32_bf16 v[128:131], v[56:59], v[72:75], v[128:131]
    ds_read_b64_tr_b16 v[24:25], v105 offset:32768
    v_mfma_f32_16x16x32_bf16 v[132:135], v[56:59], v[76:79], v[132:135]
    ds_read_b64_tr_b16 v[26:27], v105 offset:33792
    v_mfma_f32_16x16x32_bf16 v[136:139], v[56:59], v[80:83], v[136:139]
    ds_read_b128 v[8:11], v104 offset:32768
    v_mfma_f32_16x16x32_bf16 v[140:143], v[56:59], v[84:87], v[140:143]
    ds_read_b64_tr_b16 v[28:29], v106 offset:32768
    v_mfma_f32_16x16x32_bf16 v[144:147], v[56:59], v[88:91], v[144:147]
    ds_read_b64_tr_b16 v[30:31], v106 offset:33792
    v_mfma_f32_16x16x32_bf16 v[148:151], v[56:59], v[92:95], v[148:151]
    v_mfma_f32_16x16x32_bf16 v[152:155], v[56:59], v[96:99], v[152:155]
    ds_read_b64_tr_b16 v[32:33], v107 offset:32768
    v_mfma_f32_16x16x32_bf16 v[156:159], v[56:59], v[100:103], v[156:159]
    ds_read_b64_tr_b16 v[34:35], v107 offset:33792
    v_mfma_f32_16x16x32_bf16 v[188:191], v[60:63], v[100:103], v[188:191]
    ds_read_b128 v[12:15], v104 offset:33024
    v_mfma_f32_16x16x32_bf16 v[184:187], v[60:63], v[96:99], v[184:187]
    ds_read_b64_tr_b16 v[36:37], v108 offset:32768
    v_mfma_f32_16x16x32_bf16 v[180:183], v[60:63], v[92:95], v[180:183]
    ds_read_b64_tr_b16 v[38:39], v108 offset:33792
    v_mfma_f32_16x16x32_bf16 v[176:179], v[60:63], v[88:91], v[176:179]
    v_mfma_f32_16x16x32_bf16 v[172:175], v[60:63], v[84:87], v[172:175]
    ds_read_b64_tr_b16 v[40:41], v109 offset:32768
    v_mfma_f32_16x16x32_bf16 v[168:171], v[60:63], v[80:83], v[168:171]
    ds_read_b64_tr_b16 v[42:43], v109 offset:33792
    v_mfma_f32_16x16x32_bf16 v[164:167], v[60:63], v[76:79], v[164:167]
    ds_read_b128 v[16:19], v104 offset:33280
    v_mfma_f32_16x16x32_bf16 v[160:163], v[60:63], v[72:75], v[160:163]
    ds_read_b64_tr_b16 v[44:45], v110 offset:32768
    v_mfma_f32_16x16x32_bf16 v[192:195], v[64:67], v[72:75], v[192:195]
    ds_read_b64_tr_b16 v[46:47], v110 offset:33792
    v_mfma_f32_16x16x32_bf16 v[196:199], v[64:67], v[76:79], v[196:199]
    v_mfma_f32_16x16x32_bf16 v[200:203], v[64:67], v[80:83], v[200:203]
    ds_read_b64_tr_b16 v[48:49], v111 offset:32768
    v_mfma_f32_16x16x32_bf16 v[204:207], v[64:67], v[84:87], v[204:207]
    ds_read_b64_tr_b16 v[50:51], v111 offset:33792
    v_mfma_f32_16x16x32_bf16 v[208:211], v[64:67], v[88:91], v[208:211]
    ds_read_b128 v[20:23], v104 offset:33536
    v_mfma_f32_16x16x32_bf16 v[212:215], v[64:67], v[92:95], v[212:215]
    ds_read_b64_tr_b16 v[52:53], v112 offset:32768
    v_mfma_f32_16x16x32_bf16 v[216:219], v[64:67], v[96:99], v[216:219]
    ds_read_b64_tr_b16 v[54:55], v112 offset:33792
    v_mfma_f32_16x16x32_bf16 v[220:223], v[64:67], v[100:103], v[220:223]
    v_mfma_f32_16x16x32_bf16 v[252:255], v[68:71], v[100:103], v[252:255]
    v_mfma_f32_16x16x32_bf16 v[248:251], v[68:71], v[96:99], v[248:251]
    v_mfma_f32_16x16x32_bf16 v[244:247], v[68:71], v[92:95], v[244:247]
    v_mfma_f32_16x16x32_bf16 v[240:243], v[68:71], v[88:91], v[240:243]
    v_mfma_f32_16x16x32_bf16 v[236:239], v[68:71], v[84:87], v[236:239]
    v_mfma_f32_16x16x32_bf16 v[232:235], v[68:71], v[80:83], v[232:235]
    v_mfma_f32_16x16x32_bf16 v[228:231], v[68:71], v[76:79], v[228:231]
    v_mfma_f32_16x16x32_bf16 v[224:227], v[68:71], v[72:75], v[224:227]
    s_waitcnt lgkmcnt(0)
    s_barrier
    v_mfma_f32_16x16x32_bf16 v[128:131], v[8:11], v[24:27], v[128:131]
    ds_read_b64_tr_b16 v[72:73], v105 offset:40960
    v_mfma_f32_16x16x32_bf16 v[132:135], v[8:11], v[28:31], v[132:135]
    ds_read_b64_tr_b16 v[74:75], v105 offset:41984
    v_mfma_f32_16x16x32_bf16 v[136:139], v[8:11], v[32:35], v[136:139]
    ds_read_b128 v[56:59], v104 offset:40960
    v_mfma_f32_16x16x32_bf16 v[140:143], v[8:11], v[36:39], v[140:143]
    ds_read_b64_tr_b16 v[76:77], v106 offset:40960
    v_mfma_f32_16x16x32_bf16 v[144:147], v[8:11], v[40:43], v[144:147]
    ds_read_b64_tr_b16 v[78:79], v106 offset:41984
    v_mfma_f32_16x16x32_bf16 v[148:151], v[8:11], v[44:47], v[148:151]
    v_mfma_f32_16x16x32_bf16 v[152:155], v[8:11], v[48:51], v[152:155]
    ds_read_b64_tr_b16 v[80:81], v107 offset:40960
    v_mfma_f32_16x16x32_bf16 v[156:159], v[8:11], v[52:55], v[156:159]
    ds_read_b64_tr_b16 v[82:83], v107 offset:41984
    v_mfma_f32_16x16x32_bf16 v[188:191], v[12:15], v[52:55], v[188:191]
    ds_read_b128 v[60:63], v104 offset:41216
    v_mfma_f32_16x16x32_bf16 v[184:187], v[12:15], v[48:51], v[184:187]
    ds_read_b64_tr_b16 v[84:85], v108 offset:40960
    v_mfma_f32_16x16x32_bf16 v[180:183], v[12:15], v[44:47], v[180:183]
    ds_read_b64_tr_b16 v[86:87], v108 offset:41984
    v_mfma_f32_16x16x32_bf16 v[176:179], v[12:15], v[40:43], v[176:179]
    v_mfma_f32_16x16x32_bf16 v[172:175], v[12:15], v[36:39], v[172:175]
    ds_read_b64_tr_b16 v[88:89], v109 offset:40960
    v_mfma_f32_16x16x32_bf16 v[168:171], v[12:15], v[32:35], v[168:171]
    ds_read_b64_tr_b16 v[90:91], v109 offset:41984
    v_mfma_f32_16x16x32_bf16 v[164:167], v[12:15], v[28:31], v[164:167]
    ds_read_b128 v[64:67], v104 offset:41472
    v_mfma_f32_16x16x32_bf16 v[160:163], v[12:15], v[24:27], v[160:163]
    ds_read_b64_tr_b16 v[92:93], v110 offset:40960
    v_mfma_f32_16x16x32_bf16 v[192:195], v[16:19], v[24:27], v[192:195]
    ds_read_b64_tr_b16 v[94:95], v110 offset:41984
    v_mfma_f32_16x16x32_bf16 v[196:199], v[16:19], v[28:31], v[196:199]
    v_mfma_f32_16x16x32_bf16 v[200:203], v[16:19], v[32:35], v[200:203]
    ds_read_b64_tr_b16 v[96:97], v111 offset:40960
    v_mfma_f32_16x16x32_bf16 v[204:207], v[16:19], v[36:39], v[204:207]
    ds_read_b64_tr_b16 v[98:99], v111 offset:41984
    v_mfma_f32_16x16x32_bf16 v[208:211], v[16:19], v[40:43], v[208:211]
    ds_read_b128 v[68:71], v104 offset:41728
    v_mfma_f32_16x16x32_bf16 v[212:215], v[16:19], v[44:47], v[212:215]
    ds_read_b64_tr_b16 v[100:101], v112 offset:40960
    v_mfma_f32_16x16x32_bf16 v[216:219], v[16:19], v[48:51], v[216:219]
    ds_read_b64_tr_b16 v[102:103], v112 offset:41984
    v_mfma_f32_16x16x32_bf16 v[220:223], v[16:19], v[52:55], v[220:223]
    v_mfma_f32_16x16x32_bf16 v[252:255], v[20:23], v[52:55], v[252:255]
    v_mfma_f32_16x16x32_bf16 v[248:251], v[20:23], v[48:51], v[248:251]
    v_mfma_f32_16x16x32_bf16 v[244:247], v[20:23], v[44:47], v[244:247]
    v_mfma_f32_16x16x32_bf16 v[240:243], v[20:23], v[40:43], v[240:243]
    v_mfma_f32_16x16x32_bf16 v[236:239], v[20:23], v[36:39], v[236:239]
    v_mfma_f32_16x16x32_bf16 v[232:235], v[20:23], v[32:35], v[232:235]
    v_mfma_f32_16x16x32_bf16 v[228:231], v[20:23], v[28:31], v[228:231]
    v_mfma_f32_16x16x32_bf16 v[224:227], v[20:23], v[24:27], v[224:227]
    s_waitcnt lgkmcnt(0)
    s_nop 0
    v_mfma_f32_16x16x32_bf16 v[128:131], v[56:59], v[72:75], v[128:131]
    ds_read_b64_tr_b16 v[24:25], v105 offset:0
    v_mfma_f32_16x16x32_bf16 v[132:135], v[56:59], v[76:79], v[132:135]
    ds_read_b64_tr_b16 v[26:27], v105 offset:1024
    v_mfma_f32_16x16x32_bf16 v[136:139], v[56:59], v[80:83], v[136:139]
    ds_read_b128 v[8:11], v104 offset:0
    v_mfma_f32_16x16x32_bf16 v[140:143], v[56:59], v[84:87], v[140:143]
    ds_read_b64_tr_b16 v[28:29], v106 offset:0
    v_mfma_f32_16x16x32_bf16 v[144:147], v[56:59], v[88:91], v[144:147]
    ds_read_b64_tr_b16 v[30:31], v106 offset:1024
    v_mfma_f32_16x16x32_bf16 v[148:151], v[56:59], v[92:95], v[148:151]
    v_mfma_f32_16x16x32_bf16 v[152:155], v[56:59], v[96:99], v[152:155]
    ds_read_b64_tr_b16 v[32:33], v107 offset:0
    v_mfma_f32_16x16x32_bf16 v[156:159], v[56:59], v[100:103], v[156:159]
    ds_read_b64_tr_b16 v[34:35], v107 offset:1024
    v_mfma_f32_16x16x32_bf16 v[188:191], v[60:63], v[100:103], v[188:191]
    ds_read_b128 v[12:15], v104 offset:256
    v_mfma_f32_16x16x32_bf16 v[184:187], v[60:63], v[96:99], v[184:187]
    ds_read_b64_tr_b16 v[36:37], v108 offset:0
    v_mfma_f32_16x16x32_bf16 v[180:183], v[60:63], v[92:95], v[180:183]
    ds_read_b64_tr_b16 v[38:39], v108 offset:1024
    v_mfma_f32_16x16x32_bf16 v[176:179], v[60:63], v[88:91], v[176:179]
    v_mfma_f32_16x16x32_bf16 v[172:175], v[60:63], v[84:87], v[172:175]
    ds_read_b64_tr_b16 v[40:41], v109 offset:0
    v_mfma_f32_16x16x32_bf16 v[168:171], v[60:63], v[80:83], v[168:171]
    ds_read_b64_tr_b16 v[42:43], v109 offset:1024
    v_mfma_f32_16x16x32_bf16 v[164:167], v[60:63], v[76:79], v[164:167]
    ds_read_b128 v[16:19], v104 offset:512
    v_mfma_f32_16x16x32_bf16 v[160:163], v[60:63], v[72:75], v[160:163]
    ds_read_b64_tr_b16 v[44:45], v110 offset:0
    v_mfma_f32_16x16x32_bf16 v[192:195], v[64:67], v[72:75], v[192:195]
    ds_read_b64_tr_b16 v[46:47], v110 offset:1024
    v_mfma_f32_16x16x32_bf16 v[196:199], v[64:67], v[76:79], v[196:199]
    v_mfma_f32_16x16x32_bf16 v[200:203], v[64:67], v[80:83], v[200:203]
    ds_read_b64_tr_b16 v[48:49], v111 offset:0
    v_mfma_f32_16x16x32_bf16 v[204:207], v[64:67], v[84:87], v[204:207]
    ds_read_b64_tr_b16 v[50:51], v111 offset:1024
    v_mfma_f32_16x16x32_bf16 v[208:211], v[64:67], v[88:91], v[208:211]
    ds_read_b128 v[20:23], v104 offset:768
    v_mfma_f32_16x16x32_bf16 v[212:215], v[64:67], v[92:95], v[212:215]
    ds_read_b64_tr_b16 v[52:53], v112 offset:0
    v_mfma_f32_16x16x32_bf16 v[216:219], v[64:67], v[96:99], v[216:219]
    ds_read_b64_tr_b16 v[54:55], v112 offset:1024
    v_mfma_f32_16x16x32_bf16 v[220:223], v[64:67], v[100:103], v[220:223]
    v_mfma_f32_16x16x32_bf16 v[252:255], v[68:71], v[100:103], v[252:255]
    v_mfma_f32_16x16x32_bf16 v[248:251], v[68:71], v[96:99], v[248:251]
    v_mfma_f32_16x16x32_bf16 v[244:247], v[68:71], v[92:95], v[244:247]
    v_mfma_f32_16x16x32_bf16 v[240:243], v[68:71], v[88:91], v[240:243]
    v_mfma_f32_16x16x32_bf16 v[236:239], v[68:71], v[84:87], v[236:239]
    v_mfma_f32_16x16x32_bf16 v[232:235], v[68:71], v[80:83], v[232:235]
    v_mfma_f32_16x16x32_bf16 v[228:231], v[68:71], v[76:79], v[228:231]
    v_mfma_f32_16x16x32_bf16 v[224:227], v[68:71], v[72:75], v[224:227]
    s_sub_u32 s30, s30, 1
    s_cmp_lg_u32 s30, 0
    s_nop 0
    s_cbranch_scc1 L_fc1_19
    s_waitcnt lgkmcnt(0)
    s_barrier
    v_mfma_f32_16x16x32_bf16 v[128:131], v[8:11], v[24:27], v[128:131]
    ds_read_b64_tr_b16 v[72:73], v105 offset:8192
    v_mfma_f32_16x16x32_bf16 v[132:135], v[8:11], v[28:31], v[132:135]
    ds_read_b64_tr_b16 v[74:75], v105 offset:9216
    v_mfma_f32_16x16x32_bf16 v[136:139], v[8:11], v[32:35], v[136:139]
    ds_read_b128 v[56:59], v104 offset:8192
    v_mfma_f32_16x16x32_bf16 v[140:143], v[8:11], v[36:39], v[140:143]
    ds_read_b64_tr_b16 v[76:77], v106 offset:8192
    v_mfma_f32_16x16x32_bf16 v[144:147], v[8:11], v[40:43], v[144:147]
    ds_read_b64_tr_b16 v[78:79], v106 offset:9216
    v_mfma_f32_16x16x32_bf16 v[148:151], v[8:11], v[44:47], v[148:151]
    v_mfma_f32_16x16x32_bf16 v[152:155], v[8:11], v[48:51], v[152:155]
    ds_read_b64_tr_b16 v[80:81], v107 offset:8192
    v_mfma_f32_16x16x32_bf16 v[156:159], v[8:11], v[52:55], v[156:159]
    ds_read_b64_tr_b16 v[82:83], v107 offset:9216
    v_mfma_f32_16x16x32_bf16 v[188:191], v[12:15], v[52:55], v[188:191]
    ds_read_b128 v[60:63], v104 offset:8448
    v_mfma_f32_16x16x32_bf16 v[184:187], v[12:15], v[48:51], v[184:187]
    ds_read_b64_tr_b16 v[84:85], v108 offset:8192
    v_mfma_f32_16x16x32_bf16 v[180:183], v[12:15], v[44:47], v[180:183]
    ds_read_b64_tr_b16 v[86:87], v108 offset:9216
    v_mfma_f32_16x16x32_bf16 v[176:179], v[12:15], v[40:43], v[176:179]
    v_mfma_f32_16x16x32_bf16 v[172:175], v[12:15], v[36:39], v[172:175]
    ds_read_b64_tr_b16 v[88:89], v109 offset:8192
    v_mfma_f32_16x16x32_bf16 v[168:171], v[12:15], v[32:35], v[168:171]
    ds_read_b64_tr_b16 v[90:91], v109 offset:9216
    v_mfma_f32_16x16x32_bf16 v[164:167], v[12:15], v[28:31], v[164:167]
    ds_read_b128 v[64:67], v104 offset:8704
    v_mfma_f32_16x16x32_bf16 v[160:163], v[12:15], v[24:27], v[160:163]
    ds_read_b64_tr_b16 v[92:93], v110 offset:8192
    v_mfma_f32_16x16x32_bf16 v[192:195], v[16:19], v[24:27], v[192:195]
    ds_read_b64_tr_b16 v[94:95], v110 offset:9216
    v_mfma_f32_16x16x32_bf16 v[196:199], v[16:19], v[28:31], v[196:199]
    v_mfma_f32_16x16x32_bf16 v[200:203], v[16:19], v[32:35], v[200:203]
    ds_read_b64_tr_b16 v[96:97], v111 offset:8192
    v_mfma_f32_16x16x32_bf16 v[204:207], v[16:19], v[36:39], v[204:207]
    ds_read_b64_tr_b16 v[98:99], v111 offset:9216
    v_mfma_f32_16x16x32_bf16 v[208:211], v[16:19], v[40:43], v[208:211]
    ds_read_b128 v[68:71], v104 offset:8960
    v_mfma_f32_16x16x32_bf16 v[212:215], v[16:19], v[44:47], v[212:215]
    ds_read_b64_tr_b16 v[100:101], v112 offset:8192
    v_mfma_f32_16x16x32_bf16 v[216:219], v[16:19], v[48:51], v[216:219]
    ds_read_b64_tr_b16 v[102:103], v112 offset:9216
    v_mfma_f32_16x16x32_bf16 v[220:223], v[16:19], v[52:55], v[220:223]
    v_mfma_f32_16x16x32_bf16 v[252:255], v[20:23], v[52:55], v[252:255]
    v_mfma_f32_16x16x32_bf16 v[248:251], v[20:23], v[48:51], v[248:251]
    v_mfma_f32_16x16x32_bf16 v[244:247], v[20:23], v[44:47], v[244:247]
    v_mfma_f32_16x16x32_bf16 v[240:243], v[20:23], v[40:43], v[240:243]
    v_mfma_f32_16x16x32_bf16 v[236:239], v[20:23], v[36:39], v[236:239]
    v_mfma_f32_16x16x32_bf16 v[232:235], v[20:23], v[32:35], v[232:235]
    v_mfma_f32_16x16x32_bf16 v[228:231], v[20:23], v[28:31], v[228:231]
    v_mfma_f32_16x16x32_bf16 v[224:227], v[20:23], v[24:27], v[224:227]
    s_waitcnt lgkmcnt(0)
    s_nop 0
    v_mfma_f32_16x16x32_bf16 v[128:131], v[56:59], v[72:75], v[128:131]
    ds_read_b64_tr_b16 v[24:25], v105 offset:16384
    v_mfma_f32_16x16x32_bf16 v[132:135], v[56:59], v[76:79], v[132:135]
    ds_read_b64_tr_b16 v[26:27], v105 offset:17408
    v_mfma_f32_16x16x32_bf16 v[136:139], v[56:59], v[80:83], v[136:139]
    ds_read_b128 v[8:11], v104 offset:16384
    v_mfma_f32_16x16x32_bf16 v[140:143], v[56:59], v[84:87], v[140:143]
    ds_read_b64_tr_b16 v[28:29], v106 offset:16384
    v_mfma_f32_16x16x32_bf16 v[144:147], v[56:59], v[88:91], v[144:147]
    ds_read_b64_tr_b16 v[30:31], v106 offset:17408
    v_mfma_f32_16x16x32_bf16 v[148:151], v[56:59], v[92:95], v[148:151]
    v_mfma_f32_16x16x32_bf16 v[152:155], v[56:59], v[96:99], v[152:155]
    ds_read_b64_tr_b16 v[32:33], v107 offset:16384
    v_mfma_f32_16x16x32_bf16 v[156:159], v[56:59], v[100:103], v[156:159]
    ds_read_b64_tr_b16 v[34:35], v107 offset:17408
    v_mfma_f32_16x16x32_bf16 v[188:191], v[60:63], v[100:103], v[188:191]
    ds_read_b128 v[12:15], v104 offset:16640
    v_mfma_f32_16x16x32_bf16 v[184:187], v[60:63], v[96:99], v[184:187]
    ds_read_b64_tr_b16 v[36:37], v108 offset:16384
    v_mfma_f32_16x16x32_bf16 v[180:183], v[60:63], v[92:95], v[180:183]
    ds_read_b64_tr_b16 v[38:39], v108 offset:17408
    v_mfma_f32_16x16x32_bf16 v[176:179], v[60:63], v[88:91], v[176:179]
    v_mfma_f32_16x16x32_bf16 v[172:175], v[60:63], v[84:87], v[172:175]
    ds_read_b64_tr_b16 v[40:41], v109 offset:16384
    v_mfma_f32_16x16x32_bf16 v[168:171], v[60:63], v[80:83], v[168:171]
    ds_read_b64_tr_b16 v[42:43], v109 offset:17408
    v_mfma_f32_16x16x32_bf16 v[164:167], v[60:63], v[76:79], v[164:167]
    ds_read_b128 v[16:19], v104 offset:16896
    v_mfma_f32_16x16x32_bf16 v[160:163], v[60:63], v[72:75], v[160:163]
    ds_read_b64_tr_b16 v[44:45], v110 offset:16384
    v_mfma_f32_16x16x32_bf16 v[192:195], v[64:67], v[72:75], v[192:195]
    ds_read_b64_tr_b16 v[46:47], v110 offset:17408
    v_mfma_f32_16x16x32_bf16 v[196:199], v[64:67], v[76:79], v[196:199]
    v_mfma_f32_16x16x32_bf16 v[200:203], v[64:67], v[80:83], v[200:203]
    ds_read_b64_tr_b16 v[48:49], v111 offset:16384
    v_mfma_f32_16x16x32_bf16 v[204:207], v[64:67], v[84:87], v[204:207]
    ds_read_b64_tr_b16 v[50:51], v111 offset:17408
    v_mfma_f32_16x16x32_bf16 v[208:211], v[64:67], v[88:91], v[208:211]
    ds_read_b128 v[20:23], v104 offset:17152
    v_mfma_f32_16x16x32_bf16 v[212:215], v[64:67], v[92:95], v[212:215]
    ds_read_b64_tr_b16 v[52:53], v112 offset:16384
    v_mfma_f32_16x16x32_bf16 v[216:219], v[64:67], v[96:99], v[216:219]
    ds_read_b64_tr_b16 v[54:55], v112 offset:17408
    v_mfma_f32_16x16x32_bf16 v[220:223], v[64:67], v[100:103], v[220:223]
    v_mfma_f32_16x16x32_bf16 v[252:255], v[68:71], v[100:103], v[252:255]
    v_mfma_f32_16x16x32_bf16 v[248:251], v[68:71], v[96:99], v[248:251]
    v_mfma_f32_16x16x32_bf16 v[244:247], v[68:71], v[92:95], v[244:247]
    v_mfma_f32_16x16x32_bf16 v[240:243], v[68:71], v[88:91], v[240:243]
    v_mfma_f32_16x16x32_bf16 v[236:239], v[68:71], v[84:87], v[236:239]
    v_mfma_f32_16x16x32_bf16 v[232:235], v[68:71], v[80:83], v[232:235]
    v_mfma_f32_16x16x32_bf16 v[228:231], v[68:71], v[76:79], v[228:231]
    v_mfma_f32_16x16x32_bf16 v[224:227], v[68:71], v[72:75], v[224:227]
    s_waitcnt lgkmcnt(0)
    s_barrier
    v_mfma_f32_16x16x32_bf16 v[128:131], v[8:11], v[24:27], v[128:131]
    ds_read_b64_tr_b16 v[72:73], v105 offset:24576
    v_mfma_f32_16x16x32_bf16 v[132:135], v[8:11], v[28:31], v[132:135]
    ds_read_b64_tr_b16 v[74:75], v105 offset:25600
    v_mfma_f32_16x16x32_bf16 v[136:139], v[8:11], v[32:35], v[136:139]
    ds_read_b128 v[56:59], v104 offset:24576
    v_mfma_f32_16x16x32_bf16 v[140:143], v[8:11], v[36:39], v[140:143]
    ds_read_b64_tr_b16 v[76:77], v106 offset:24576
    v_mfma_f32_16x16x32_bf16 v[144:147], v[8:11], v[40:43], v[144:147]
    ds_read_b64_tr_b16 v[78:79], v106 offset:25600
    v_mfma_f32_16x16x32_bf16 v[148:151], v[8:11], v[44:47], v[148:151]
    v_mfma_f32_16x16x32_bf16 v[152:155], v[8:11], v[48:51], v[152:155]
    ds_read_b64_tr_b16 v[80:81], v107 offset:24576
    v_mfma_f32_16x16x32_bf16 v[156:159], v[8:11], v[52:55], v[156:159]
    ds_read_b64_tr_b16 v[82:83], v107 offset:25600
    v_mfma_f32_16x16x32_bf16 v[188:191], v[12:15], v[52:55], v[188:191]
    ds_read_b128 v[60:63], v104 offset:24832
    v_mfma_f32_16x16x32_bf16 v[184:187], v[12:15], v[48:51], v[184:187]
    ds_read_b64_tr_b16 v[84:85], v108 offset:24576
    v_mfma_f32_16x16x32_bf16 v[180:183], v[12:15], v[44:47], v[180:183]
    ds_read_b64_tr_b16 v[86:87], v108 offset:25600
    v_mfma_f32_16x16x32_bf16 v[176:179], v[12:15], v[40:43], v[176:179]
    v_mfma_f32_16x16x32_bf16 v[172:175], v[12:15], v[36:39], v[172:175]
    ds_read_b64_tr_b16 v[88:89], v109 offset:24576
    v_mfma_f32_16x16x32_bf16 v[168:171], v[12:15], v[32:35], v[168:171]
    ds_read_b64_tr_b16 v[90:91], v109 offset:25600
    v_mfma_f32_16x16x32_bf16 v[164:167], v[12:15], v[28:31], v[164:167]
    ds_read_b128 v[64:67], v104 offset:25088
    v_mfma_f32_16x16x32_bf16 v[160:163], v[12:15], v[24:27], v[160:163]
    ds_read_b64_tr_b16 v[92:93], v110 offset:24576
    v_mfma_f32_16x16x32_bf16 v[192:195], v[16:19], v[24:27], v[192:195]
    ds_read_b64_tr_b16 v[94:95], v110 offset:25600
    v_mfma_f32_16x16x32_bf16 v[196:199], v[16:19], v[28:31], v[196:199]
    v_mfma_f32_16x16x32_bf16 v[200:203], v[16:19], v[32:35], v[200:203]
    ds_read_b64_tr_b16 v[96:97], v111 offset:24576
    v_mfma_f32_16x16x32_bf16 v[204:207], v[16:19], v[36:39], v[204:207]
    ds_read_b64_tr_b16 v[98:99], v111 offset:25600
    v_mfma_f32_16x16x32_bf16 v[208:211], v[16:19], v[40:43], v[208:211]
    ds_read_b128 v[68:71], v104 offset:25344
    v_mfma_f32_16x16x32_bf16 v[212:215], v[16:19], v[44:47], v[212:215]
    ds_read_b64_tr_b16 v[100:101], v112 offset:24576
    v_mfma_f32_16x16x32_bf16 v[216:219], v[16:19], v[48:51], v[216:219]
    ds_read_b64_tr_b16 v[102:103], v112 offset:25600
    v_mfma_f32_16x16x32_bf16 v[220:223], v[16:19], v[52:55], v[220:223]
    v_mfma_f32_16x16x32_bf16 v[252:255], v[20:23], v[52:55], v[252:255]
    v_mfma_f32_16x16x32_bf16 v[248:251], v[20:23], v[48:51], v[248:251]
    v_mfma_f32_16x16x32_bf16 v[244:247], v[20:23], v[44:47], v[244:247]
    v_mfma_f32_16x16x32_bf16 v[240:243], v[20:23], v[40:43], v[240:243]
    v_mfma_f32_16x16x32_bf16 v[236:239], v[20:23], v[36:39], v[236:239]
    v_mfma_f32_16x16x32_bf16 v[232:235], v[20:23], v[32:35], v[232:235]
    v_mfma_f32_16x16x32_bf16 v[228:231], v[20:23], v[28:31], v[228:231]
    v_mfma_f32_16x16x32_bf16 v[224:227], v[20:23], v[24:27], v[224:227]
    s_waitcnt lgkmcnt(0)
    s_nop 0
    v_mfma_f32_16x16x32_bf16 v[128:131], v[56:59], v[72:75], v[128:131]
    v_mfma_f32_16x16x32_bf16 v[132:135], v[56:59], v[76:79], v[132:135]
    v_mfma_f32_16x16x32_bf16 v[136:139], v[56:59], v[80:83], v[136:139]
    v_mfma_f32_16x16x32_bf16 v[140:143], v[56:59], v[84:87], v[140:143]
    v_mfma_f32_16x16x32_bf16 v[144:147], v[56:59], v[88:91], v[144:147]
    v_mfma_f32_16x16x32_bf16 v[148:151], v[56:59], v[92:95], v[148:151]
    v_mfma_f32_16x16x32_bf16 v[152:155], v[56:59], v[96:99], v[152:155]
    v_mfma_f32_16x16x32_bf16 v[156:159], v[56:59], v[100:103], v[156:159]
    v_mfma_f32_16x16x32_bf16 v[188:191], v[60:63], v[100:103], v[188:191]
    v_mfma_f32_16x16x32_bf16 v[184:187], v[60:63], v[96:99], v[184:187]
    v_mfma_f32_16x16x32_bf16 v[180:183], v[60:63], v[92:95], v[180:183]
    v_mfma_f32_16x16x32_bf16 v[176:179], v[60:63], v[88:91], v[176:179]
    v_mfma_f32_16x16x32_bf16 v[172:175], v[60:63], v[84:87], v[172:175]
    v_mfma_f32_16x16x32_bf16 v[168:171], v[60:63], v[80:83], v[168:171]
    v_mfma_f32_16x16x32_bf16 v[164:167], v[60:63], v[76:79], v[164:167]
    v_mfma_f32_16x16x32_bf16 v[160:163], v[60:63], v[72:75], v[160:163]
    v_mfma_f32_16x16x32_bf16 v[192:195], v[64:67], v[72:75], v[192:195]
    v_mfma_f32_16x16x32_bf16 v[196:199], v[64:67], v[76:79], v[196:199]
    v_mfma_f32_16x16x32_bf16 v[200:203], v[64:67], v[80:83], v[200:203]
    v_mfma_f32_16x16x32_bf16 v[204:207], v[64:67], v[84:87], v[204:207]
    v_mfma_f32_16x16x32_bf16 v[208:211], v[64:67], v[88:91], v[208:211]
    v_mfma_f32_16x16x32_bf16 v[212:215], v[64:67], v[92:95], v[212:215]
    v_mfma_f32_16x16x32_bf16 v[216:219], v[64:67], v[96:99], v[216:219]
    v_mfma_f32_16x16x32_bf16 v[220:223], v[64:67], v[100:103], v[220:223]
    v_mfma_f32_16x16x32_bf16 v[252:255], v[68:71], v[100:103], v[252:255]
    v_mfma_f32_16x16x32_bf16 v[248:251], v[68:71], v[96:99], v[248:251]
    v_mfma_f32_16x16x32_bf16 v[244:247], v[68:71], v[92:95], v[244:247]
    v_mfma_f32_16x16x32_bf16 v[240:243], v[68:71], v[88:91], v[240:243]
    v_mfma_f32_16x16x32_bf16 v[236:239], v[68:71], v[84:87], v[236:239]
    v_mfma_f32_16x16x32_bf16 v[232:235], v[68:71], v[80:83], v[232:235]
    v_mfma_f32_16x16x32_bf16 v[228:231], v[68:71], v[76:79], v[228:231]
    v_mfma_f32_16x16x32_bf16 v[224:227], v[68:71], v[72:75], v[224:227]
    s_setprio 0
    v_mov_b32 v5, 0
    v_lshlrev_b32 v7, 4, v2
    s_nop 4
    s_add_u32 s39, s51, 0
    v_cvt_pk_bf16_f32 v8, v128, v129
    v_cvt_pk_bf16_f32 v9, v130, v131
    v_cvt_pk_bf16_f32 v10, v160, v161
    v_cvt_pk_bf16_f32 v11, v162, v163
    buffer_store_dwordx4 v[8:11], v7, s[60:63], s39 offen offset:0 sc1
    v_cvt_pk_bf16_f32 v12, v132, v133
    v_cvt_pk_bf16_f32 v13, v134, v135
    v_cvt_pk_bf16_f32 v14, v164, v165
    v_cvt_pk_bf16_f32 v15, v166, v167
    buffer_store_dwordx4 v[12:15], v7, s[60:63], s39 offen offset:1024 sc1
    v_cvt_pk_bf16_f32 v16, v136, v137
    v_cvt_pk_bf16_f32 v17, v138, v139
    v_cvt_pk_bf16_f32 v18, v168, v169
    v_cvt_pk_bf16_f32 v19, v170, v171
    buffer_store_dwordx4 v[16:19], v7, s[60:63], s39 offen offset:2048 sc1
    v_cvt_pk_bf16_f32 v20, v140, v141
    v_cvt_pk_bf16_f32 v21, v142, v143
    v_cvt_pk_bf16_f32 v22, v172, v173
    v_cvt_pk_bf16_f32 v23, v174, v175
    buffer_store_dwordx4 v[20:23], v7, s[60:63], s39 offen offset:3072 sc1
    s_add_u32 s39, s51, 4096
    v_cvt_pk_bf16_f32 v24, v192, v193
    v_cvt_pk_bf16_f32 v25, v194, v195
    v_cvt_pk_bf16_f32 v26, v224, v225
    v_cvt_pk_bf16_f32 v27, v226, v227
    buffer_store_dwordx4 v[24:27], v7, s[60:63], s39 offen offset:0 sc1
    v_cvt_pk_bf16_f32 v28, v196, v197
    v_cvt_pk_bf16_f32 v29, v198, v199
    v_cvt_pk_bf16_f32 v30, v228, v229
    v_cvt_pk_bf16_f32 v31, v230, v231
    buffer_store_dwordx4 v[28:31], v7, s[60:63], s39 offen offset:1024 sc1
    v_cvt_pk_bf16_f32 v32, v200, v201
    v_cvt_pk_bf16_f32 v33, v202, v203
    v_cvt_pk_bf16_f32 v34, v232, v233
    v_cvt_pk_bf16_f32 v35, v234, v235
    buffer_store_dwordx4 v[32:35], v7, s[60:63], s39 offen offset:2048 sc1
    v_cvt_pk_bf16_f32 v36, v204, v205
    v_cvt_pk_bf16_f32 v37, v206, v207
    v_cvt_pk_bf16_f32 v38, v236, v237
    v_cvt_pk_bf16_f32 v39, v238, v239
    buffer_store_dwordx4 v[36:39], v7, s[60:63], s39 offen offset:3072 sc1
    s_add_u32 s39, s51, 16384
    v_cvt_pk_bf16_f32 v8, v144, v145
    v_cvt_pk_bf16_f32 v9, v146, v147
    v_cvt_pk_bf16_f32 v10, v176, v177
    v_cvt_pk_bf16_f32 v11, v178, v179
    buffer_store_dwordx4 v[8:11], v7, s[60:63], s39 offen offset:0 sc1
    v_cvt_pk_bf16_f32 v12, v148, v149
    v_cvt_pk_bf16_f32 v13, v150, v151
    v_cvt_pk_bf16_f32 v14, v180, v181
    v_cvt_pk_bf16_f32 v15, v182, v183
    buffer_store_dwordx4 v[12:15], v7, s[60:63], s39 offen offset:1024 sc1
    v_cvt_pk_bf16_f32 v16, v152, v153
    v_cvt_pk_bf16_f32 v17, v154, v155
    v_cvt_pk_bf16_f32 v18, v184, v185
    v_cvt_pk_bf16_f32 v19, v186, v187
    buffer_store_dwordx4 v[16:19], v7, s[60:63], s39 offen offset:2048 sc1
    v_cvt_pk_bf16_f32 v20, v156, v157
    v_cvt_pk_bf16_f32 v21, v158, v159
    v_cvt_pk_bf16_f32 v22, v188, v189
    v_cvt_pk_bf16_f32 v23, v190, v191
    buffer_store_dwordx4 v[20:23], v7, s[60:63], s39 offen offset:3072 sc1
    s_add_u32 s39, s51, 20480
    v_cvt_pk_bf16_f32 v24, v208, v209
    v_cvt_pk_bf16_f32 v25, v210, v211
    v_cvt_pk_bf16_f32 v26, v240, v241
    v_cvt_pk_bf16_f32 v27, v242, v243
    buffer_store_dwordx4 v[24:27], v7, s[60:63], s39 offen offset:0 sc1
    v_cvt_pk_bf16_f32 v28, v212, v213
    v_cvt_pk_bf16_f32 v29, v214, v215
    v_cvt_pk_bf16_f32 v30, v244, v245
    v_cvt_pk_bf16_f32 v31, v246, v247
    buffer_store_dwordx4 v[28:31], v7, s[60:63], s39 offen offset:1024 sc1
    v_cvt_pk_bf16_f32 v32, v216, v217
    v_cvt_pk_bf16_f32 v33, v218, v219
    v_cvt_pk_bf16_f32 v34, v248, v249
    v_cvt_pk_bf16_f32 v35, v250, v251
    buffer_store_dwordx4 v[32:35], v7, s[60:63], s39 offen offset:2048 sc1
    v_cvt_pk_bf16_f32 v36, v220, v221
    v_cvt_pk_bf16_f32 v37, v222, v223
    v_cvt_pk_bf16_f32 v38, v252, v253
    v_cvt_pk_bf16_f32 v39, v254, v255
    buffer_store_dwordx4 v[36:39], v7, s[60:63], s39 offen offset:3072 sc1
    s_waitcnt vmcnt(0)
    v_mov_b32 v6, s3
    s_mov_b64 exec, 1
    buffer_store_dword v6, v5, s[24:27], s50 offen sc1
    s_mov_b64 exec, -1
    s_endpgm
L_a:
    s_mov_b32 s8, s36
    s_and_b32 s9, s37, 0xffff
    s_mov_b32 s10, 0x400000
    s_mov_b32 s11, 0x00020000
    s_mov_b32 s12, s38
    s_and_b32 s13, s39, 0xffff
    s_mov_b32 s14, 0x600000
    s_mov_b32 s15, 0x00020000
    s_add_u32 s16, s34, 0x1000000
    s_addc_u32 s17, s35, 0
    s_and_b32 s17, s17, 0xffff
    s_mov_b32 s18, 0x400000
    s_mov_b32 s19, 0x00020000
    s_mov_b32 s20, s40
    s_and_b32 s21, s41, 0xffff
    s_mov_b32 s22, 0xe00000
    s_mov_b32 s23, 0x00020000
    s_mov_b32 s24, s6
    s_and_b32 s25, s7, 0xffff
    s_mov_b32 s26, 0xe00000
    s_mov_b32 s27, 0x00020000
    s_mov_b32 s48, s4
    s_and_b32 s49, s5, 0xffff
    s_mov_b32 s50, 0x200000
    s_mov_b32 s51, 0x00020000
    s_lshl_b32 s36, s32, 12
    s_lshl_b32 s37, s33, 7
    v_lshrrev_b32 v5, 2, v4
    v_lshl_add_u32 v6, v3, 3, v5
    v_mul_u32_u24 v6, 384, v6
    v_and_b32 v7, 3, v4
    v_lshl_add_u32 v6, v7, 3, v6
    v_lshrrev_b32 v5, 3, v4
    v_and_b32 v7, 1, v3
    v_lshl_or_b32 v5, v7, 1, v5
    s_cmp_lt_u32 s31, 4
    s_cbranch_scc1 L_q_cons
    s_sub_u32 s39, s31, 4
    s_lshr_b32 s46, s39, 1
    s_and_b32 s47, s39, 1
    s_lshl_b32 s38, s46, 1
    s_add_u32 s40, s38, 0
    v_xor_b32 v7, s40, v5
    v_lshl_add_u32 v7, v7, 5, v6
    s_lshl_b32 s40, s47, 7
    s_add_u32 s40, s40, 17536
    v_add_u32 v20, s40, v7
    v_add_u32 v23, 59392, v20
    v_add_u32 v26, 118784, v20
    s_add_u32 s40, s38, 1
    v_xor_b32 v7, s40, v5
    v_lshl_add_u32 v7, v7, 5, v6
    s_lshl_b32 s40, s47, 7
    s_add_u32 s40, s40, 17536
    v_add_u32 v21, s40, v7
    v_add_u32 v24, 59392, v21
    v_add_u32 v27, 118784, v21
    v_lshrrev_b32 v7, 1, v4
    v_and_b32 v7, 3, v7
    v_xor_b32 v7, v7, v3
    v_lshlrev_b32 v7, 4, v7
    v_lshl_add_u32 v7, v4, 6, v7
    v_add_u32 v22, 16384, v7
    v_add_u32 v25, 75776, v7
    v_add_u32 v28, 135168, v7
    v_mov_b32 v48, 0
    v_mov_b32 v49, 0
    v_mov_b32 v50, 0
    v_mov_b32 v51, 0
    v_mov_b32 v52, 0
    v_mov_b32 v53, 0
    v_mov_b32 v54, 0
    v_mov_b32 v55, 0
    v_lshrrev_b32 v13, 3, v2
    v_xor_b32 v13, v13, v2
    v_and_b32 v13, 3, v13
    v_lshlrev_b32 v13, 4, v13
    v_lshrrev_b32 v14, 2, v2
    v_lshl_add_u32 v13, v14, 11, v13
    s_lshl_b32 s38, s32, 19
    s_lshl_b32 s40, s39, 17
    s_add_u32 s40, s40, s38
    v_add_u32 v8, s40, v13
    v_add_u32 v57, 31744, v8
    v_add_u32 v58, 63488, v8
    v_add_u32 v59, 95232, v8
    s_lshl_b32 s40, s39, 2
    v_add_u32 v14, s40, v3
    v_lshrrev_b32 v15, 1, v14
    v_lshrrev_b32 v9, 2, v4
    v_xor_b32 v15, v15, v9
    v_and_b32 v15, 3, v15
    v_lshlrev_b32 v15, 4, v15
    v_and_b32 v9, 3, v4
    v_lshl_add_u32 v15, v9, 2, v15
    v_lshl_add_u32 v15, v14, 11, v15
    s_sub_u32 s38, s38, 32768
    s_max_i32 s38, s38, 0
    v_add_u32 v9, s38, v15
    s_mul_i32 s41, s39, 49152
    s_add_u32 s41, s41, s37
    s_and_b32 s40, s39, 1
    s_lshl_b32 s40, s40, 1
    v_add_u32 v13, 0, v2
    v_mul_u32_u24 v14, 171, v13
    v_lshrrev_b32 v14, 12, v14
    v_mul_u32_u24 v15, 24, v14
    v_sub_u32 v13, v13, v15
    v_lshrrev_b32 v15, 1, v14
    v_and_b32 v15, 1, v15
    v_or_b32 v15, s40, v15
    v_lshlrev_b32 v15, 1, v15
    v_xor_b32 v13, v13, v15
    v_lshrrev_b32 v15, 3, v13
    v_and_b32 v13, 7, v13
    v_lshlrev_b32 v13, 4, v13
    v_lshl_add_u32 v13, v15, 11, v13
    v_mul_u32_u24 v14, 6144, v14
    v_add3_u32 v13, v13, v14, s41
    v_subrev_u32 v10, 0, v13
    v_add_u32 v13, 64, v2
    v_mul_u32_u24 v14, 171, v13
    v_lshrrev_b32 v14, 12, v14
    v_mul_u32_u24 v15, 24, v14
    v_sub_u32 v13, v13, v15
    v_lshrrev_b32 v15, 1, v14
    v_and_b32 v15, 1, v15
    v_or_b32 v15, s40, v15
    v_lshlrev_b32 v15, 1, v15
    v_xor_b32 v13, v13, v15
    v_lshrrev_b32 v15, 3, v13
    v_and_b32 v13, 7, v13
    v_lshlrev_b32 v13, 4, v13
    v_lshl_add_u32 v13, v15, 11, v13
    v_mul_u32_u24 v14, 6144, v14
    v_add3_u32 v13, v13, v14, s41
    v_subrev_u32 v11, 1024, v13
    v_add_u32 v13, 128, v2
    v_mul_u32_u24 v14, 171, v13
    v_lshrrev_b32 v14, 12, v14
    v_mul_u32_u24 v15, 24, v14
    v_sub_u32 v13, v13, v15
    v_lshrrev_b32 v15, 1, v14
    v_and_b32 v15, 1, v15
    v_or_b32 v15, s40, v15
    v_lshlrev_b32 v15, 1, v15
    v_xor_b32 v13, v13, v15
    v_lshrrev_b32 v15, 3, v13
    v_and_b32 v13, 7, v13
    v_lshlrev_b32 v13, 4, v13
    v_lshl_add_u32 v13, v15, 11, v13
    v_mul_u32_u24 v14, 6144, v14
    v_add3_u32 v13, v13, v14, s41
    v_subrev_u32 v12, 2048, v13
    s_lshl_b32 s44, s39, 12
    s_mul_i32 s45, s39, 3072
    s_add_u32 s45, s45, 17408
    s_lshl_b32 s43, s39, 8
    s_add_u32 s43, s43, 16384
    s_mov_b32 s28, 0
    s_mov_b32 s29, 0
    s_lshl_b32 s38, s32, 4
    s_add_u32 s38, s38, s33
    s_lshl_b32 s38, s38, 2
    s_add_u32 s38, s38, s39
    s_lshl_b32 s38, s38, 13
    v_lshlrev_b32 v16, 7, v2
    v_add_u32 v16, s38, v16
    s_add_u32 m0, s44, 0
    s_nop 0
    buffer_load_dwordx4 v8, s[8:11], s28 offen lds
    buffer_load_dwordx4 v57, s[8:11], s28 offen offset:1024 lds
    buffer_load_dwordx4 v58, s[8:11], s28 offen offset:2048 lds
    buffer_load_dwordx4 v59, s[8:11], s28 offen offset:3072 lds
    s_add_u32 m0, s43, 0
    s_nop 0
    buffer_load_dword v9, s[8:11], s28 offen lds
    s_add_u32 m0, s45, 0
    s_add_u32 s28, s28, 64
    buffer_load_dwordx4 v10, s[12:15], s29 offen lds
    buffer_load_dwordx4 v11, s[12:15], s29 offen offset:1024 lds
    buffer_load_dwordx4 v12, s[12:15], s29 offen offset:2048 lds
    s_add_u32 s29, s29, 196608
    s_add_u32 m0, s44, 29696
    s_nop 0
    buffer_load_dwordx4 v8, s[8:11], s28 offen lds
    buffer_load_dwordx4 v57, s[8:11], s28 offen offset:1024 lds
    buffer_load_dwordx4 v58, s[8:11], s28 offen offset:2048 lds
    buffer_load_dwordx4 v59, s[8:11], s28 offen offset:3072 lds
    s_add_u32 m0, s43, 29696
    s_nop 0
    buffer_load_dword v9, s[8:11], s28 offen lds
    s_add_u32 m0, s45, 29696
    s_add_u32 s28, s28, 64
    buffer_load_dwordx4 v10, s[12:15], s29 offen lds
    buffer_load_dwordx4 v11, s[12:15], s29 offen offset:1024 lds
    buffer_load_dwordx4 v12, s[12:15], s29 offen offset:2048 lds
    s_add_u32 s29, s29, 196608
    s_add_u32 m0, s44, 59392
    s_nop 0
    buffer_load_dwordx4 v8, s[8:11], s28 offen lds
    buffer_load_dwordx4 v57, s[8:11], s28 offen offset:1024 lds
    buffer_load_dwordx4 v58, s[8:11], s28 offen offset:2048 lds
    buffer_load_dwordx4 v59, s[8:11], s28 offen offset:3072 lds
    s_add_u32 m0, s43, 59392
    s_nop 0
    buffer_load_dword v9, s[8:11], s28 offen lds
    s_add_u32 m0, s45, 59392
    s_add_u32 s28, s28, 64
    buffer_load_dwordx4 v10, s[12:15], s29 offen lds
    buffer_load_dwordx4 v11, s[12:15], s29 offen offset:1024 lds
    buffer_load_dwordx4 v12, s[12:15], s29 offen offset:2048 lds
    s_add_u32 s29, s29, 196608
    s_add_u32 m0, s44, 89088
    s_nop 0
    buffer_load_dwordx4 v8, s[8:11], s28 offen lds
    buffer_load_dwordx4 v57, s[8:11], s28 offen offset:1024 lds
    buffer_load_dwordx4 v58, s[8:11], s28 offen offset:2048 lds
    buffer_load_dwordx4 v59, s[8:11], s28 offen offset:3072 lds
    s_add_u32 m0, s43, 89088
    s_nop 0
    buffer_load_dword v9, s[8:11], s28 offen lds
    s_add_u32 m0, s45, 89088
    s_add_u32 s28, s28, 64
    buffer_load_dwordx4 v10, s[12:15], s29 offen lds
    buffer_load_dwordx4 v11, s[12:15], s29 offen offset:1024 lds
    buffer_load_dwordx4 v12, s[12:15], s29 offen offset:2048 lds
    s_add_u32 s29, s29, 196608
    s_add_u32 m0, s44, 118784
    s_nop 0
    buffer_load_dwordx4 v8, s[8:11], s28 offen lds
    buffer_load_dwordx4 v57, s[8:11], s28 offen offset:1024 lds
    buffer_load_dwordx4 v58, s[8:11], s28 offen offset:2048 lds
    buffer_load_dwordx4 v59, s[8:11], s28 offen offset:3072 lds
    s_add_u32 m0, s43, 118784
    s_nop 0
    buffer_load_dword v9, s[8:11], s28 offen lds
    s_add_u32 m0, s45, 118784
    s_add_u32 s28, s28, 64
    buffer_load_dwordx4 v10, s[12:15], s29 offen lds
    buffer_load_dwordx4 v11, s[12:15], s29 offen offset:1024 lds
    buffer_load_dwordx4 v12, s[12:15], s29 offen offset:2048 lds
    s_add_u32 s29, s29, 196608
    s_mov_b32 s38, 0xf0000
    buffer_load_dword v250, v16, s[12:15], s38 offen
    s_mov_b32 s38, 0x4f0000
    buffer_load_dword v250, v16, s[12:15], s38 offen
    s_waitcnt vmcnt(34)
    s_barrier
    ds_read_b128 v[32:35], v22 offset:0
    ds_read_b64_tr_b16 v[36:37], v20 offset:0
    ds_read_b64_tr_b16 v[38:39], v20 offset:1536
    ds_read_b64_tr_b16 v[40:41], v21 offset:0
    ds_read_b64_tr_b16 v[42:43], v21 offset:1536
    s_waitcnt lgkmcnt(0)
    v_mfma_f32_16x16x32_bf16 v[48:51], v[36:39], v[32:35], v[48:51]
    v_mfma_f32_16x16x32_bf16 v[52:55], v[40:43], v[32:35], v[52:55]
    s_waitcnt vmcnt(26)
    s_barrier
    s_add_u32 m0, s44, 0
    s_nop 0
    buffer_load_dwordx4 v8, s[8:11], s28 offen lds
    buffer_load_dwordx4 v57, s[8:11], s28 offen offset:1024 lds
    buffer_load_dwordx4 v58, s[8:11], s28 offen offset:2048 lds
    buffer_load_dwordx4 v59, s[8:11], s28 offen offset:3072 lds
    s_add_u32 m0, s43, 0
    s_nop 0
    buffer_load_dword v9, s[8:11], s28 offen lds
    s_add_u32 m0, s45, 0
    s_add_u32 s28, s28, 64
    buffer_load_dwordx4 v10, s[12:15], s29 offen lds
    buffer_load_dwordx4 v11, s[12:15], s29 offen offset:1024 lds
    buffer_load_dwordx4 v12, s[12:15], s29 offen offset:2048 lds
    s_add_u32 s29, s29, 196608
    ds_read_b128 v[32:35], v22 offset:29696
    ds_read_b64_tr_b16 v[36:37], v20 offset:29696
    ds_read_b64_tr_b16 v[38:39], v20 offset:31232
    ds_read_b64_tr_b16 v[40:41], v21 offset:29696
    ds_read_b64_tr_b16 v[42:43], v21 offset:31232
    s_waitcnt lgkmcnt(0)
    v_mfma_f32_16x16x32_bf16 v[48:51], v[36:39], v[32:35], v[48:51]
    v_mfma_f32_16x16x32_bf16 v[52:55], v[40:43], v[32:35], v[52:55]
    s_waitcnt vmcnt(26)
    s_barrier
    s_add_u32 m0, s44, 29696
    s_nop 0
    buffer_load_dwordx4 v8, s[8:11], s28 offen lds
    buffer_load_dwordx4 v57, s[8:11], s28 offen offset:1024 lds
    buffer_load_dwordx4 v58, s[8:11], s28 offen offset:2048 lds
    buffer_load_dwordx4 v59, s[8:11], s28 offen offset:3072 lds
    s_add_u32 m0, s43, 29696
    s_nop 0
    buffer_load_dword v9, s[8:11], s28 offen lds
    s_add_u32 m0, s45, 29696
    s_add_u32 s28, s28, 64
    buffer_load_dwordx4 v10, s[12:15], s29 offen lds
    buffer_load_dwordx4 v11, s[12:15], s29 offen offset:1024 lds
    buffer_load_dwordx4 v12, s[12:15], s29 offen offset:2048 lds
    s_add_u32 s29, s29, 196608
    ds_read_b128 v[32:35], v25 offset:0
    ds_read_b64_tr_b16 v[36:37], v23 offset:0
    ds_read_b64_tr_b16 v[38:39], v23 offset:1536
    ds_read_b64_tr_b16 v[40:41], v24 offset:0
    ds_read_b64_tr_b16 v[42:43], v24 offset:1536
    s_waitcnt lgkmcnt(0)
    v_mfma_f32_16x16x32_bf16 v[48:51], v[36:39], v[32:35], v[48:51]
    v_mfma_f32_16x16x32_bf16 v[52:55], v[40:43], v[32:35], v[52:55]
    s_waitcnt vmcnt(26)
    s_barrier
    s_add_u32 m0, s44, 59392
    s_nop 0
    buffer_load_dwordx4 v8, s[8:11], s28 offen lds
    buffer_load_dwordx4 v57, s[8:11], s28 offen offset:1024 lds
    buffer_load_dwordx4 v58, s[8:11], s28 offen offset:2048 lds
    buffer_load_dwordx4 v59, s[8:11], s28 offen offset:3072 lds
    s_add_u32 m0, s43, 59392
    s_nop 0
    buffer_load_dword v9, s[8:11], s28 offen lds
    s_add_u32 m0, s45, 59392
    s_add_u32 s28, s28, 64
    buffer_load_dwordx4 v10, s[12:15], s29 offen lds
    buffer_load_dwordx4 v11, s[12:15], s29 offen offset:1024 lds
    buffer_load_dwordx4 v12, s[12:15], s29 offen offset:2048 lds
    s_add_u32 s29, s29, 196608
    ds_read_b128 v[32:35], v25 offset:29696
    ds_read_b64_tr_b16 v[36:37], v23 offset:29696
    ds_read_b64_tr_b16 v[38:39], v23 offset:31232
    ds_read_b64_tr_b16 v[40:41], v24 offset:29696
    ds_read_b64_tr_b16 v[42:43], v24 offset:31232
    s_waitcnt lgkmcnt(0)
    v_mfma_f32_16x16x32_bf16 v[48:51], v[36:39], v[32:35], v[48:51]
    v_mfma_f32_16x16x32_bf16 v[52:55], v[40:43], v[32:35], v[52:55]
    s_waitcnt vmcnt(26)
    s_barrier
    s_add_u32 m0, s44, 89088
    s_nop 0
    buffer_load_dwordx4 v8, s[8:11], s28 offen lds
    buffer_load_dwordx4 v57, s[8:11], s28 offen offset:1024 lds
    buffer_load_dwordx4 v58, s[8:11], s28 offen offset:2048 lds
    buffer_load_dwordx4 v59, s[8:11], s28 offen offset:3072 lds
    s_add_u32 m0, s43, 89088
    s_nop 0
    buffer_load_dword v9, s[8:11], s28 offen lds
    s_add_u32 m0, s45, 89088
    s_add_u32 s28, s28, 64
    buffer_load_dwordx4 v10, s[12:15], s29 offen lds
    buffer_load_dwordx4 v11, s[12:15], s29 offen offset:1024 lds
    buffer_load_dwordx4 v12, s[12:15], s29 offen offset:2048 lds
    s_add_u32 s29, s29, 196608
    ds_read_b128 v[32:35], v28 offset:0
    ds_read_b64_tr_b16 v[36:37], v26 offset:0
    ds_read_b64_tr_b16 v[38:39], v26 offset:1536
    ds_read_b64_tr_b16 v[40:41], v27 offset:0
    ds_read_b64_tr_b16 v[42:43], v27 offset:1536
    s_waitcnt lgkmcnt(0)
    v_mfma_f32_16x16x32_bf16 v[48:51], v[36:39], v[32:35], v[48:51]
    v_mfma_f32_16x16x32_bf16 v[52:55], v[40:43], v[32:35], v[52:55]
    s_waitcnt vmcnt(24)
    s_barrier
    s_add_u32 m0, s44, 118784
    s_nop 0
    buffer_load_dwordx4 v8, s[8:11], s28 offen lds
    buffer_load_dwordx4 v57, s[8:11], s28 offen offset:1024 lds
    buffer_load_dwordx4 v58, s[8:11], s28 offen offset:2048 lds
    buffer_load_dwordx4 v59, s[8:11], s28 offen offset:3072 lds
    s_add_u32 m0, s43, 118784
    s_nop 0
    buffer_load_dword v9, s[8:11], s28 offen lds
    s_add_u32 m0, s45, 118784
    s_add_u32 s28, s28, 64
    buffer_load_dwordx4 v10, s[12:15], s29 offen lds
    buffer_load_dwordx4 v11, s[12:15], s29 offen offset:1024 lds
    buffer_load_dwordx4 v12, s[12:15], s29 offen offset:2048 lds
    s_add_u32 s29, s29, 196608
    ds_read_b128 v[32:35], v22 offset:0
    ds_read_b64_tr_b16 v[36:37], v20 offset:0
    ds_read_b64_tr_b16 v[38:39], v20 offset:1536
    ds_read_b64_tr_b16 v[40:41], v21 offset:0
    ds_read_b64_tr_b16 v[42:43], v21 offset:1536
    s_waitcnt lgkmcnt(0)
    v_mfma_f32_16x16x32_bf16 v[48:51], v[36:39], v[32:35], v[48:51]
    v_mfma_f32_16x16x32_bf16 v[52:55], v[40:43], v[32:35], v[52:55]
    s_waitcnt vmcnt(24)
    s_barrier
    s_add_u32 m0, s44, 0
    s_nop 0
    buffer_load_dwordx4 v8, s[8:11], s28 offen lds
    buffer_load_dwordx4 v57, s[8:11], s28 offen offset:1024 lds
    buffer_load_dwordx4 v58, s[8:11], s28 offen offset:2048 lds
    buffer_load_dwordx4 v59, s[8:11], s28 offen offset:3072 lds
    s_add_u32 m0, s43, 0
    s_nop 0
    buffer_load_dword v9, s[8:11], s28 offen lds
    s_add_u32 m0, s45, 0
    s_add_u32 s28, s28, 64
    buffer_load_dwordx4 v10, s[12:15], s29 offen lds
    buffer_load_dwordx4 v11, s[12:15], s29 offen offset:1024 lds
    buffer_load_dwordx4 v12, s[12:15], s29 offen offset:2048 lds
    s_add_u32 s29, s29, 196608
    ds_read_b128 v[32:35], v22 offset:29696
    ds_read_b64_tr_b16 v[36:37], v20 offset:29696
    ds_read_b64_tr_b16 v[38:39], v20 offset:31232
    ds_read_b64_tr_b16 v[40:41], v21 offset:29696
    ds_read_b64_tr_b16 v[42:43], v21 offset:31232
    s_waitcnt lgkmcnt(0)
    v_mfma_f32_16x16x32_bf16 v[48:51], v[36:39], v[32:35], v[48:51]
    v_mfma_f32_16x16x32_bf16 v[52:55], v[40:43], v[32:35], v[52:55]
    s_waitcnt vmcnt(24)
    s_barrier
    s_add_u32 m0, s44, 29696
    s_nop 0
    buffer_load_dwordx4 v8, s[8:11], s28 offen lds
    buffer_load_dwordx4 v57, s[8:11], s28 offen offset:1024 lds
    buffer_load_dwordx4 v58, s[8:11], s28 offen offset:2048 lds
    buffer_load_dwordx4 v59, s[8:11], s28 offen offset:3072 lds
    s_add_u32 m0, s43, 29696
    s_nop 0
    buffer_load_dword v9, s[8:11], s28 offen lds
    s_add_u32 m0, s45, 29696
    s_add_u32 s28, s28, 64
    buffer_load_dwordx4 v10, s[12:15], s29 offen lds
    buffer_load_dwordx4 v11, s[12:15], s29 offen offset:1024 lds
    buffer_load_dwordx4 v12, s[12:15], s29 offen offset:2048 lds
    s_add_u32 s29, s29, 196608
    ds_read_b128 v[32:35], v25 offset:0
    ds_read_b64_tr_b16 v[36:37], v23 offset:0
    ds_read_b64_tr_b16 v[38:39], v23 offset:1536
    ds_read_b64_tr_b16 v[40:41], v24 offset:0
    ds_read_b64_tr_b16 v[42:43], v24 offset:1536
    s_waitcnt lgkmcnt(0)
    v_mfma_f32_16x16x32_bf16 v[48:51], v[36:39], v[32:35], v[48:51]
    v_mfma_f32_16x16x32_bf16 v[52:55], v[40:43], v[32:35], v[52:55]
    s_waitcnt vmcnt(24)
    s_barrier
    s_add_u32 m0, s44, 59392
    s_nop 0
    buffer_load_dwordx4 v8, s[8:11], s28 offen lds
    buffer_load_dwordx4 v57, s[8:11], s28 offen offset:1024 lds
    buffer_load_dwordx4 v58, s[8:11], s28 offen offset:2048 lds
    buffer_load_dwordx4 v59, s[8:11], s28 offen offset:3072 lds
    s_add_u32 m0, s43, 59392
    s_nop 0
    buffer_load_dword v9, s[8:11], s28 offen lds
    s_add_u32 m0, s45, 59392
    s_add_u32 s28, s28, 64
    buffer_load_dwordx4 v10, s[12:15], s29 offen lds
    buffer_load_dwordx4 v11, s[12:15], s29 offen offset:1024 lds
    buffer_load_dwordx4 v12, s[12:15], s29 offen offset:2048 lds
    s_add_u32 s29, s29, 196608
    ds_read_b128 v[32:35], v25 offset:29696
    ds_read_b64_tr_b16 v[36:37], v23 offset:29696
    ds_read_b64_tr_b16 v[38:39], v23 offset:31232
    ds_read_b64_tr_b16 v[40:41], v24 offset:29696
    ds_read_b64_tr_b16 v[42:43], v24 offset:31232
    s_waitcnt lgkmcnt(0)
    v_mfma_f32_16x16x32_bf16 v[48:51], v[36:39], v[32:35], v[48:51]
    v_mfma_f32_16x16x32_bf16 v[52:55], v[40:43], v[32:35], v[52:55]
    s_waitcnt vmcnt(24)
    s_barrier
    s_add_u32 m0, s44, 89088
    s_nop 0
    buffer_load_dwordx4 v8, s[8:11], s28 offen lds
    buffer_load_dwordx4 v57, s[8:11], s28 offen offset:1024 lds
    buffer_load_dwordx4 v58, s[8:11], s28 offen offset:2048 lds
    buffer_load_dwordx4 v59, s[8:11], s28 offen offset:3072 lds
    s_add_u32 m0, s43, 89088
    s_nop 0
    buffer_load_dword v9, s[8:11], s28 offen lds
    s_add_u32 m0, s45, 89088
    s_add_u32 s28, s28, 64
    buffer_load_dwordx4 v10, s[12:15], s29 offen lds
    buffer_load_dwordx4 v11, s[12:15], s29 offen offset:1024 lds
    buffer_load_dwordx4 v12, s[12:15], s29 offen offset:2048 lds
    s_add_u32 s29, s29, 196608
    ds_read_b128 v[32:35], v28 offset:0
    ds_read_b64_tr_b16 v[36:37], v26 offset:0
    ds_read_b64_tr_b16 v[38:39], v26 offset:1536
    ds_read_b64_tr_b16 v[40:41], v27 offset:0
    ds_read_b64_tr_b16 v[42:43], v27 offset:1536
    s_waitcnt lgkmcnt(0)
    v_mfma_f32_16x16x32_bf16 v[48:51], v[36:39], v[32:35], v[48:51]
    v_mfma_f32_16x16x32_bf16 v[52:55], v[40:43], v[32:35], v[52:55]
    s_waitcnt vmcnt(24)
    s_barrier
    s_add_u32 m0, s44, 118784
    s_nop 0
    buffer_load_dwordx4 v8, s[8:11], s28 offen lds
    buffer_load_dwordx4 v57, s[8:11], s28 offen offset:1024 lds
    buffer_load_dwordx4 v58, s[8:11], s28 offen offset:2048 lds
    buffer_load_dwordx4 v59, s[8:11], s28 offen offset:3072 lds
    s_add_u32 m0, s43, 118784
    s_nop 0
    buffer_load_dword v9, s[8:11], s28 offen lds
    s_add_u32 m0, s45, 118784
    s_add_u32 s28, s28, 64
    buffer_load_dwordx4 v10, s[12:15], s29 offen lds
    buffer_load_dwordx4 v11, s[12:15], s29 offen offset:1024 lds
    buffer_load_dwordx4 v12, s[12:15], s29 offen offset:2048 lds
    s_add_u32 s29, s29, 196608
    ds_read_b128 v[32:35], v22 offset:0
    ds_read_b64_tr_b16 v[36:37], v20 offset:0
    ds_read_b64_tr_b16 v[38:39], v20 offset:1536
    ds_read_b64_tr_b16 v[40:41], v21 offset:0
    ds_read_b64_tr_b16 v[42:43], v21 offset:1536
    s_waitcnt lgkmcnt(0)
    v_mfma_f32_16x16x32_bf16 v[48:51], v[36:39], v[32:35], v[48:51]
    v_mfma_f32_16x16x32_bf16 v[52:55], v[40:43], v[32:35], v[52:55]
    s_waitcnt vmcnt(24)
    s_barrier
    s_add_u32 m0, s44, 0
    s_nop 0
    buffer_load_dwordx4 v8, s[8:11], s28 offen lds
    buffer_load_dwordx4 v57, s[8:11], s28 offen offset:1024 lds
    buffer_load_dwordx4 v58, s[8:11], s28 offen offset:2048 lds
    buffer_load_dwordx4 v59, s[8:11], s28 offen offset:3072 lds
    s_add_u32 m0, s43, 0
    s_nop 0
    buffer_load_dword v9, s[8:11], s28 offen lds
    s_add_u32 m0, s45, 0
    s_add_u32 s28, s28, 64
    buffer_load_dwordx4 v10, s[12:15], s29 offen lds
    buffer_load_dwordx4 v11, s[12:15], s29 offen offset:1024 lds
    buffer_load_dwordx4 v12, s[12:15], s29 offen offset:2048 lds
    s_add_u32 s29, s29, 196608
    s_mov_b32 s38, 0x550000
    buffer_load_dword v250, v16, s[20:23], s38 offen
    ds_read_b128 v[32:35], v22 offset:29696
    ds_read_b64_tr_b16 v[36:37], v20 offset:29696
    ds_read_b64_tr_b16 v[38:39], v20 offset:31232
    ds_read_b64_tr_b16 v[40:41], v21 offset:29696
    ds_read_b64_tr_b16 v[42:43], v21 offset:31232
    s_waitcnt lgkmcnt(0)
    v_mfma_f32_16x16x32_bf16 v[48:51], v[36:39], v[32:35], v[48:51]
    v_mfma_f32_16x16x32_bf16 v[52:55], v[40:43], v[32:35], v[52:55]
    s_waitcnt vmcnt(25)
    s_barrier
    s_add_u32 m0, s44, 29696
    s_nop 0
    buffer_load_dwordx4 v8, s[8:11], s28 offen lds
    buffer_load_dwordx4 v57, s[8:11], s28 offen offset:1024 lds
    buffer_load_dwordx4 v58, s[8:11], s28 offen offset:2048 lds
    buffer_load_dwordx4 v59, s[8:11], s28 offen offset:3072 lds
    s_add_u32 m0, s43, 29696
    s_nop 0
    buffer_load_dword v9, s[8:11], s28 offen lds
    s_add_u32 m0, s45, 29696
    s_add_u32 s28, s28, 64
    buffer_load_dwordx4 v10, s[12:15], s29 offen lds
    buffer_load_dwordx4 v11, s[12:15], s29 offen offset:1024 lds
    buffer_load_dwordx4 v12, s[12:15], s29 offen offset:2048 lds
    s_add_u32 s29, s29, 196608
    ds_read_b128 v[32:35], v25 offset:0
    ds_read_b64_tr_b16 v[36:37], v23 offset:0
    ds_read_b64_tr_b16 v[38:39], v23 offset:1536
    ds_read_b64_tr_b16 v[40:41], v24 offset:0
    ds_read_b64_tr_b16 v[42:43], v24 offset:1536
    s_waitcnt lgkmcnt(0)
    v_mfma_f32_16x16x32_bf16 v[48:51], v[36:39], v[32:35], v[48:51]
    v_mfma_f32_16x16x32_bf16 v[52:55], v[40:43], v[32:35], v[52:55]
    s_waitcnt vmcnt(25)
    s_barrier
    s_add_u32 m0, s44, 59392
    s_nop 0
    buffer_load_dwordx4 v8, s[8:11], s28 offen lds
    buffer_load_dwordx4 v57, s[8:11], s28 offen offset:1024 lds
    buffer_load_dwordx4 v58, s[8:11], s28 offen offset:2048 lds
    buffer_load_dwordx4 v59, s[8:11], s28 offen offset:3072 lds
    s_add_u32 m0, s43, 59392
    s_nop 0
    buffer_load_dword v9, s[8:11], s28 offen lds
    s_add_u32 m0, s45, 59392
    s_add_u32 s28, s28, 64
    buffer_load_dwordx4 v10, s[12:15], s29 offen lds
    buffer_load_dwordx4 v11, s[12:15], s29 offen offset:1024 lds
    buffer_load_dwordx4 v12, s[12:15], s29 offen offset:2048 lds
    s_add_u32 s29, s29, 196608
    ds_read_b128 v[32:35], v25 offset:29696
    ds_read_b64_tr_b16 v[36:37], v23 offset:29696
    ds_read_b64_tr_b16 v[38:39], v23 offset:31232
    ds_read_b64_tr_b16 v[40:41], v24 offset:29696
    ds_read_b64_tr_b16 v[42:43], v24 offset:31232
    s_waitcnt lgkmcnt(0)
    v_mfma_f32_16x16x32_bf16 v[48:51], v[36:39], v[32:35], v[48:51]
    v_mfma_f32_16x16x32_bf16 v[52:55], v[40:43], v[32:35], v[52:55]
    s_waitcnt vmcnt(25)
    s_barrier
    s_add_u32 m0, s44, 89088
    s_nop 0
    buffer_load_dwordx4 v8, s[8:11], s28 offen lds
    buffer_load_dwordx4 v57, s[8:11], s28 offen offset:1024 lds
    buffer_load_dwordx4 v58, s[8:11], s28 offen offset:2048 lds
    buffer_load_dwordx4 v59, s[8:11], s28 offen offset:3072 lds
    s_add_u32 m0, s43, 89088
    s_nop 0
    buffer_load_dword v9, s[8:11], s28 offen lds
    s_add_u32 m0, s45, 89088
    s_add_u32 s28, s28, 64
    buffer_load_dwordx4 v10, s[12:15], s29 offen lds
    buffer_load_dwordx4 v11, s[12:15], s29 offen offset:1024 lds
    buffer_load_dwordx4 v12, s[12:15], s29 offen offset:2048 lds
    s_add_u32 s29, s29, 196608
    ds_read_b128 v[32:35], v28 offset:0
    ds_read_b64_tr_b16 v[36:37], v26 offset:0
    ds_read_b64_tr_b16 v[38:39], v26 offset:1536
    ds_read_b64_tr_b16 v[40:41], v27 offset:0
    ds_read_b64_tr_b16 v[42:43], v27 offset:1536
    s_waitcnt lgkmcnt(0)
    v_mfma_f32_16x16x32_bf16 v[48:51], v[36:39], v[32:35], v[48:51]
    v_mfma_f32_16x16x32_bf16 v[52:55], v[40:43], v[32:35], v[52:55]
    s_waitcnt vmcnt(25)
    s_barrier
    s_add_u32 m0, s44, 118784
    s_nop 0
    buffer_load_dwordx4 v8, s[8:11], s28 offen lds
    buffer_load_dwordx4 v57, s[8:11], s28 offen offset:1024 lds
    buffer_load_dwordx4 v58, s[8:11], s28 offen offset:2048 lds
    buffer_load_dwordx4 v59, s[8:11], s28 offen offset:3072 lds
    s_add_u32 m0, s43, 118784
    s_nop 0
    buffer_load_dword v9, s[8:11], s28 offen lds
    s_add_u32 m0, s45, 118784
    s_add_u32 s28, s28, 64
    buffer_load_dwordx4 v10, s[12:15], s29 offen lds
    buffer_load_dwordx4 v11, s[12:15], s29 offen offset:1024 lds
    buffer_load_dwordx4 v12, s[12:15], s29 offen offset:2048 lds
    s_add_u32 s29, s29, 196608
    ds_read_b128 v[32:35], v22 offset:0
    ds_read_b64_tr_b16 v[36:37], v20 offset:0
    ds_read_b64_tr_b16 v[38:39], v20 offset:1536
    ds_read_b64_tr_b16 v[40:41], v21 offset:0
    ds_read_b64_tr_b16 v[42:43], v21 offset:1536
    s_waitcnt lgkmcnt(0)
    v_mfma_f32_16x16x32_bf16 v[48:51], v[36:39], v[32:35], v[48:51]
    v_mfma_f32_16x16x32_bf16 v[52:55], v[40:43], v[32:35], v[52:55]
    s_waitcnt vmcnt(24)
    s_barrier
    s_add_u32 m0, s44, 0
    s_nop 0
    buffer_load_dwordx4 v8, s[8:11], s28 offen lds
    buffer_load_dwordx4 v57, s[8:11], s28 offen offset:1024 lds
    buffer_load_dwordx4 v58, s[8:11], s28 offen offset:2048 lds
    buffer_load_dwordx4 v59, s[8:11], s28 offen offset:3072 lds
    s_add_u32 m0, s43, 0
    s_nop 0
    buffer_load_dword v9, s[8:11], s28 offen lds
    s_add_u32 m0, s45, 0
    s_add_u32 s28, s28, 64
    buffer_load_dwordx4 v10, s[12:15], s29 offen lds
    buffer_load_dwordx4 v11, s[12:15], s29 offen offset:1024 lds
    buffer_load_dwordx4 v12, s[12:15], s29 offen offset:2048 lds
    s_add_u32 s29, s29, 196608
    ds_read_b128 v[32:35], v22 offset:29696
    ds_read_b64_tr_b16 v[36:37], v20 offset:29696
    ds_read_b64_tr_b16 v[38:39], v20 offset:31232
    ds_read_b64_tr_b16 v[40:41], v21 offset:29696
    ds_read_b64_tr_b16 v[42:43], v21 offset:31232
    s_waitcnt lgkmcnt(0)
    v_mfma_f32_16x16x32_bf16 v[48:51], v[36:39], v[32:35], v[48:51]
    v_mfma_f32_16x16x32_bf16 v[52:55], v[40:43], v[32:35], v[52:55]
    s_waitcnt vmcnt(24)
    s_barrier
    s_add_u32 m0, s44, 29696
    s_nop 0
    buffer_load_dwordx4 v8, s[8:11], s28 offen lds
    buffer_load_dwordx4 v57, s[8:11], s28 offen offset:1024 lds
    buffer_load_dwordx4 v58, s[8:11], s28 offen offset:2048 lds
    buffer_load_dwordx4 v59, s[8:11], s28 offen offset:3072 lds
    s_add_u32 m0, s43, 29696
    s_nop 0
    buffer_load_dword v9, s[8:11], s28 offen lds
    s_add_u32 m0, s45, 29696
    s_add_u32 s28, s28, 64
    buffer_load_dwordx4 v10, s[12:15], s29 offen lds
    buffer_load_dwordx4 v11, s[12:15], s29 offen offset:1024 lds
    buffer_load_dwordx4 v12, s[12:15], s29 offen offset:2048 lds
    s_add_u32 s29, s29, 196608
    ds_read_b128 v[32:35], v25 offset:0
    ds_read_b64_tr_b16 v[36:37], v23 offset:0
    ds_read_b64_tr_b16 v[38:39], v23 offset:1536
    ds_read_b64_tr_b16 v[40:41], v24 offset:0
    ds_read_b64_tr_b16 v[42:43], v24 offset:1536
    s_waitcnt lgkmcnt(0)
    v_mfma_f32_16x16x32_bf16 v[48:51], v[36:39], v[32:35], v[48:51]
    v_mfma_f32_16x16x32_bf16 v[52:55], v[40:43], v[32:35], v[52:55]
    s_waitcnt vmcnt(24)
    s_barrier
    s_add_u32 m0, s44, 59392
    s_nop 0
    buffer_load_dwordx4 v8, s[8:11], s28 offen lds
    buffer_load_dwordx4 v57, s[8:11], s28 offen offset:1024 lds
    buffer_load_dwordx4 v58, s[8:11], s28 offen offset:2048 lds
    buffer_load_dwordx4 v59, s[8:11], s28 offen offset:3072 lds
    s_add_u32 m0, s43, 59392
    s_nop 0
    buffer_load_dword v9, s[8:11], s28 offen lds
    s_add_u32 m0, s45, 59392
    s_add_u32 s28, s28, 64
    buffer_load_dwordx4 v10, s[12:15], s29 offen lds
    buffer_load_dwordx4 v11, s[12:15], s29 offen offset:1024 lds
    buffer_load_dwordx4 v12, s[12:15], s29 offen offset:2048 lds
    s_add_u32 s29, s29, 196608
    ds_read_b128 v[32:35], v25 offset:29696
    ds_read_b64_tr_b16 v[36:37], v23 offset:29696
    ds_read_b64_tr_b16 v[38:39], v23 offset:31232
    ds_read_b64_tr_b16 v[40:41], v24 offset:29696
    ds_read_b64_tr_b16 v[42:43], v24 offset:31232
    s_waitcnt lgkmcnt(0)
    v_mfma_f32_16x16x32_bf16 v[48:51], v[36:39], v[32:35], v[48:51]
    v_mfma_f32_16x16x32_bf16 v[52:55], v[40:43], v[32:35], v[52:55]
    s_waitcnt vmcnt(24)
    s_barrier
    s_add_u32 m0, s44, 89088
    s_nop 0
    buffer_load_dwordx4 v8, s[8:11], s28 offen lds
    buffer_load_dwordx4 v57, s[8:11], s28 offen offset:1024 lds
    buffer_load_dwordx4 v58, s[8:11], s28 offen offset:2048 lds
    buffer_load_dwordx4 v59, s[8:11], s28 offen offset:3072 lds
    s_add_u32 m0, s43, 89088
    s_nop 0
    buffer_load_dword v9, s[8:11], s28 offen lds
    s_add_u32 m0, s45, 89088
    s_add_u32 s28, s28, 64
    buffer_load_dwordx4 v10, s[12:15], s29 offen lds
    buffer_load_dwordx4 v11, s[12:15], s29 offen offset:1024 lds
    buffer_load_dwordx4 v12, s[12:15], s29 offen offset:2048 lds
    s_add_u32 s29, s29, 196608
    s_mov_b32 s38, 0x950000
    buffer_load_dword v250, v16, s[20:23], s38 offen
    s_mov_b32 s38, 0xd50000
    buffer_load_dword v250, v16, s[20:23], s38 offen
    ds_read_b128 v[32:35], v28 offset:0
    ds_read_b64_tr_b16 v[36:37], v26 offset:0
    ds_read_b64_tr_b16 v[38:39], v26 offset:1536
    ds_read_b64_tr_b16 v[40:41], v27 offset:0
    ds_read_b64_tr_b16 v[42:43], v27 offset:1536
    s_waitcnt lgkmcnt(0)
    v_mfma_f32_16x16x32_bf16 v[48:51], v[36:39], v[32:35], v[48:51]
    v_mfma_f32_16x16x32_bf16 v[52:55], v[40:43], v[32:35], v[52:55]
    s_waitcnt vmcnt(26)
    s_barrier
    s_add_u32 m0, s44, 118784
    s_nop 0
    buffer_load_dwordx4 v8, s[8:11], s28 offen lds
    buffer_load_dwordx4 v57, s[8:11], s28 offen offset:1024 lds
    buffer_load_dwordx4 v58, s[8:11], s28 offen offset:2048 lds
    buffer_load_dwordx4 v59, s[8:11], s28 offen offset:3072 lds
    s_add_u32 m0, s43, 118784
    s_nop 0
    buffer_load_dword v9, s[8:11], s28 offen lds
    s_add_u32 m0, s45, 118784
    s_add_u32 s28, s28, 64
    buffer_load_dwordx4 v10, s[12:15], s29 offen lds
    buffer_load_dwordx4 v11, s[12:15], s29 offen offset:1024 lds
    buffer_load_dwordx4 v12, s[12:15], s29 offen offset:2048 lds
    s_add_u32 s29, s29, 196608
    ds_read_b128 v[32:35], v22 offset:0
    ds_read_b64_tr_b16 v[36:37], v20 offset:0
    ds_read_b64_tr_b16 v[38:39], v20 offset:1536
    ds_read_b64_tr_b16 v[40:41], v21 offset:0
    ds_read_b64_tr_b16 v[42:43], v21 offset:1536
    s_waitcnt lgkmcnt(0)
    v_mfma_f32_16x16x32_bf16 v[48:51], v[36:39], v[32:35], v[48:51]
    v_mfma_f32_16x16x32_bf16 v[52:55], v[40:43], v[32:35], v[52:55]
    s_waitcnt vmcnt(26)
    s_barrier
    s_add_u32 m0, s44, 0
    s_nop 0
    buffer_load_dwordx4 v8, s[8:11], s28 offen lds
    buffer_load_dwordx4 v57, s[8:11], s28 offen offset:1024 lds
    buffer_load_dwordx4 v58, s[8:11], s28 offen offset:2048 lds
    buffer_load_dwordx4 v59, s[8:11], s28 offen offset:3072 lds
    s_add_u32 m0, s43, 0
    s_nop 0
    buffer_load_dword v9, s[8:11], s28 offen lds
    s_add_u32 m0, s45, 0
    s_add_u32 s28, s28, 64
    buffer_load_dwordx4 v10, s[12:15], s29 offen lds
    buffer_load_dwordx4 v11, s[12:15], s29 offen offset:1024 lds
    buffer_load_dwordx4 v12, s[12:15], s29 offen offset:2048 lds
    s_add_u32 s29, s29, 196608
    ds_read_b128 v[32:35], v22 offset:29696
    ds_read_b64_tr_b16 v[36:37], v20 offset:29696
    ds_read_b64_tr_b16 v[38:39], v20 offset:31232
    ds_read_b64_tr_b16 v[40:41], v21 offset:29696
    ds_read_b64_tr_b16 v[42:43], v21 offset:31232
    s_waitcnt lgkmcnt(0)
    v_mfma_f32_16x16x32_bf16 v[48:51], v[36:39], v[32:35], v[48:51]
    v_mfma_f32_16x16x32_bf16 v[52:55], v[40:43], v[32:35], v[52:55]
    s_waitcnt vmcnt(26)
    s_barrier
    s_add_u32 m0, s44, 29696
    s_nop 0
    buffer_load_dwordx4 v8, s[8:11], s28 offen lds
    buffer_load_dwordx4 v57, s[8:11], s28 offen offset:1024 lds
    buffer_load_dwordx4 v58, s[8:11], s28 offen offset:2048 lds
    buffer_load_dwordx4 v59, s[8:11], s28 offen offset:3072 lds
    s_add_u32 m0, s43, 29696
    s_nop 0
    buffer_load_dword v9, s[8:11], s28 offen lds
    s_add_u32 m0, s45, 29696
    s_add_u32 s28, s28, 64
    buffer_load_dwordx4 v10, s[12:15], s29 offen lds
    buffer_load_dwordx4 v11, s[12:15], s29 offen offset:1024 lds
    buffer_load_dwordx4 v12, s[12:15], s29 offen offset:2048 lds
    s_add_u32 s29, s29, 196608
    ds_read_b128 v[32:35], v25 offset:0
    ds_read_b64_tr_b16 v[36:37], v23 offset:0
    ds_read_b64_tr_b16 v[38:39], v23 offset:1536
    ds_read_b64_tr_b16 v[40:41], v24 offset:0
    ds_read_b64_tr_b16 v[42:43], v24 offset:1536
    s_waitcnt lgkmcnt(0)
    v_mfma_f32_16x16x32_bf16 v[48:51], v[36:39], v[32:35], v[48:51]
    v_mfma_f32_16x16x32_bf16 v[52:55], v[40:43], v[32:35], v[52:55]
    s_waitcnt vmcnt(26)
    s_barrier
    s_add_u32 m0, s44, 59392
    s_nop 0
    buffer_load_dwordx4 v8, s[8:11], s28 offen lds
    buffer_load_dwordx4 v57, s[8:11], s28 offen offset:1024 lds
    buffer_load_dwordx4 v58, s[8:11], s28 offen offset:2048 lds
    buffer_load_dwordx4 v59, s[8:11], s28 offen offset:3072 lds
    s_add_u32 m0, s43, 59392
    s_nop 0
    buffer_load_dword v9, s[8:11], s28 offen lds
    s_add_u32 m0, s45, 59392
    s_add_u32 s28, s28, 64
    buffer_load_dwordx4 v10, s[12:15], s29 offen lds
    buffer_load_dwordx4 v11, s[12:15], s29 offen offset:1024 lds
    buffer_load_dwordx4 v12, s[12:15], s29 offen offset:2048 lds
    s_add_u32 s29, s29, 196608
    s_mov_b32 s38, 0x0
    buffer_load_dword v250, v16, s[48:51], s38 offen
    ds_read_b128 v[32:35], v25 offset:29696
    ds_read_b64_tr_b16 v[36:37], v23 offset:29696
    ds_read_b64_tr_b16 v[38:39], v23 offset:31232
    ds_read_b64_tr_b16 v[40:41], v24 offset:29696
    ds_read_b64_tr_b16 v[42:43], v24 offset:31232
    s_waitcnt lgkmcnt(0)
    v_mfma_f32_16x16x32_bf16 v[48:51], v[36:39], v[32:35], v[48:51]
    v_mfma_f32_16x16x32_bf16 v[52:55], v[40:43], v[32:35], v[52:55]
    s_waitcnt vmcnt(25)
    s_barrier
    s_add_u32 m0, s44, 89088
    s_nop 0
    buffer_load_dwordx4 v8, s[8:11], s28 offen lds
    buffer_load_dwordx4 v57, s[8:11], s28 offen offset:1024 lds
    buffer_load_dwordx4 v58, s[8:11], s28 offen offset:2048 lds
    buffer_load_dwordx4 v59, s[8:11], s28 offen offset:3072 lds
    s_add_u32 m0, s43, 89088
    s_nop 0
    buffer_load_dword v9, s[8:11], s28 offen lds
    s_add_u32 m0, s45, 89088
    s_add_u32 s28, s28, 64
    buffer_load_dwordx4 v10, s[12:15], s29 offen lds
    buffer_load_dwordx4 v11, s[12:15], s29 offen offset:1024 lds
    buffer_load_dwordx4 v12, s[12:15], s29 offen offset:2048 lds
    s_add_u32 s29, s29, 196608
    ds_read_b128 v[32:35], v28 offset:0
    ds_read_b64_tr_b16 v[36:37], v26 offset:0
    ds_read_b64_tr_b16 v[38:39], v26 offset:1536
    ds_read_b64_tr_b16 v[40:41], v27 offset:0
    ds_read_b64_tr_b16 v[42:43], v27 offset:1536
    s_waitcnt lgkmcnt(0)
    v_mfma_f32_16x16x32_bf16 v[48:51], v[36:39], v[32:35], v[48:51]
    v_mfma_f32_16x16x32_bf16 v[52:55], v[40:43], v[32:35], v[52:55]
    s_waitcnt vmcnt(25)
    s_barrier
    s_add_u32 m0, s44, 118784
    s_nop 0
    buffer_load_dwordx4 v8, s[8:11], s28 offen lds
    buffer_load_dwordx4 v57, s[8:11], s28 offen offset:1024 lds
    buffer_load_dwordx4 v58, s[8:11], s28 offen offset:2048 lds
    buffer_load_dwordx4 v59, s[8:11], s28 offen offset:3072 lds
    s_add_u32 m0, s43, 118784
    s_nop 0
    buffer_load_dword v9, s[8:11], s28 offen lds
    s_add_u32 m0, s45, 118784
    s_add_u32 s28, s28, 64
    buffer_load_dwordx4 v10, s[12:15], s29 offen lds
    buffer_load_dwordx4 v11, s[12:15], s29 offen offset:1024 lds
    buffer_load_dwordx4 v12, s[12:15], s29 offen offset:2048 lds
    s_add_u32 s29, s29, 196608
    ds_read_b128 v[32:35], v22 offset:0
    ds_read_b64_tr_b16 v[36:37], v20 offset:0
    ds_read_b64_tr_b16 v[38:39], v20 offset:1536
    ds_read_b64_tr_b16 v[40:41], v21 offset:0
    ds_read_b64_tr_b16 v[42:43], v21 offset:1536
    s_waitcnt lgkmcnt(0)
    v_mfma_f32_16x16x32_bf16 v[48:51], v[36:39], v[32:35], v[48:51]
    v_mfma_f32_16x16x32_bf16 v[52:55], v[40:43], v[32:35], v[52:55]
    s_waitcnt vmcnt(25)
    s_barrier
    s_add_u32 m0, s44, 0
    s_nop 0
    buffer_load_dwordx4 v8, s[8:11], s28 offen lds
    buffer_load_dwordx4 v57, s[8:11], s28 offen offset:1024 lds
    buffer_load_dwordx4 v58, s[8:11], s28 offen offset:2048 lds
    buffer_load_dwordx4 v59, s[8:11], s28 offen offset:3072 lds
    s_add_u32 m0, s43, 0
    s_nop 0
    buffer_load_dword v9, s[8:11], s28 offen lds
    s_add_u32 m0, s45, 0
    s_add_u32 s28, s28, 64
    buffer_load_dwordx4 v10, s[12:15], s29 offen lds
    buffer_load_dwordx4 v11, s[12:15], s29 offen offset:1024 lds
    buffer_load_dwordx4 v12, s[12:15], s29 offen offset:2048 lds
    s_add_u32 s29, s29, 196608
    ds_read_b128 v[32:35], v22 offset:29696
    ds_read_b64_tr_b16 v[36:37], v20 offset:29696
    ds_read_b64_tr_b16 v[38:39], v20 offset:31232
    ds_read_b64_tr_b16 v[40:41], v21 offset:29696
    ds_read_b64_tr_b16 v[42:43], v21 offset:31232
    s_waitcnt lgkmcnt(0)
    v_mfma_f32_16x16x32_bf16 v[48:51], v[36:39], v[32:35], v[48:51]
    v_mfma_f32_16x16x32_bf16 v[52:55], v[40:43], v[32:35], v[52:55]
    s_waitcnt vmcnt(25)
    s_barrier
    s_add_u32 m0, s44, 29696
    s_nop 0
    buffer_load_dwordx4 v8, s[8:11], s28 offen lds
    buffer_load_dwordx4 v57, s[8:11], s28 offen offset:1024 lds
    buffer_load_dwordx4 v58, s[8:11], s28 offen offset:2048 lds
    buffer_load_dwordx4 v59, s[8:11], s28 offen offset:3072 lds
    s_add_u32 m0, s43, 29696
    s_nop 0
    buffer_load_dword v9, s[8:11], s28 offen lds
    s_add_u32 m0, s45, 29696
    s_add_u32 s28, s28, 64
    buffer_load_dwordx4 v10, s[12:15], s29 offen lds
    buffer_load_dwordx4 v11, s[12:15], s29 offen offset:1024 lds
    buffer_load_dwordx4 v12, s[12:15], s29 offen offset:2048 lds
    s_add_u32 s29, s29, 196608
    s_mov_b32 s38, 0x400000
    buffer_load_dword v250, v16, s[24:27], s38 offen
    s_mov_b32 s38, 0x800000
    buffer_load_dword v250, v16, s[24:27], s38 offen
    ds_read_b128 v[32:35], v25 offset:0
    ds_read_b64_tr_b16 v[36:37], v23 offset:0
    ds_read_b64_tr_b16 v[38:39], v23 offset:1536
    ds_read_b64_tr_b16 v[40:41], v24 offset:0
    ds_read_b64_tr_b16 v[42:43], v24 offset:1536
    s_waitcnt lgkmcnt(0)
    v_mfma_f32_16x16x32_bf16 v[48:51], v[36:39], v[32:35], v[48:51]
    v_mfma_f32_16x16x32_bf16 v[52:55], v[40:43], v[32:35], v[52:55]
    s_waitcnt vmcnt(26)
    s_barrier
    ds_read_b128 v[32:35], v25 offset:29696
    ds_read_b64_tr_b16 v[36:37], v23 offset:29696
    ds_read_b64_tr_b16 v[38:39], v23 offset:31232
    ds_read_b64_tr_b16 v[40:41], v24 offset:29696
    ds_read_b64_tr_b16 v[42:43], v24 offset:31232
    s_waitcnt lgkmcnt(0)
    v_mfma_f32_16x16x32_bf16 v[48:51], v[36:39], v[32:35], v[48:51]
    v_mfma_f32_16x16x32_bf16 v[52:55], v[40:43], v[32:35], v[52:55]
    s_waitcnt vmcnt(18)
    s_barrier
    ds_read_b128 v[32:35], v28 offset:0
    ds_read_b64_tr_b16 v[36:37], v26 offset:0
    ds_read_b64_tr_b16 v[38:39], v26 offset:1536
    ds_read_b64_tr_b16 v[40:41], v27 offset:0
    ds_read_b64_tr_b16 v[42:43], v27 offset:1536
    s_waitcnt lgkmcnt(0)
    v_mfma_f32_16x16x32_bf16 v[48:51], v[36:39], v[32:35], v[48:51]
    v_mfma_f32_16x16x32_bf16 v[52:55], v[40:43], v[32:35], v[52:55]
    s_waitcnt vmcnt(10)
    s_barrier
    ds_read_b128 v[32:35], v22 offset:0
    ds_read_b64_tr_b16 v[36:37], v20 offset:0
    ds_read_b64_tr_b16 v[38:39], v20 offset:1536
    ds_read_b64_tr_b16 v[40:41], v21 offset:0
    ds_read_b64_tr_b16 v[42:43], v21 offset:1536
    s_waitcnt lgkmcnt(0)
    v_mfma_f32_16x16x32_bf16 v[48:51], v[36:39], v[32:35], v[48:51]
    v_mfma_f32_16x16x32_bf16 v[52:55], v[40:43], v[32:35], v[52:55]
    s_waitcnt vmcnt(2)
    s_barrier
    ds_read_b128 v[32:35], v22 offset:29696
    ds_read_b64_tr_b16 v[36:37], v20 offset:29696
    ds_read_b64_tr_b16 v[38:39], v20 offset:31232
    ds_read_b64_tr_b16 v[40:41], v21 offset:29696
    ds_read_b64_tr_b16 v[42:43], v21 offset:31232
    s_waitcnt lgkmcnt(0)
    v_mfma_f32_16x16x32_bf16 v[48:51], v[36:39], v[32:35], v[48:51]
    v_mfma_f32_16x16x32_bf16 v[52:55], v[40:43], v[32:35], v[52:55]
    s_mov_b32 s96, s82
    s_and_b32 s97, s83, 0xffff
    s_mov_b32 s98, 0x100
    s_mov_b32 s99, 0x00020000
    buffer_load_dword v1, off, s[96:99], 0 sc1
    v_and_b32 v5, 1, v4
    v_mul_u32_u24 v5, 8704, v5
    v_lshrrev_b32 v6, 1, v4
    v_lshl_add_u32 v5, v6, 6, v5
    v_and_b32 v7, 1, v3
    v_lshl_add_u32 v5, v7, 3, v5
    s_mul_i32 s38, s46, 51200
    s_mul_i32 s40, s47, 17408
    s_add_u32 s38, s38, s40
    s_add_u32 s38, s38, 16384
    v_add_u32 v5, s38, v5
    v_lshrrev_b32 v6, 2, v4
    v_lshrrev_b32 v7, 1, v3
    v_xor_b32 v6, v6, v7
    v_lshl_add_u32 v13, v6, 4, v5
    v_xor_b32 v6, 2, v6
    v_lshl_add_u32 v14, v6, 4, v5
    v_cvt_pk_bf16_f32 v32, v48, v49
    v_cvt_pk_bf16_f32 v33, v50, v51
    v_cvt_pk_bf16_f32 v34, v52, v53
    v_cvt_pk_bf16_f32 v35, v54, v55
    s_barrier
    ds_write_b64 v13, v[32:33]
    ds_write_b64 v14, v[34:35]
    s_branch L_q_attn
L_q_cons:
    s_and_b32 s46, s31, 1
    s_lshr_b32 s47, s31, 1
    s_lshl_b32 s38, s47, 1
    v_xor_b32 v7, s38, v5
    v_lshl_add_u32 v7, v7, 5, v6
    s_add_u32 s38, s38, 1
    v_xor_b32 v5, s38, v5
    v_lshl_add_u32 v5, v5, 5, v6
    v_add_u32 v6, 17408, v7
    v_add_u32 v7, 17408, v5
    v_lshrrev_b32 v5, 1, v4
    v_and_b32 v5, 3, v5
    v_xor_b32 v5, v5, v3
    v_lshlrev_b32 v5, 4, v5
    v_lshl_add_u32 v5, v4, 6, v5
    s_lshl_b32 s38, s46, 13
    v_add_u32 v5, s38, v5
    v_mov_b32 v64, 0
    v_mov_b32 v65, 0
    v_mov_b32 v66, 0
    v_mov_b32 v67, 0
    v_mov_b32 v68, 0
    v_mov_b32 v69, 0
    v_mov_b32 v70, 0
    v_mov_b32 v71, 0
    v_mov_b32 v72, 0
    v_mov_b32 v73, 0
    v_mov_b32 v74, 0
    v_mov_b32 v75, 0
    v_mov_b32 v76, 0
    v_mov_b32 v77, 0
    v_mov_b32 v78, 0
    v_mov_b32 v79, 0
    v_mov_b32 v80, 0
    v_mov_b32 v81, 0
    v_mov_b32 v82, 0
    v_mov_b32 v83, 0
    v_mov_b32 v84, 0
    v_mov_b32 v85, 0
    v_mov_b32 v86, 0
    v_mov_b32 v87, 0
    v_mov_b32 v88, 0
    v_mov_b32 v89, 0
    v_mov_b32 v90, 0
    v_mov_b32 v91, 0
    v_mov_b32 v92, 0
    v_mov_b32 v93, 0
    v_mov_b32 v94, 0
    v_mov_b32 v95, 0
    v_mov_b32 v96, 0
    v_mov_b32 v97, 0
    v_mov_b32 v98, 0
    v_mov_b32 v99, 0
    v_mov_b32 v100, 0
    v_mov_b32 v101, 0
    v_mov_b32 v102, 0
    v_mov_b32 v103, 0
    v_mov_b32 v104, 0
    v_mov_b32 v105, 0
    v_mov_b32 v106, 0
    v_mov_b32 v107, 0
    v_mov_b32 v108, 0
    v_mov_b32 v109, 0
    v_mov_b32 v110, 0
    v_mov_b32 v111, 0
    v_mov_b32 v112, 0
    v_mov_b32 v113, 0
    v_mov_b32 v114, 0
    v_mov_b32 v115, 0
    v_mov_b32 v116, 0
    v_mov_b32 v117, 0
    v_mov_b32 v118, 0
    v_mov_b32 v119, 0
    v_mov_b32 v120, 0
    v_mov_b32 v121, 0
    v_mov_b32 v122, 0
    v_mov_b32 v123, 0
    v_mov_b32 v124, 0
    v_mov_b32 v125, 0
    v_mov_b32 v126, 0
    v_mov_b32 v127, 0
    v_mov_b32 v128, 0
    v_mov_b32 v129, 0
    v_mov_b32 v130, 0
    v_mov_b32 v131, 0
    v_mov_b32 v132, 0
    v_mov_b32 v133, 0
    v_mov_b32 v134, 0
    v_mov_b32 v135, 0
    v_mov_b32 v136, 0
    v_mov_b32 v137, 0
    v_mov_b32 v138, 0
    v_mov_b32 v139, 0
    v_mov_b32 v140, 0
    v_mov_b32 v141, 0
    v_mov_b32 v142, 0
    v_mov_b32 v143, 0
    v_mov_b32 v144, 0
    v_mov_b32 v145, 0
    v_mov_b32 v146, 0
    v_mov_b32 v147, 0
    v_mov_b32 v148, 0
    v_mov_b32 v149, 0
    v_mov_b32 v150, 0
    v_mov_b32 v151, 0
    v_mov_b32 v152, 0
    v_mov_b32 v153, 0
    v_mov_b32 v154, 0
    v_mov_b32 v155, 0
    v_mov_b32 v156, 0
    v_mov_b32 v157, 0
    v_mov_b32 v158, 0
    v_mov_b32 v159, 0
    v_mov_b32 v160, 0
    v_mov_b32 v161, 0
    v_mov_b32 v162, 0
    v_mov_b32 v163, 0
    v_mov_b32 v164, 0
    v_mov_b32 v165, 0
    v_mov_b32 v166, 0
    v_mov_b32 v167, 0
    v_mov_b32 v168, 0
    v_mov_b32 v169, 0
    v_mov_b32 v170, 0
    v_mov_b32 v171, 0
    v_mov_b32 v172, 0
    v_mov_b32 v173, 0
    v_mov_b32 v174, 0
    v_mov_b32 v175, 0
    v_mov_b32 v176, 0
    v_mov_b32 v177, 0
    v_mov_b32 v178, 0
    v_mov_b32 v179, 0
    v_mov_b32 v180, 0
    v_mov_b32 v181, 0
    v_mov_b32 v182, 0
    v_mov_b32 v183, 0
    v_mov_b32 v184, 0
    v_mov_b32 v185, 0
    v_mov_b32 v186, 0
    v_mov_b32 v187, 0
    v_mov_b32 v188, 0
    v_mov_b32 v189, 0
    v_mov_b32 v190, 0
    v_mov_b32 v191, 0
    v_mov_b32 v192, 0
    v_mov_b32 v193, 0
    v_mov_b32 v194, 0
    v_mov_b32 v195, 0
    v_mov_b32 v196, 0
    v_mov_b32 v197, 0
    v_mov_b32 v198, 0
    v_mov_b32 v199, 0
    v_mov_b32 v200, 0
    v_mov_b32 v201, 0
    v_mov_b32 v202, 0
    v_mov_b32 v203, 0
    v_mov_b32 v204, 0
    v_mov_b32 v205, 0
    v_mov_b32 v206, 0
    v_mov_b32 v207, 0
    v_mov_b32 v208, 0
    v_mov_b32 v209, 0
    v_mov_b32 v210, 0
    v_mov_b32 v211, 0
    v_mov_b32 v212, 0
    v_mov_b32 v213, 0
    v_mov_b32 v214, 0
    v_mov_b32 v215, 0
    v_mov_b32 v216, 0
    v_mov_b32 v217, 0
    v_mov_b32 v218, 0
    v_mov_b32 v219, 0
    v_mov_b32 v220, 0
    v_mov_b32 v221, 0
    v_mov_b32 v222, 0
    v_mov_b32 v223, 0
    v_mov_b32 v224, 0
    v_mov_b32 v225, 0
    v_mov_b32 v226, 0
    v_mov_b32 v227, 0
    v_mov_b32 v228, 0
    v_mov_b32 v229, 0
    v_mov_b32 v230, 0
    v_mov_b32 v231, 0
    v_mov_b32 v232, 0
    v_mov_b32 v233, 0
    v_mov_b32 v234, 0
    v_mov_b32 v235, 0
    v_mov_b32 v236, 0
    v_mov_b32 v237, 0
    v_mov_b32 v238, 0
    v_mov_b32 v239, 0
    v_mov_b32 v240, 0
    v_mov_b32 v241, 0
    v_mov_b32 v242, 0
    v_mov_b32 v243, 0
    v_mov_b32 v244, 0
    v_mov_b32 v245, 0
    v_mov_b32 v246, 0
    v_mov_b32 v247, 0
    v_mov_b32 v248, 0
    v_mov_b32 v249, 0
    v_mov_b32 v250, 0
    v_mov_b32 v251, 0
    v_mov_b32 v252, 0
    v_mov_b32 v253, 0
    v_mov_b32 v254, 0
    v_mov_b32 v255, 0
    s_setprio 1
    s_barrier
    .p2align 6
    ds_read_b64_tr_b16 v[40:41], v6 offset:0
    ds_read_b64_tr_b16 v[42:43], v6 offset:1536
    ds_read_b64_tr_b16 v[44:45], v7 offset:0
    ds_read_b64_tr_b16 v[46:47], v7 offset:1536
    ds_read_b64_tr_b16 v[48:49], v6 offset:128
    ds_read_b64_tr_b16 v[50:51], v6 offset:1664
    ds_read_b64_tr_b16 v[52:53], v7 offset:128
    ds_read_b64_tr_b16 v[54:55], v7 offset:1664
    ds_read_b128 v[8:11], v5 offset:0
    ds_read_b128 v[12:15], v5 offset:1024
    ds_read_b128 v[16:19], v5 offset:2048
    ds_read_b128 v[20:23], v5 offset:3072
    ds_read_b128 v[24:27], v5 offset:4096
    ds_read_b128 v[28:31], v5 offset:5120
    ds_read_b128 v[32:35], v5 offset:6144
    ds_read_b128 v[36:39], v5 offset:7168
    ds_read_b64_tr_b16 v[56:57], v6 offset:256
    ds_read_b64_tr_b16 v[58:59], v6 offset:1792
    ds_read_b64_tr_b16 v[60:61], v7 offset:256
    ds_read_b64_tr_b16 v[62:63], v7 offset:1792
    s_waitcnt lgkmcnt(11)
    s_nop 0
    v_mfma_f32_16x16x32_bf16 v[64:67], v[40:43], v[8:11], v[64:67]
    v_mfma_f32_16x16x32_bf16 v[96:99], v[44:47], v[8:11], v[96:99]
    s_waitcnt lgkmcnt(10)
    s_nop 0
    v_mfma_f32_16x16x32_bf16 v[100:103], v[44:47], v[12:15], v[100:103]
    v_mfma_f32_16x16x32_bf16 v[68:71], v[40:43], v[12:15], v[68:71]
    s_waitcnt lgkmcnt(9)
    s_nop 0
    v_mfma_f32_16x16x32_bf16 v[72:75], v[40:43], v[16:19], v[72:75]
    v_mfma_f32_16x16x32_bf16 v[104:107], v[44:47], v[16:19], v[104:107]
    s_waitcnt lgkmcnt(8)
    s_nop 0
    v_mfma_f32_16x16x32_bf16 v[108:111], v[44:47], v[20:23], v[108:111]
    v_mfma_f32_16x16x32_bf16 v[76:79], v[40:43], v[20:23], v[76:79]
    s_waitcnt lgkmcnt(7)
    s_nop 0
    v_mfma_f32_16x16x32_bf16 v[80:83], v[40:43], v[24:27], v[80:83]
    v_mfma_f32_16x16x32_bf16 v[112:115], v[44:47], v[24:27], v[112:115]
    s_waitcnt lgkmcnt(6)
    s_nop 0
    v_mfma_f32_16x16x32_bf16 v[116:119], v[44:47], v[28:31], v[116:119]
    v_mfma_f32_16x16x32_bf16 v[84:87], v[40:43], v[28:31], v[84:87]
    s_waitcnt lgkmcnt(5)
    s_nop 0
    v_mfma_f32_16x16x32_bf16 v[88:91], v[40:43], v[32:35], v[88:91]
    v_mfma_f32_16x16x32_bf16 v[120:123], v[44:47], v[32:35], v[120:123]
    s_waitcnt lgkmcnt(4)
    s_nop 0
    v_mfma_f32_16x16x32_bf16 v[124:127], v[44:47], v[36:39], v[124:127]
    v_add_u32 v6, 29696, v6
    v_mfma_f32_16x16x32_bf16 v[92:95], v[40:43], v[36:39], v[92:95]
    v_add_u32 v7, 29696, v7
    v_mfma_f32_16x16x32_bf16 v[156:159], v[48:51], v[36:39], v[156:159]
    v_add_u32 v5, 29696, v5
    v_mfma_f32_16x16x32_bf16 v[188:191], v[52:55], v[36:39], v[188:191]
    s_waitcnt lgkmcnt(0)
    s_barrier
    v_mfma_f32_16x16x32_bf16 v[184:187], v[52:55], v[32:35], v[184:187]
    ds_read_b64_tr_b16 v[40:41], v6 offset:0
    v_mfma_f32_16x16x32_bf16 v[152:155], v[48:51], v[32:35], v[152:155]
    ds_read_b64_tr_b16 v[42:43], v6 offset:1536
    v_mfma_f32_16x16x32_bf16 v[148:151], v[48:51], v[28:31], v[148:151]
    ds_read_b64_tr_b16 v[44:45], v7 offset:0
    v_mfma_f32_16x16x32_bf16 v[180:183], v[52:55], v[28:31], v[180:183]
    ds_read_b64_tr_b16 v[46:47], v7 offset:1536
    v_mfma_f32_16x16x32_bf16 v[176:179], v[52:55], v[24:27], v[176:179]
    v_mfma_f32_16x16x32_bf16 v[144:147], v[48:51], v[24:27], v[144:147]
    v_mfma_f32_16x16x32_bf16 v[140:143], v[48:51], v[20:23], v[140:143]
    v_mfma_f32_16x16x32_bf16 v[172:175], v[52:55], v[20:23], v[172:175]
    v_mfma_f32_16x16x32_bf16 v[168:171], v[52:55], v[16:19], v[168:171]
    v_mfma_f32_16x16x32_bf16 v[136:139], v[48:51], v[16:19], v[136:139]
    v_mfma_f32_16x16x32_bf16 v[132:135], v[48:51], v[12:15], v[132:135]
    v_mfma_f32_16x16x32_bf16 v[164:167], v[52:55], v[12:15], v[164:167]
    v_mfma_f32_16x16x32_bf16 v[160:163], v[52:55], v[8:11], v[160:163]
    v_mfma_f32_16x16x32_bf16 v[128:131], v[48:51], v[8:11], v[128:131]
    v_mfma_f32_16x16x32_bf16 v[192:195], v[56:59], v[8:11], v[192:195]
    ds_read_b64_tr_b16 v[48:49], v6 offset:128
    v_mfma_f32_16x16x32_bf16 v[224:227], v[60:63], v[8:11], v[224:227]
    ds_read_b128 v[8:11], v5 offset:0
    v_mfma_f32_16x16x32_bf16 v[228:231], v[60:63], v[12:15], v[228:231]
    ds_read_b64_tr_b16 v[50:51], v6 offset:1664
    v_mfma_f32_16x16x32_bf16 v[196:199], v[56:59], v[12:15], v[196:199]
    ds_read_b128 v[12:15], v5 offset:1024
    v_mfma_f32_16x16x32_bf16 v[200:203], v[56:59], v[16:19], v[200:203]
    ds_read_b64_tr_b16 v[52:53], v7 offset:128
    v_mfma_f32_16x16x32_bf16 v[232:235], v[60:63], v[16:19], v[232:235]
    ds_read_b128 v[16:19], v5 offset:2048
    v_mfma_f32_16x16x32_bf16 v[236:239], v[60:63], v[20:23], v[236:239]
    ds_read_b64_tr_b16 v[54:55], v7 offset:1664
    v_mfma_f32_16x16x32_bf16 v[204:207], v[56:59], v[20:23], v[204:207]
    ds_read_b128 v[20:23], v5 offset:3072
    v_mfma_f32_16x16x32_bf16 v[208:211], v[56:59], v[24:27], v[208:211]
    v_mfma_f32_16x16x32_bf16 v[240:243], v[60:63], v[24:27], v[240:243]
    ds_read_b128 v[24:27], v5 offset:4096
    v_mfma_f32_16x16x32_bf16 v[244:247], v[60:63], v[28:31], v[244:247]
    v_mfma_f32_16x16x32_bf16 v[212:215], v[56:59], v[28:31], v[212:215]
    ds_read_b128 v[28:31], v5 offset:5120
    v_mfma_f32_16x16x32_bf16 v[216:219], v[56:59], v[32:35], v[216:219]
    v_mfma_f32_16x16x32_bf16 v[248:251], v[60:63], v[32:35], v[248:251]
    ds_read_b128 v[32:35], v5 offset:6144
    v_mfma_f32_16x16x32_bf16 v[252:255], v[60:63], v[36:39], v[252:255]
    v_mfma_f32_16x16x32_bf16 v[220:223], v[56:59], v[36:39], v[220:223]
    ds_read_b128 v[36:39], v5 offset:7168
    s_mov_b32 s30, 6
    s_nop 0
L_qc_20:
    s_waitcnt lgkmcnt(10)
    s_nop 0
    v_mfma_f32_16x16x32_bf16 v[64:67], v[40:43], v[8:11], v[64:67]
    v_mfma_f32_16x16x32_bf16 v[96:99], v[44:47], v[8:11], v[96:99]
    s_waitcnt lgkmcnt(8)
    s_nop 0
    v_mfma_f32_16x16x32_bf16 v[100:103], v[44:47], v[12:15], v[100:103]
    v_mfma_f32_16x16x32_bf16 v[68:71], v[40:43], v[12:15], v[68:71]
    s_waitcnt lgkmcnt(6)
    s_nop 0
    v_mfma_f32_16x16x32_bf16 v[72:75], v[40:43], v[16:19], v[72:75]
    ds_read_b64_tr_b16 v[56:57], v6 offset:256
    v_mfma_f32_16x16x32_bf16 v[104:107], v[44:47], v[16:19], v[104:107]
    s_waitcnt lgkmcnt(5)
    s_nop 0
    v_mfma_f32_16x16x32_bf16 v[108:111], v[44:47], v[20:23], v[108:111]
    ds_read_b64_tr_b16 v[58:59], v6 offset:1792
    v_mfma_f32_16x16x32_bf16 v[76:79], v[40:43], v[20:23], v[76:79]
    s_waitcnt lgkmcnt(5)
    s_nop 0
    v_mfma_f32_16x16x32_bf16 v[80:83], v[40:43], v[24:27], v[80:83]
    ds_read_b64_tr_b16 v[60:61], v7 offset:256
    v_mfma_f32_16x16x32_bf16 v[112:115], v[44:47], v[24:27], v[112:115]
    s_waitcnt lgkmcnt(5)
    s_nop 0
    v_mfma_f32_16x16x32_bf16 v[116:119], v[44:47], v[28:31], v[116:119]
    ds_read_b64_tr_b16 v[62:63], v7 offset:1792
    v_mfma_f32_16x16x32_bf16 v[84:87], v[40:43], v[28:31], v[84:87]
    s_waitcnt lgkmcnt(5)
    s_nop 0
    v_mfma_f32_16x16x32_bf16 v[88:91], v[40:43], v[32:35], v[88:91]
    v_mfma_f32_16x16x32_bf16 v[120:123], v[44:47], v[32:35], v[120:123]
    s_waitcnt lgkmcnt(4)
    s_nop 0
    v_mfma_f32_16x16x32_bf16 v[124:127], v[44:47], v[36:39], v[124:127]
    v_add_u32 v6, 29696, v6
    v_mfma_f32_16x16x32_bf16 v[92:95], v[40:43], v[36:39], v[92:95]
    v_add_u32 v7, 29696, v7
    v_mfma_f32_16x16x32_bf16 v[156:159], v[48:51], v[36:39], v[156:159]
    v_add_u32 v5, 29696, v5
    v_mfma_f32_16x16x32_bf16 v[188:191], v[52:55], v[36:39], v[188:191]
    s_waitcnt lgkmcnt(0)
    s_barrier
    v_mfma_f32_16x16x32_bf16 v[184:187], v[52:55], v[32:35], v[184:187]
    ds_read_b64_tr_b16 v[40:41], v6 offset:0
    v_mfma_f32_16x16x32_bf16 v[152:155], v[48:51], v[32:35], v[152:155]
    ds_read_b64_tr_b16 v[42:43], v6 offset:1536
    v_mfma_f32_16x16x32_bf16 v[148:151], v[48:51], v[28:31], v[148:151]
    ds_read_b64_tr_b16 v[44:45], v7 offset:0
    v_mfma_f32_16x16x32_bf16 v[180:183], v[52:55], v[28:31], v[180:183]
    ds_read_b64_tr_b16 v[46:47], v7 offset:1536
    v_mfma_f32_16x16x32_bf16 v[176:179], v[52:55], v[24:27], v[176:179]
    v_mfma_f32_16x16x32_bf16 v[144:147], v[48:51], v[24:27], v[144:147]
    v_mfma_f32_16x16x32_bf16 v[140:143], v[48:51], v[20:23], v[140:143]
    v_mfma_f32_16x16x32_bf16 v[172:175], v[52:55], v[20:23], v[172:175]
    v_mfma_f32_16x16x32_bf16 v[168:171], v[52:55], v[16:19], v[168:171]
    v_mfma_f32_16x16x32_bf16 v[136:139], v[48:51], v[16:19], v[136:139]
    v_mfma_f32_16x16x32_bf16 v[132:135], v[48:51], v[12:15], v[132:135]
    v_mfma_f32_16x16x32_bf16 v[164:167], v[52:55], v[12:15], v[164:167]
    v_mfma_f32_16x16x32_bf16 v[160:163], v[52:55], v[8:11], v[160:163]
    v_mfma_f32_16x16x32_bf16 v[128:131], v[48:51], v[8:11], v[128:131]
    v_mfma_f32_16x16x32_bf16 v[192:195], v[56:59], v[8:11], v[192:195]
    ds_read_b64_tr_b16 v[48:49], v6 offset:128
    v_mfma_f32_16x16x32_bf16 v[224:227], v[60:63], v[8:11], v[224:227]
    ds_read_b128 v[8:11], v5 offset:0
    v_mfma_f32_16x16x32_bf16 v[228:231], v[60:63], v[12:15], v[228:231]
    ds_read_b64_tr_b16 v[50:51], v6 offset:1664
    v_mfma_f32_16x16x32_bf16 v[196:199], v[56:59], v[12:15], v[196:199]
    ds_read_b128 v[12:15], v5 offset:1024
    v_mfma_f32_16x16x32_bf16 v[200:203], v[56:59], v[16:19], v[200:203]
    ds_read_b64_tr_b16 v[52:53], v7 offset:128
    v_mfma_f32_16x16x32_bf16 v[232:235], v[60:63], v[16:19], v[232:235]
    ds_read_b128 v[16:19], v5 offset:2048
    v_mfma_f32_16x16x32_bf16 v[236:239], v[60:63], v[20:23], v[236:239]
    ds_read_b64_tr_b16 v[54:55], v7 offset:1664
    v_mfma_f32_16x16x32_bf16 v[204:207], v[56:59], v[20:23], v[204:207]
    ds_read_b128 v[20:23], v5 offset:3072
    v_mfma_f32_16x16x32_bf16 v[208:211], v[56:59], v[24:27], v[208:211]
    v_mfma_f32_16x16x32_bf16 v[240:243], v[60:63], v[24:27], v[240:243]
    ds_read_b128 v[24:27], v5 offset:4096
    v_mfma_f32_16x16x32_bf16 v[244:247], v[60:63], v[28:31], v[244:247]
    v_mfma_f32_16x16x32_bf16 v[212:215], v[56:59], v[28:31], v[212:215]
    ds_read_b128 v[28:31], v5 offset:5120
    v_mfma_f32_16x16x32_bf16 v[216:219], v[56:59], v[32:35], v[216:219]
    v_mfma_f32_16x16x32_bf16 v[248:251], v[60:63], v[32:35], v[248:251]
    ds_read_b128 v[32:35], v5 offset:6144
    v_mfma_f32_16x16x32_bf16 v[252:255], v[60:63], v[36:39], v[252:255]
    v_mfma_f32_16x16x32_bf16 v[220:223], v[56:59], v[36:39], v[220:223]
    ds_read_b128 v[36:39], v5 offset:7168
    s_waitcnt lgkmcnt(10)
    s_nop 0
    v_mfma_f32_16x16x32_bf16 v[64:67], v[40:43], v[8:11], v[64:67]
    v_mfma_f32_16x16x32_bf16 v[96:99], v[44:47], v[8:11], v[96:99]
    s_waitcnt lgkmcnt(8)
    s_nop 0
    v_mfma_f32_16x16x32_bf16 v[100:103], v[44:47], v[12:15], v[100:103]
    v_mfma_f32_16x16x32_bf16 v[68:71], v[40:43], v[12:15], v[68:71]
    s_waitcnt lgkmcnt(6)
    s_nop 0
    v_mfma_f32_16x16x32_bf16 v[72:75], v[40:43], v[16:19], v[72:75]
    ds_read_b64_tr_b16 v[56:57], v6 offset:256
    v_mfma_f32_16x16x32_bf16 v[104:107], v[44:47], v[16:19], v[104:107]
    s_waitcnt lgkmcnt(5)
    s_nop 0
    v_mfma_f32_16x16x32_bf16 v[108:111], v[44:47], v[20:23], v[108:111]
    ds_read_b64_tr_b16 v[58:59], v6 offset:1792
    v_mfma_f32_16x16x32_bf16 v[76:79], v[40:43], v[20:23], v[76:79]
    s_waitcnt lgkmcnt(5)
    s_nop 0
    v_mfma_f32_16x16x32_bf16 v[80:83], v[40:43], v[24:27], v[80:83]
    ds_read_b64_tr_b16 v[60:61], v7 offset:256
    v_mfma_f32_16x16x32_bf16 v[112:115], v[44:47], v[24:27], v[112:115]
    s_waitcnt lgkmcnt(5)
    s_nop 0
    v_mfma_f32_16x16x32_bf16 v[116:119], v[44:47], v[28:31], v[116:119]
    ds_read_b64_tr_b16 v[62:63], v7 offset:1792
    v_mfma_f32_16x16x32_bf16 v[84:87], v[40:43], v[28:31], v[84:87]
    s_waitcnt lgkmcnt(5)
    s_nop 0
    v_mfma_f32_16x16x32_bf16 v[88:91], v[40:43], v[32:35], v[88:91]
    v_mfma_f32_16x16x32_bf16 v[120:123], v[44:47], v[32:35], v[120:123]
    s_waitcnt lgkmcnt(4)
    s_nop 0
    v_mfma_f32_16x16x32_bf16 v[124:127], v[44:47], v[36:39], v[124:127]
    v_add_u32 v6, 29696, v6
    v_mfma_f32_16x16x32_bf16 v[92:95], v[40:43], v[36:39], v[92:95]
    v_add_u32 v7, 29696, v7
    v_mfma_f32_16x16x32_bf16 v[156:159], v[48:51], v[36:39], v[156:159]
    v_add_u32 v5, 29696, v5
    v_mfma_f32_16x16x32_bf16 v[188:191], v[52:55], v[36:39], v[188:191]
    s_waitcnt lgkmcnt(0)
    s_barrier
    v_mfma_f32_16x16x32_bf16 v[184:187], v[52:55], v[32:35], v[184:187]
    ds_read_b64_tr_b16 v[40:41], v6 offset:0
    v_mfma_f32_16x16x32_bf16 v[152:155], v[48:51], v[32:35], v[152:155]
    ds_read_b64_tr_b16 v[42:43], v6 offset:1536
    v_mfma_f32_16x16x32_bf16 v[148:151], v[48:51], v[28:31], v[148:151]
    ds_read_b64_tr_b16 v[44:45], v7 offset:0
    v_mfma_f32_16x16x32_bf16 v[180:183], v[52:55], v[28:31], v[180:183]
    ds_read_b64_tr_b16 v[46:47], v7 offset:1536
    v_mfma_f32_16x16x32_bf16 v[176:179], v[52:55], v[24:27], v[176:179]
    v_mfma_f32_16x16x32_bf16 v[144:147], v[48:51], v[24:27], v[144:147]
    v_mfma_f32_16x16x32_bf16 v[140:143], v[48:51], v[20:23], v[140:143]
    v_mfma_f32_16x16x32_bf16 v[172:175], v[52:55], v[20:23], v[172:175]
    v_mfma_f32_16x16x32_bf16 v[168:171], v[52:55], v[16:19], v[168:171]
    v_mfma_f32_16x16x32_bf16 v[136:139], v[48:51], v[16:19], v[136:139]
    v_mfma_f32_16x16x32_bf16 v[132:135], v[48:51], v[12:15], v[132:135]
    v_mfma_f32_16x16x32_bf16 v[164:167], v[52:55], v[12:15], v[164:167]
    v_mfma_f32_16x16x32_bf16 v[160:163], v[52:55], v[8:11], v[160:163]
    v_mfma_f32_16x16x32_bf16 v[128:131], v[48:51], v[8:11], v[128:131]
    v_mfma_f32_16x16x32_bf16 v[192:195], v[56:59], v[8:11], v[192:195]
    ds_read_b64_tr_b16 v[48:49], v6 offset:128
    v_mfma_f32_16x16x32_bf16 v[224:227], v[60:63], v[8:11], v[224:227]
    ds_read_b128 v[8:11], v5 offset:0
    v_mfma_f32_16x16x32_bf16 v[228:231], v[60:63], v[12:15], v[228:231]
    ds_read_b64_tr_b16 v[50:51], v6 offset:1664
    v_mfma_f32_16x16x32_bf16 v[196:199], v[56:59], v[12:15], v[196:199]
    ds_read_b128 v[12:15], v5 offset:1024
    v_mfma_f32_16x16x32_bf16 v[200:203], v[56:59], v[16:19], v[200:203]
    ds_read_b64_tr_b16 v[52:53], v7 offset:128
    v_mfma_f32_16x16x32_bf16 v[232:235], v[60:63], v[16:19], v[232:235]
    ds_read_b128 v[16:19], v5 offset:2048
    v_mfma_f32_16x16x32_bf16 v[236:239], v[60:63], v[20:23], v[236:239]
    ds_read_b64_tr_b16 v[54:55], v7 offset:1664
    v_mfma_f32_16x16x32_bf16 v[204:207], v[56:59], v[20:23], v[204:207]
    ds_read_b128 v[20:23], v5 offset:3072
    v_mfma_f32_16x16x32_bf16 v[208:211], v[56:59], v[24:27], v[208:211]
    v_mfma_f32_16x16x32_bf16 v[240:243], v[60:63], v[24:27], v[240:243]
    ds_read_b128 v[24:27], v5 offset:4096
    v_mfma_f32_16x16x32_bf16 v[244:247], v[60:63], v[28:31], v[244:247]
    v_mfma_f32_16x16x32_bf16 v[212:215], v[56:59], v[28:31], v[212:215]
    ds_read_b128 v[28:31], v5 offset:5120
    v_mfma_f32_16x16x32_bf16 v[216:219], v[56:59], v[32:35], v[216:219]
    v_mfma_f32_16x16x32_bf16 v[248:251], v[60:63], v[32:35], v[248:251]
    ds_read_b128 v[32:35], v5 offset:6144
    v_mfma_f32_16x16x32_bf16 v[252:255], v[60:63], v[36:39], v[252:255]
    v_mfma_f32_16x16x32_bf16 v[220:223], v[56:59], v[36:39], v[220:223]
    ds_read_b128 v[36:39], v5 offset:7168
    s_waitcnt lgkmcnt(10)
    s_nop 0
    v_mfma_f32_16x16x32_bf16 v[64:67], v[40:43], v[8:11], v[64:67]
    v_mfma_f32_16x16x32_bf16 v[96:99], v[44:47], v[8:11], v[96:99]
    s_waitcnt lgkmcnt(8)
    s_nop 0
    v_mfma_f32_16x16x32_bf16 v[100:103], v[44:47], v[12:15], v[100:103]
    v_mfma_f32_16x16x32_bf16 v[68:71], v[40:43], v[12:15], v[68:71]
    s_waitcnt lgkmcnt(6)
    s_nop 0
    v_mfma_f32_16x16x32_bf16 v[72:75], v[40:43], v[16:19], v[72:75]
    ds_read_b64_tr_b16 v[56:57], v6 offset:256
    v_mfma_f32_16x16x32_bf16 v[104:107], v[44:47], v[16:19], v[104:107]
    s_waitcnt lgkmcnt(5)
    s_nop 0
    v_mfma_f32_16x16x32_bf16 v[108:111], v[44:47], v[20:23], v[108:111]
    ds_read_b64_tr_b16 v[58:59], v6 offset:1792
    v_mfma_f32_16x16x32_bf16 v[76:79], v[40:43], v[20:23], v[76:79]
    s_waitcnt lgkmcnt(5)
    s_nop 0
    v_mfma_f32_16x16x32_bf16 v[80:83], v[40:43], v[24:27], v[80:83]
    ds_read_b64_tr_b16 v[60:61], v7 offset:256
    v_mfma_f32_16x16x32_bf16 v[112:115], v[44:47], v[24:27], v[112:115]
    s_waitcnt lgkmcnt(5)
    s_nop 0
    v_mfma_f32_16x16x32_bf16 v[116:119], v[44:47], v[28:31], v[116:119]
    ds_read_b64_tr_b16 v[62:63], v7 offset:1792
    v_mfma_f32_16x16x32_bf16 v[84:87], v[40:43], v[28:31], v[84:87]
    s_waitcnt lgkmcnt(5)
    s_nop 0
    v_mfma_f32_16x16x32_bf16 v[88:91], v[40:43], v[32:35], v[88:91]
    v_mfma_f32_16x16x32_bf16 v[120:123], v[44:47], v[32:35], v[120:123]
    s_waitcnt lgkmcnt(4)
    s_nop 0
    v_mfma_f32_16x16x32_bf16 v[124:127], v[44:47], v[36:39], v[124:127]
    v_add_u32 v6, 29696, v6
    v_mfma_f32_16x16x32_bf16 v[92:95], v[40:43], v[36:39], v[92:95]
    v_add_u32 v7, 29696, v7
    v_mfma_f32_16x16x32_bf16 v[156:159], v[48:51], v[36:39], v[156:159]
    v_add_u32 v5, 29696, v5
    v_mfma_f32_16x16x32_bf16 v[188:191], v[52:55], v[36:39], v[188:191]
    s_waitcnt lgkmcnt(0)
    s_barrier
    v_mfma_f32_16x16x32_bf16 v[184:187], v[52:55], v[32:35], v[184:187]
    ds_read_b64_tr_b16 v[40:41], v6 offset:0
    v_mfma_f32_16x16x32_bf16 v[152:155], v[48:51], v[32:35], v[152:155]
    ds_read_b64_tr_b16 v[42:43], v6 offset:1536
    v_mfma_f32_16x16x32_bf16 v[148:151], v[48:51], v[28:31], v[148:151]
    ds_read_b64_tr_b16 v[44:45], v7 offset:0
    v_mfma_f32_16x16x32_bf16 v[180:183], v[52:55], v[28:31], v[180:183]
    ds_read_b64_tr_b16 v[46:47], v7 offset:1536
    v_mfma_f32_16x16x32_bf16 v[176:179], v[52:55], v[24:27], v[176:179]
    v_mfma_f32_16x16x32_bf16 v[144:147], v[48:51], v[24:27], v[144:147]
    v_mfma_f32_16x16x32_bf16 v[140:143], v[48:51], v[20:23], v[140:143]
    v_mfma_f32_16x16x32_bf16 v[172:175], v[52:55], v[20:23], v[172:175]
    v_mfma_f32_16x16x32_bf16 v[168:171], v[52:55], v[16:19], v[168:171]
    v_mfma_f32_16x16x32_bf16 v[136:139], v[48:51], v[16:19], v[136:139]
    v_mfma_f32_16x16x32_bf16 v[132:135], v[48:51], v[12:15], v[132:135]
    v_mfma_f32_16x16x32_bf16 v[164:167], v[52:55], v[12:15], v[164:167]
    v_mfma_f32_16x16x32_bf16 v[160:163], v[52:55], v[8:11], v[160:163]
    v_mfma_f32_16x16x32_bf16 v[128:131], v[48:51], v[8:11], v[128:131]
    v_mfma_f32_16x16x32_bf16 v[192:195], v[56:59], v[8:11], v[192:195]
    ds_read_b64_tr_b16 v[48:49], v6 offset:128
    v_mfma_f32_16x16x32_bf16 v[224:227], v[60:63], v[8:11], v[224:227]
    ds_read_b128 v[8:11], v5 offset:0
    v_mfma_f32_16x16x32_bf16 v[228:231], v[60:63], v[12:15], v[228:231]
    ds_read_b64_tr_b16 v[50:51], v6 offset:1664
    v_mfma_f32_16x16x32_bf16 v[196:199], v[56:59], v[12:15], v[196:199]
    ds_read_b128 v[12:15], v5 offset:1024
    v_mfma_f32_16x16x32_bf16 v[200:203], v[56:59], v[16:19], v[200:203]
    ds_read_b64_tr_b16 v[52:53], v7 offset:128
    v_mfma_f32_16x16x32_bf16 v[232:235], v[60:63], v[16:19], v[232:235]
    ds_read_b128 v[16:19], v5 offset:2048
    v_mfma_f32_16x16x32_bf16 v[236:239], v[60:63], v[20:23], v[236:239]
    ds_read_b64_tr_b16 v[54:55], v7 offset:1664
    v_mfma_f32_16x16x32_bf16 v[204:207], v[56:59], v[20:23], v[204:207]
    ds_read_b128 v[20:23], v5 offset:3072
    v_mfma_f32_16x16x32_bf16 v[208:211], v[56:59], v[24:27], v[208:211]
    v_mfma_f32_16x16x32_bf16 v[240:243], v[60:63], v[24:27], v[240:243]
    ds_read_b128 v[24:27], v5 offset:4096
    v_mfma_f32_16x16x32_bf16 v[244:247], v[60:63], v[28:31], v[244:247]
    v_mfma_f32_16x16x32_bf16 v[212:215], v[56:59], v[28:31], v[212:215]
    ds_read_b128 v[28:31], v5 offset:5120
    v_mfma_f32_16x16x32_bf16 v[216:219], v[56:59], v[32:35], v[216:219]
    v_mfma_f32_16x16x32_bf16 v[248:251], v[60:63], v[32:35], v[248:251]
    ds_read_b128 v[32:35], v5 offset:6144
    v_mfma_f32_16x16x32_bf16 v[252:255], v[60:63], v[36:39], v[252:255]
    v_mfma_f32_16x16x32_bf16 v[220:223], v[56:59], v[36:39], v[220:223]
    ds_read_b128 v[36:39], v5 offset:7168
    s_waitcnt lgkmcnt(10)
    s_nop 0
    v_mfma_f32_16x16x32_bf16 v[64:67], v[40:43], v[8:11], v[64:67]
    v_mfma_f32_16x16x32_bf16 v[96:99], v[44:47], v[8:11], v[96:99]
    s_waitcnt lgkmcnt(8)
    s_nop 0
    v_mfma_f32_16x16x32_bf16 v[100:103], v[44:47], v[12:15], v[100:103]
    v_mfma_f32_16x16x32_bf16 v[68:71], v[40:43], v[12:15], v[68:71]
    s_waitcnt lgkmcnt(6)
    s_nop 0
    v_mfma_f32_16x16x32_bf16 v[72:75], v[40:43], v[16:19], v[72:75]
    ds_read_b64_tr_b16 v[56:57], v6 offset:256
    v_mfma_f32_16x16x32_bf16 v[104:107], v[44:47], v[16:19], v[104:107]
    s_waitcnt lgkmcnt(5)
    s_nop 0
    v_mfma_f32_16x16x32_bf16 v[108:111], v[44:47], v[20:23], v[108:111]
    ds_read_b64_tr_b16 v[58:59], v6 offset:1792
    v_mfma_f32_16x16x32_bf16 v[76:79], v[40:43], v[20:23], v[76:79]
    s_waitcnt lgkmcnt(5)
    s_nop 0
    v_mfma_f32_16x16x32_bf16 v[80:83], v[40:43], v[24:27], v[80:83]
    ds_read_b64_tr_b16 v[60:61], v7 offset:256
    v_mfma_f32_16x16x32_bf16 v[112:115], v[44:47], v[24:27], v[112:115]
    s_waitcnt lgkmcnt(5)
    s_nop 0
    v_mfma_f32_16x16x32_bf16 v[116:119], v[44:47], v[28:31], v[116:119]
    ds_read_b64_tr_b16 v[62:63], v7 offset:1792
    v_mfma_f32_16x16x32_bf16 v[84:87], v[40:43], v[28:31], v[84:87]
    s_waitcnt lgkmcnt(5)
    s_nop 0
    v_mfma_f32_16x16x32_bf16 v[88:91], v[40:43], v[32:35], v[88:91]
    v_mfma_f32_16x16x32_bf16 v[120:123], v[44:47], v[32:35], v[120:123]
    s_waitcnt lgkmcnt(4)
    s_nop 0
    v_mfma_f32_16x16x32_bf16 v[124:127], v[44:47], v[36:39], v[124:127]
    v_add_u32 v6, 4294848512, v6
    v_mfma_f32_16x16x32_bf16 v[92:95], v[40:43], v[36:39], v[92:95]
    v_add_u32 v7, 4294848512, v7
    v_mfma_f32_16x16x32_bf16 v[156:159], v[48:51], v[36:39], v[156:159]
    v_add_u32 v5, 4294848512, v5
    v_mfma_f32_16x16x32_bf16 v[188:191], v[52:55], v[36:39], v[188:191]
    s_waitcnt lgkmcnt(0)
    s_barrier
    v_mfma_f32_16x16x32_bf16 v[184:187], v[52:55], v[32:35], v[184:187]
    ds_read_b64_tr_b16 v[40:41], v6 offset:0
    v_mfma_f32_16x16x32_bf16 v[152:155], v[48:51], v[32:35], v[152:155]
    ds_read_b64_tr_b16 v[42:43], v6 offset:1536
    v_mfma_f32_16x16x32_bf16 v[148:151], v[48:51], v[28:31], v[148:151]
    ds_read_b64_tr_b16 v[44:45], v7 offset:0
    v_mfma_f32_16x16x32_bf16 v[180:183], v[52:55], v[28:31], v[180:183]
    ds_read_b64_tr_b16 v[46:47], v7 offset:1536
    v_mfma_f32_16x16x32_bf16 v[176:179], v[52:55], v[24:27], v[176:179]
    v_mfma_f32_16x16x32_bf16 v[144:147], v[48:51], v[24:27], v[144:147]
    v_mfma_f32_16x16x32_bf16 v[140:143], v[48:51], v[20:23], v[140:143]
    v_mfma_f32_16x16x32_bf16 v[172:175], v[52:55], v[20:23], v[172:175]
    v_mfma_f32_16x16x32_bf16 v[168:171], v[52:55], v[16:19], v[168:171]
    v_mfma_f32_16x16x32_bf16 v[136:139], v[48:51], v[16:19], v[136:139]
    v_mfma_f32_16x16x32_bf16 v[132:135], v[48:51], v[12:15], v[132:135]
    v_mfma_f32_16x16x32_bf16 v[164:167], v[52:55], v[12:15], v[164:167]
    v_mfma_f32_16x16x32_bf16 v[160:163], v[52:55], v[8:11], v[160:163]
    v_mfma_f32_16x16x32_bf16 v[128:131], v[48:51], v[8:11], v[128:131]
    v_mfma_f32_16x16x32_bf16 v[192:195], v[56:59], v[8:11], v[192:195]
    ds_read_b64_tr_b16 v[48:49], v6 offset:128
    v_mfma_f32_16x16x32_bf16 v[224:227], v[60:63], v[8:11], v[224:227]
    ds_read_b128 v[8:11], v5 offset:0
    v_mfma_f32_16x16x32_bf16 v[228:231], v[60:63], v[12:15], v[228:231]
    ds_read_b64_tr_b16 v[50:51], v6 offset:1664
    v_mfma_f32_16x16x32_bf16 v[196:199], v[56:59], v[12:15], v[196:199]
    ds_read_b128 v[12:15], v5 offset:1024
    v_mfma_f32_16x16x32_bf16 v[200:203], v[56:59], v[16:19], v[200:203]
    ds_read_b64_tr_b16 v[52:53], v7 offset:128
    v_mfma_f32_16x16x32_bf16 v[232:235], v[60:63], v[16:19], v[232:235]
    ds_read_b128 v[16:19], v5 offset:2048
    v_mfma_f32_16x16x32_bf16 v[236:239], v[60:63], v[20:23], v[236:239]
    ds_read_b64_tr_b16 v[54:55], v7 offset:1664
    v_mfma_f32_16x16x32_bf16 v[204:207], v[56:59], v[20:23], v[204:207]
    ds_read_b128 v[20:23], v5 offset:3072
    v_mfma_f32_16x16x32_bf16 v[208:211], v[56:59], v[24:27], v[208:211]
    v_mfma_f32_16x16x32_bf16 v[240:243], v[60:63], v[24:27], v[240:243]
    ds_read_b128 v[24:27], v5 offset:4096
    v_mfma_f32_16x16x32_bf16 v[244:247], v[60:63], v[28:31], v[244:247]
    v_mfma_f32_16x16x32_bf16 v[212:215], v[56:59], v[28:31], v[212:215]
    ds_read_b128 v[28:31], v5 offset:5120
    v_mfma_f32_16x16x32_bf16 v[216:219], v[56:59], v[32:35], v[216:219]
    v_mfma_f32_16x16x32_bf16 v[248:251], v[60:63], v[32:35], v[248:251]
    ds_read_b128 v[32:35], v5 offset:6144
    v_mfma_f32_16x16x32_bf16 v[252:255], v[60:63], v[36:39], v[252:255]
    v_mfma_f32_16x16x32_bf16 v[220:223], v[56:59], v[36:39], v[220:223]
    ds_read_b128 v[36:39], v5 offset:7168
    s_waitcnt lgkmcnt(10)
    s_nop 0
    v_mfma_f32_16x16x32_bf16 v[64:67], v[40:43], v[8:11], v[64:67]
    v_mfma_f32_16x16x32_bf16 v[96:99], v[44:47], v[8:11], v[96:99]
    s_waitcnt lgkmcnt(8)
    s_nop 0
    v_mfma_f32_16x16x32_bf16 v[100:103], v[44:47], v[12:15], v[100:103]
    v_mfma_f32_16x16x32_bf16 v[68:71], v[40:43], v[12:15], v[68:71]
    s_waitcnt lgkmcnt(6)
    s_nop 0
    v_mfma_f32_16x16x32_bf16 v[72:75], v[40:43], v[16:19], v[72:75]
    ds_read_b64_tr_b16 v[56:57], v6 offset:256
    v_mfma_f32_16x16x32_bf16 v[104:107], v[44:47], v[16:19], v[104:107]
    s_waitcnt lgkmcnt(5)
    s_nop 0
    v_mfma_f32_16x16x32_bf16 v[108:111], v[44:47], v[20:23], v[108:111]
    ds_read_b64_tr_b16 v[58:59], v6 offset:1792
    v_mfma_f32_16x16x32_bf16 v[76:79], v[40:43], v[20:23], v[76:79]
    s_waitcnt lgkmcnt(5)
    s_nop 0
    v_mfma_f32_16x16x32_bf16 v[80:83], v[40:43], v[24:27], v[80:83]
    ds_read_b64_tr_b16 v[60:61], v7 offset:256
    v_mfma_f32_16x16x32_bf16 v[112:115], v[44:47], v[24:27], v[112:115]
    s_waitcnt lgkmcnt(5)
    s_nop 0
    v_mfma_f32_16x16x32_bf16 v[116:119], v[44:47], v[28:31], v[116:119]
    ds_read_b64_tr_b16 v[62:63], v7 offset:1792
    v_mfma_f32_16x16x32_bf16 v[84:87], v[40:43], v[28:31], v[84:87]
    s_waitcnt lgkmcnt(5)
    s_nop 0
    v_mfma_f32_16x16x32_bf16 v[88:91], v[40:43], v[32:35], v[88:91]
    v_mfma_f32_16x16x32_bf16 v[120:123], v[44:47], v[32:35], v[120:123]
    s_waitcnt lgkmcnt(4)
    s_nop 0
    v_mfma_f32_16x16x32_bf16 v[124:127], v[44:47], v[36:39], v[124:127]
    v_add_u32 v6, 29696, v6
    v_mfma_f32_16x16x32_bf16 v[92:95], v[40:43], v[36:39], v[92:95]
    v_add_u32 v7, 29696, v7
    v_mfma_f32_16x16x32_bf16 v[156:159], v[48:51], v[36:39], v[156:159]
    v_add_u32 v5, 29696, v5
    v_mfma_f32_16x16x32_bf16 v[188:191], v[52:55], v[36:39], v[188:191]
    s_waitcnt lgkmcnt(0)
    s_barrier
    v_mfma_f32_16x16x32_bf16 v[184:187], v[52:55], v[32:35], v[184:187]
    ds_read_b64_tr_b16 v[40:41], v6 offset:0
    v_mfma_f32_16x16x32_bf16 v[152:155], v[48:51], v[32:35], v[152:155]
    ds_read_b64_tr_b16 v[42:43], v6 offset:1536
    v_mfma_f32_16x16x32_bf16 v[148:151], v[48:51], v[28:31], v[148:151]
    ds_read_b64_tr_b16 v[44:45], v7 offset:0
    v_mfma_f32_16x16x32_bf16 v[180:183], v[52:55], v[28:31], v[180:183]
    ds_read_b64_tr_b16 v[46:47], v7 offset:1536
    v_mfma_f32_16x16x32_bf16 v[176:179], v[52:55], v[24:27], v[176:179]
    v_mfma_f32_16x16x32_bf16 v[144:147], v[48:51], v[24:27], v[144:147]
    v_mfma_f32_16x16x32_bf16 v[140:143], v[48:51], v[20:23], v[140:143]
    v_mfma_f32_16x16x32_bf16 v[172:175], v[52:55], v[20:23], v[172:175]
    v_mfma_f32_16x16x32_bf16 v[168:171], v[52:55], v[16:19], v[168:171]
    v_mfma_f32_16x16x32_bf16 v[136:139], v[48:51], v[16:19], v[136:139]
    v_mfma_f32_16x16x32_bf16 v[132:135], v[48:51], v[12:15], v[132:135]
    v_mfma_f32_16x16x32_bf16 v[164:167], v[52:55], v[12:15], v[164:167]
    v_mfma_f32_16x16x32_bf16 v[160:163], v[52:55], v[8:11], v[160:163]
    v_mfma_f32_16x16x32_bf16 v[128:131], v[48:51], v[8:11], v[128:131]
    v_mfma_f32_16x16x32_bf16 v[192:195], v[56:59], v[8:11], v[192:195]
    ds_read_b64_tr_b16 v[48:49], v6 offset:128
    v_mfma_f32_16x16x32_bf16 v[224:227], v[60:63], v[8:11], v[224:227]
    ds_read_b128 v[8:11], v5 offset:0
    v_mfma_f32_16x16x32_bf16 v[228:231], v[60:63], v[12:15], v[228:231]
    ds_read_b64_tr_b16 v[50:51], v6 offset:1664
    v_mfma_f32_16x16x32_bf16 v[196:199], v[56:59], v[12:15], v[196:199]
    ds_read_b128 v[12:15], v5 offset:1024
    v_mfma_f32_16x16x32_bf16 v[200:203], v[56:59], v[16:19], v[200:203]
    ds_read_b64_tr_b16 v[52:53], v7 offset:128
    v_mfma_f32_16x16x32_bf16 v[232:235], v[60:63], v[16:19], v[232:235]
    ds_read_b128 v[16:19], v5 offset:2048
    v_mfma_f32_16x16x32_bf16 v[236:239], v[60:63], v[20:23], v[236:239]
    ds_read_b64_tr_b16 v[54:55], v7 offset:1664
    v_mfma_f32_16x16x32_bf16 v[204:207], v[56:59], v[20:23], v[204:207]
    ds_read_b128 v[20:23], v5 offset:3072
    v_mfma_f32_16x16x32_bf16 v[208:211], v[56:59], v[24:27], v[208:211]
    v_mfma_f32_16x16x32_bf16 v[240:243], v[60:63], v[24:27], v[240:243]
    ds_read_b128 v[24:27], v5 offset:4096
    v_mfma_f32_16x16x32_bf16 v[244:247], v[60:63], v[28:31], v[244:247]
    v_mfma_f32_16x16x32_bf16 v[212:215], v[56:59], v[28:31], v[212:215]
    ds_read_b128 v[28:31], v5 offset:5120
    v_mfma_f32_16x16x32_bf16 v[216:219], v[56:59], v[32:35], v[216:219]
    v_mfma_f32_16x16x32_bf16 v[248:251], v[60:63], v[32:35], v[248:251]
    ds_read_b128 v[32:35], v5 offset:6144
    v_mfma_f32_16x16x32_bf16 v[252:255], v[60:63], v[36:39], v[252:255]
    v_mfma_f32_16x16x32_bf16 v[220:223], v[56:59], v[36:39], v[220:223]
    ds_read_b128 v[36:39], v5 offset:7168
    s_sub_u32 s30, s30, 1
    s_cmp_lg_u32 s30, 0
    s_nop 0
    s_cbranch_scc1 L_qc_20
    s_waitcnt lgkmcnt(10)
    s_nop 0
    v_mfma_f32_16x16x32_bf16 v[64:67], v[40:43], v[8:11], v[64:67]
    v_mfma_f32_16x16x32_bf16 v[96:99], v[44:47], v[8:11], v[96:99]
    s_waitcnt lgkmcnt(8)
    s_nop 0
    v_mfma_f32_16x16x32_bf16 v[100:103], v[44:47], v[12:15], v[100:103]
    v_mfma_f32_16x16x32_bf16 v[68:71], v[40:43], v[12:15], v[68:71]
    s_waitcnt lgkmcnt(6)
    s_nop 0
    v_mfma_f32_16x16x32_bf16 v[72:75], v[40:43], v[16:19], v[72:75]
    ds_read_b64_tr_b16 v[56:57], v6 offset:256
    v_mfma_f32_16x16x32_bf16 v[104:107], v[44:47], v[16:19], v[104:107]
    s_waitcnt lgkmcnt(5)
    s_nop 0
    v_mfma_f32_16x16x32_bf16 v[108:111], v[44:47], v[20:23], v[108:111]
    ds_read_b64_tr_b16 v[58:59], v6 offset:1792
    v_mfma_f32_16x16x32_bf16 v[76:79], v[40:43], v[20:23], v[76:79]
    s_waitcnt lgkmcnt(5)
    s_nop 0
    v_mfma_f32_16x16x32_bf16 v[80:83], v[40:43], v[24:27], v[80:83]
    ds_read_b64_tr_b16 v[60:61], v7 offset:256
    v_mfma_f32_16x16x32_bf16 v[112:115], v[44:47], v[24:27], v[112:115]
    s_waitcnt lgkmcnt(5)
    s_nop 0
    v_mfma_f32_16x16x32_bf16 v[116:119], v[44:47], v[28:31], v[116:119]
    ds_read_b64_tr_b16 v[62:63], v7 offset:1792
    v_mfma_f32_16x16x32_bf16 v[84:87], v[40:43], v[28:31], v[84:87]
    s_waitcnt lgkmcnt(5)
    s_nop 0
    v_mfma_f32_16x16x32_bf16 v[88:91], v[40:43], v[32:35], v[88:91]
    v_mfma_f32_16x16x32_bf16 v[120:123], v[44:47], v[32:35], v[120:123]
    s_waitcnt lgkmcnt(4)
    s_nop 0
    v_mfma_f32_16x16x32_bf16 v[124:127], v[44:47], v[36:39], v[124:127]
    v_mfma_f32_16x16x32_bf16 v[92:95], v[40:43], v[36:39], v[92:95]
    v_mfma_f32_16x16x32_bf16 v[156:159], v[48:51], v[36:39], v[156:159]
    v_mfma_f32_16x16x32_bf16 v[188:191], v[52:55], v[36:39], v[188:191]
    v_mfma_f32_16x16x32_bf16 v[184:187], v[52:55], v[32:35], v[184:187]
    v_mfma_f32_16x16x32_bf16 v[152:155], v[48:51], v[32:35], v[152:155]
    v_mfma_f32_16x16x32_bf16 v[148:151], v[48:51], v[28:31], v[148:151]
    v_mfma_f32_16x16x32_bf16 v[180:183], v[52:55], v[28:31], v[180:183]
    v_mfma_f32_16x16x32_bf16 v[176:179], v[52:55], v[24:27], v[176:179]
    v_mfma_f32_16x16x32_bf16 v[144:147], v[48:51], v[24:27], v[144:147]
    v_mfma_f32_16x16x32_bf16 v[140:143], v[48:51], v[20:23], v[140:143]
    v_mfma_f32_16x16x32_bf16 v[172:175], v[52:55], v[20:23], v[172:175]
    v_mfma_f32_16x16x32_bf16 v[168:171], v[52:55], v[16:19], v[168:171]
    v_mfma_f32_16x16x32_bf16 v[136:139], v[48:51], v[16:19], v[136:139]
    v_mfma_f32_16x16x32_bf16 v[132:135], v[48:51], v[12:15], v[132:135]
    v_mfma_f32_16x16x32_bf16 v[164:167], v[52:55], v[12:15], v[164:167]
    v_mfma_f32_16x16x32_bf16 v[160:163], v[52:55], v[8:11], v[160:163]
    v_mfma_f32_16x16x32_bf16 v[128:131], v[48:51], v[8:11], v[128:131]
    s_waitcnt lgkmcnt(2)
    s_nop 0
    v_mfma_f32_16x16x32_bf16 v[192:195], v[56:59], v[8:11], v[192:195]
    s_waitcnt lgkmcnt(0)
    s_nop 0
    v_mfma_f32_16x16x32_bf16 v[224:227], v[60:63], v[8:11], v[224:227]
    v_mfma_f32_16x16x32_bf16 v[228:231], v[60:63], v[12:15], v[228:231]
    v_mfma_f32_16x16x32_bf16 v[196:199], v[56:59], v[12:15], v[196:199]
    v_mfma_f32_16x16x32_bf16 v[200:203], v[56:59], v[16:19], v[200:203]
    v_mfma_f32_16x16x32_bf16 v[232:235], v[60:63], v[16:19], v[232:235]
    v_mfma_f32_16x16x32_bf16 v[236:239], v[60:63], v[20:23], v[236:239]
    v_mfma_f32_16x16x32_bf16 v[204:207], v[56:59], v[20:23], v[204:207]
    v_mfma_f32_16x16x32_bf16 v[208:211], v[56:59], v[24:27], v[208:211]
    v_mfma_f32_16x16x32_bf16 v[240:243], v[60:63], v[24:27], v[240:243]
    v_mfma_f32_16x16x32_bf16 v[244:247], v[60:63], v[28:31], v[244:247]
    v_mfma_f32_16x16x32_bf16 v[212:215], v[56:59], v[28:31], v[212:215]
    v_mfma_f32_16x16x32_bf16 v[216:219], v[56:59], v[32:35], v[216:219]
    v_mfma_f32_16x16x32_bf16 v[248:251], v[60:63], v[32:35], v[248:251]
    v_mfma_f32_16x16x32_bf16 v[252:255], v[60:63], v[36:39], v[252:255]
    v_mfma_f32_16x16x32_bf16 v[220:223], v[56:59], v[36:39], v[220:223]
    s_setprio 0
    s_mov_b32 s96, s82
    s_and_b32 s97, s83, 0xffff
    s_mov_b32 s98, 0x100
    s_mov_b32 s99, 0x00020000
    buffer_load_dword v1, off, s[96:99], 0 sc1
    v_and_b32 v2, 63, v0
    v_lshrrev_b32 v3, 4, v2
    v_and_b32 v4, 15, v2
    v_lshrrev_b32 v6, 1, v4
    v_lshlrev_b32 v5, 6, v6
    v_and_b32 v7, 1, v3
    v_lshl_add_u32 v5, v7, 3, v5
    s_mul_i32 s38, s47, 51200
    s_lshl_b32 s40, s46, 12
    s_add_u32 s38, s38, s40
    v_add_u32 v5, s38, v5
    v_lshrrev_b32 v6, 2, v4
    v_lshrrev_b32 v7, 1, v3
    v_xor_b32 v6, v6, v7
    v_lshl_add_u32 v8, v6, 4, v5
    v_xor_b32 v6, 2, v6
    v_lshl_add_u32 v9, v6, 4, v5
    v_and_b32 v7, 1, v4
    v_mul_u32_u24 v6, 8192, v7
    v_mul_u32_u24 v7, 8704, v7
    v_add_u32 v10, v8, v6
    v_add_u32 v11, v9, v6
    v_add_u32 v12, v8, v7
    v_add_u32 v13, v9, v7
    s_barrier
    v_cvt_pk_bf16_f32 v16, v64, v65
    v_cvt_pk_bf16_f32 v17, v66, v67
    ds_write_b64 v10, v[16:17] offset:0
    v_cvt_pk_bf16_f32 v18, v68, v69
    v_cvt_pk_bf16_f32 v19, v70, v71
    ds_write_b64 v10, v[18:19] offset:512
    v_cvt_pk_bf16_f32 v20, v72, v73
    v_cvt_pk_bf16_f32 v21, v74, v75
    ds_write_b64 v10, v[20:21] offset:1024
    v_cvt_pk_bf16_f32 v22, v76, v77
    v_cvt_pk_bf16_f32 v23, v78, v79
    ds_write_b64 v10, v[22:23] offset:1536
    v_cvt_pk_bf16_f32 v24, v80, v81
    v_cvt_pk_bf16_f32 v25, v82, v83
    ds_write_b64 v10, v[24:25] offset:2048
    v_cvt_pk_bf16_f32 v26, v84, v85
    v_cvt_pk_bf16_f32 v27, v86, v87
    ds_write_b64 v10, v[26:27] offset:2560
    v_cvt_pk_bf16_f32 v28, v88, v89
    v_cvt_pk_bf16_f32 v29, v90, v91
    ds_write_b64 v10, v[28:29] offset:3072
    v_cvt_pk_bf16_f32 v30, v92, v93
    v_cvt_pk_bf16_f32 v31, v94, v95
    ds_write_b64 v10, v[30:31] offset:3584
    v_cvt_pk_bf16_f32 v16, v96, v97
    v_cvt_pk_bf16_f32 v17, v98, v99
    ds_write_b64 v11, v[16:17] offset:0
    v_cvt_pk_bf16_f32 v18, v100, v101
    v_cvt_pk_bf16_f32 v19, v102, v103
    ds_write_b64 v11, v[18:19] offset:512
    v_cvt_pk_bf16_f32 v20, v104, v105
    v_cvt_pk_bf16_f32 v21, v106, v107
    ds_write_b64 v11, v[20:21] offset:1024
    v_cvt_pk_bf16_f32 v22, v108, v109
    v_cvt_pk_bf16_f32 v23, v110, v111
    ds_write_b64 v11, v[22:23] offset:1536
    v_cvt_pk_bf16_f32 v24, v112, v113
    v_cvt_pk_bf16_f32 v25, v114, v115
    ds_write_b64 v11, v[24:25] offset:2048
    v_cvt_pk_bf16_f32 v26, v116, v117
    v_cvt_pk_bf16_f32 v27, v118, v119
    ds_write_b64 v11, v[26:27] offset:2560
    v_cvt_pk_bf16_f32 v28, v120, v121
    v_cvt_pk_bf16_f32 v29, v122, v123
    ds_write_b64 v11, v[28:29] offset:3072
    v_cvt_pk_bf16_f32 v30, v124, v125
    v_cvt_pk_bf16_f32 v31, v126, v127
    ds_write_b64 v11, v[30:31] offset:3584
    v_cvt_pk_bf16_f32 v16, v128, v129
    v_cvt_pk_bf16_f32 v17, v130, v131
    ds_write_b64 v12, v[16:17] offset:16896
    v_cvt_pk_bf16_f32 v18, v132, v133
    v_cvt_pk_bf16_f32 v19, v134, v135
    ds_write_b64 v12, v[18:19] offset:17408
    v_cvt_pk_bf16_f32 v20, v136, v137
    v_cvt_pk_bf16_f32 v21, v138, v139
    ds_write_b64 v12, v[20:21] offset:17920
    v_cvt_pk_bf16_f32 v22, v140, v141
    v_cvt_pk_bf16_f32 v23, v142, v143
    ds_write_b64 v12, v[22:23] offset:18432
    v_cvt_pk_bf16_f32 v24, v144, v145
    v_cvt_pk_bf16_f32 v25, v146, v147
    ds_write_b64 v12, v[24:25] offset:18944
    v_cvt_pk_bf16_f32 v26, v148, v149
    v_cvt_pk_bf16_f32 v27, v150, v151
    ds_write_b64 v12, v[26:27] offset:19456
    v_cvt_pk_bf16_f32 v28, v152, v153
    v_cvt_pk_bf16_f32 v29, v154, v155
    ds_write_b64 v12, v[28:29] offset:19968
    v_cvt_pk_bf16_f32 v30, v156, v157
    v_cvt_pk_bf16_f32 v31, v158, v159
    ds_write_b64 v12, v[30:31] offset:20480
    v_cvt_pk_bf16_f32 v16, v160, v161
    v_cvt_pk_bf16_f32 v17, v162, v163
    ds_write_b64 v13, v[16:17] offset:16896
    v_cvt_pk_bf16_f32 v18, v164, v165
    v_cvt_pk_bf16_f32 v19, v166, v167
    ds_write_b64 v13, v[18:19] offset:17408
    v_cvt_pk_bf16_f32 v20, v168, v169
    v_cvt_pk_bf16_f32 v21, v170, v171
    ds_write_b64 v13, v[20:21] offset:17920
    v_cvt_pk_bf16_f32 v22, v172, v173
    v_cvt_pk_bf16_f32 v23, v174, v175
    ds_write_b64 v13, v[22:23] offset:18432
    v_cvt_pk_bf16_f32 v24, v176, v177
    v_cvt_pk_bf16_f32 v25, v178, v179
    ds_write_b64 v13, v[24:25] offset:18944
    v_cvt_pk_bf16_f32 v26, v180, v181
    v_cvt_pk_bf16_f32 v27, v182, v183
    ds_write_b64 v13, v[26:27] offset:19456
    v_cvt_pk_bf16_f32 v28, v184, v185
    v_cvt_pk_bf16_f32 v29, v186, v187
    ds_write_b64 v13, v[28:29] offset:19968
    v_cvt_pk_bf16_f32 v30, v188, v189
    v_cvt_pk_bf16_f32 v31, v190, v191
    ds_write_b64 v13, v[30:31] offset:20480
    v_cvt_pk_bf16_f32 v16, v192, v193
    v_cvt_pk_bf16_f32 v17, v194, v195
    ds_write_b64 v12, v[16:17] offset:34304
    v_cvt_pk_bf16_f32 v18, v196, v197
    v_cvt_pk_bf16_f32 v19, v198, v199
    ds_write_b64 v12, v[18:19] offset:34816
    v_cvt_pk_bf16_f32 v20, v200, v201
    v_cvt_pk_bf16_f32 v21, v202, v203
    ds_write_b64 v12, v[20:21] offset:35328
    v_cvt_pk_bf16_f32 v22, v204, v205
    v_cvt_pk_bf16_f32 v23, v206, v207
    ds_write_b64 v12, v[22:23] offset:35840
    v_cvt_pk_bf16_f32 v24, v208, v209
    v_cvt_pk_bf16_f32 v25, v210, v211
    ds_write_b64 v12, v[24:25] offset:36352
    v_cvt_pk_bf16_f32 v26, v212, v213
    v_cvt_pk_bf16_f32 v27, v214, v215
    ds_write_b64 v12, v[26:27] offset:36864
    v_cvt_pk_bf16_f32 v28, v216, v217
    v_cvt_pk_bf16_f32 v29, v218, v219
    ds_write_b64 v12, v[28:29] offset:37376
    v_cvt_pk_bf16_f32 v30, v220, v221
    v_cvt_pk_bf16_f32 v31, v222, v223
    ds_write_b64 v12, v[30:31] offset:37888
    v_cvt_pk_bf16_f32 v16, v224, v225
    v_cvt_pk_bf16_f32 v17, v226, v227
    ds_write_b64 v13, v[16:17] offset:34304
    v_cvt_pk_bf16_f32 v18, v228, v229
    v_cvt_pk_bf16_f32 v19, v230, v231
    ds_write_b64 v13, v[18:19] offset:34816
    v_cvt_pk_bf16_f32 v20, v232, v233
    v_cvt_pk_bf16_f32 v21, v234, v235
    ds_write_b64 v13, v[20:21] offset:35328
    v_cvt_pk_bf16_f32 v22, v236, v237
    v_cvt_pk_bf16_f32 v23, v238, v239
    ds_write_b64 v13, v[22:23] offset:35840
    v_cvt_pk_bf16_f32 v24, v240, v241
    v_cvt_pk_bf16_f32 v25, v242, v243
    ds_write_b64 v13, v[24:25] offset:36352
    v_cvt_pk_bf16_f32 v26, v244, v245
    v_cvt_pk_bf16_f32 v27, v246, v247
    ds_write_b64 v13, v[26:27] offset:36864
    v_cvt_pk_bf16_f32 v28, v248, v249
    v_cvt_pk_bf16_f32 v29, v250, v251
    ds_write_b64 v13, v[28:29] offset:37376
    v_cvt_pk_bf16_f32 v30, v252, v253
    v_cvt_pk_bf16_f32 v31, v254, v255
    ds_write_b64 v13, v[30:31] offset:37888
L_q_attn:
    s_lshr_b32 s46, s31, 2
    s_and_b32 s47, s31, 3
    v_lshrrev_b32 v5, 1, v4
    v_and_b32 v5, 3, v5
    v_xor_b32 v5, v5, v3
    v_lshlrev_b32 v5, 4, v5
    v_lshl_add_u32 v5, v4, 6, v5
    s_mul_i32 s38, s46, 51200
    s_lshl_b32 s40, s47, 11
    s_add_u32 s38, s38, s40
    v_add_u32 v5, s38, v5
    v_lshrrev_b32 v6, 2, v4
    v_lshl_add_u32 v6, v3, 2, v6
    v_lshrrev_b32 v7, 1, v6
    v_and_b32 v7, 3, v7
    v_lshrrev_b32 v8, 1, v4
    v_and_b32 v8, 1, v8
    v_xor_b32 v7, v7, v8
    v_lshlrev_b32 v6, 6, v6
    v_and_b32 v8, 1, v4
    v_lshl_add_u32 v6, v8, 3, v6
    v_add_u32 v6, s38, v6
    v_lshl_add_u32 v8, v7, 4, v6
    v_xor_b32 v7, 2, v7
    v_lshl_add_u32 v9, v7, 4, v6
    v_lshlrev_b32 v6, 2, v3
    v_sub_u32 v6, v4, v6
    v_add_u32 v7, 16, v6
    v_cmp_gt_u32 s[56:57], 8, v7
    v_add_u32 v7, 15, v6
    v_cmp_gt_u32 s[58:59], 8, v7
    v_add_u32 v7, 14, v6
    v_cmp_gt_u32 s[60:61], 8, v7
    v_add_u32 v7, 13, v6
    v_cmp_gt_u32 s[62:63], 8, v7
    v_add_u32 v7, 0, v6
    v_cmp_gt_u32 s[64:65], 8, v7
    v_add_u32 v7, 4294967295, v6
    v_cmp_gt_u32 s[66:67], 8, v7
    v_add_u32 v7, 4294967294, v6
    v_cmp_gt_u32 s[68:69], 8, v7
    v_add_u32 v7, 4294967293, v6
    v_cmp_gt_u32 s[70:71], 8, v7
    s_or_b32 s38, s32, s47
    s_cmp_eq_u32 s38, 0
    s_cselect_b64 s[72:73], 0, -1
    s_and_b64 s[74:75], s[56:57], s[72:73]
    s_and_b64 s[76:77], s[58:59], s[72:73]
    s_and_b64 s[78:79], s[60:61], s[72:73]
    s_and_b64 s[80:81], s[62:63], s[72:73]
    s_mov_b32 s52, 0xffff0000
    s_mov_b32 s53, 0x3e3504f3
    s_mov_b32 s54, 0x3fb8aa3b
    v_mov_b32 v10, 0xf149f2ca
    v_and_b32 v6, 1, v3
    v_lshrrev_b32 v7, 1, v3
    v_lshl_add_u32 v6, v6, 1, v7
    v_lshlrev_b32 v6, 15, v6
    v_lshl_add_u32 v11, v4, 5, v6
    s_lshl_b32 s38, s33, 1
    s_add_u32 s38, s38, s46
    s_lshl_b32 s38, s38, 17
    s_add_u32 s38, s38, s36
    s_lshl_b32 s40, s47, 10
    s_add_u32 s55, s38, s40
    s_waitcnt lgkmcnt(0)
    s_barrier
    ds_read_b128 v[16:19], v5 offset:0
    ds_read_b128 v[20:23], v5 offset:15872
    ds_read_b128 v[24:27], v5 offset:16896
    ds_read_b128 v[64:67], v5 offset:1024
    ds_read_b128 v[68:71], v5 offset:16896
    ds_read_b128 v[72:75], v5 offset:17920
    ds_read_b128 v[112:115], v5 offset:8192
    ds_read_b128 v[116:119], v5 offset:24576
    ds_read_b128 v[120:123], v5 offset:25600
    ds_read_b128 v[160:163], v5 offset:9216
    ds_read_b128 v[164:167], v5 offset:25600
    ds_read_b128 v[168:171], v5 offset:26624
    ds_read_b64_tr_b16 v[28:29], v8 offset:33280
    ds_read_b64_tr_b16 v[30:31], v8 offset:34304
    ds_read_b64_tr_b16 v[32:33], v9 offset:33280
    ds_read_b64_tr_b16 v[34:35], v9 offset:34304
    ds_read_b64_tr_b16 v[76:77], v8 offset:34304
    ds_read_b64_tr_b16 v[78:79], v8 offset:35328
    ds_read_b64_tr_b16 v[80:81], v9 offset:34304
    ds_read_b64_tr_b16 v[82:83], v9 offset:35328
    ds_read_b64_tr_b16 v[124:125], v8 offset:41984
    ds_read_b64_tr_b16 v[126:127], v8 offset:43008
    ds_read_b64_tr_b16 v[128:129], v9 offset:41984
    ds_read_b64_tr_b16 v[130:131], v9 offset:43008
    ds_read_b64_tr_b16 v[172:173], v8 offset:43008
    ds_read_b64_tr_b16 v[174:175], v8 offset:44032
    ds_read_b64_tr_b16 v[176:177], v9 offset:43008
    ds_read_b64_tr_b16 v[178:179], v9 offset:44032
    s_waitcnt lgkmcnt(15)
    s_waitcnt lgkmcnt(15)
    v_mfma_f32_16x16x32_bf16 v[36:39], v[20:23], v[16:19], 0
    v_mfma_f32_16x16x32_bf16 v[40:43], v[24:27], v[16:19], 0
    s_waitcnt lgkmcnt(15)
    v_mfma_f32_16x16x32_bf16 v[84:87], v[68:71], v[64:67], 0
    v_mfma_f32_16x16x32_bf16 v[88:91], v[72:75], v[64:67], 0
    s_waitcnt lgkmcnt(15)
    v_mfma_f32_16x16x32_bf16 v[132:135], v[116:119], v[112:115], 0
    v_mfma_f32_16x16x32_bf16 v[136:139], v[120:123], v[112:115], 0
    s_waitcnt lgkmcnt(15)
    v_mfma_f32_16x16x32_bf16 v[180:183], v[164:167], v[160:163], 0
    v_mfma_f32_16x16x32_bf16 v[184:187], v[168:171], v[160:163], 0
    s_nop 7
    v_cvt_pk_bf16_f32 v16, v36, v37
    v_cvt_pk_bf16_f32 v17, v38, v39
    v_cvt_pk_bf16_f32 v18, v40, v41
    v_cvt_pk_bf16_f32 v19, v42, v43
    v_lshlrev_b32 v36, 16, v16
    v_and_b32 v37, s52, v16
    v_lshlrev_b32 v38, 16, v17
    v_and_b32 v39, s52, v17
    v_lshlrev_b32 v40, 16, v18
    v_and_b32 v41, s52, v18
    v_lshlrev_b32 v42, 16, v19
    v_and_b32 v43, s52, v19
    v_mul_f32 v36, s53, v36
    v_mul_f32 v37, s53, v37
    v_mul_f32 v38, s53, v38
    v_mul_f32 v39, s53, v39
    v_mul_f32 v40, s53, v40
    v_mul_f32 v41, s53, v41
    v_mul_f32 v42, s53, v42
    v_mul_f32 v43, s53, v43
    v_cvt_pk_bf16_f32 v16, v36, v37
    v_cvt_pk_bf16_f32 v17, v38, v39
    v_cvt_pk_bf16_f32 v18, v40, v41
    v_cvt_pk_bf16_f32 v19, v42, v43
    v_lshlrev_b32 v36, 16, v16
    v_and_b32 v37, s52, v16
    v_lshlrev_b32 v38, 16, v17
    v_and_b32 v39, s52, v17
    v_lshlrev_b32 v40, 16, v18
    v_and_b32 v41, s52, v18
    v_lshlrev_b32 v42, 16, v19
    v_and_b32 v43, s52, v19
    v_cndmask_b32 v36, v10, v36, s[74:75]
    v_cndmask_b32 v37, v10, v37, s[76:77]
    v_cndmask_b32 v38, v10, v38, s[78:79]
    v_cndmask_b32 v39, v10, v39, s[80:81]
    v_cndmask_b32 v40, v10, v40, s[64:65]
    v_cndmask_b32 v41, v10, v41, s[66:67]
    v_cndmask_b32 v42, v10, v42, s[68:69]
    v_cndmask_b32 v43, v10, v43, s[70:71]
    v_max3_f32 v44, v36, v37, v38
    v_max3_f32 v45, v39, v40, v41
    v_max3_f32 v44, v44, v42, v43
    v_max_f32 v44, v44, v45
    v_cvt_pk_bf16_f32 v64, v84, v85
    v_cvt_pk_bf16_f32 v65, v86, v87
    v_cvt_pk_bf16_f32 v66, v88, v89
    v_cvt_pk_bf16_f32 v67, v90, v91
    v_lshlrev_b32 v84, 16, v64
    v_and_b32 v85, s52, v64
    v_lshlrev_b32 v86, 16, v65
    v_and_b32 v87, s52, v65
    v_lshlrev_b32 v88, 16, v66
    v_and_b32 v89, s52, v66
    v_lshlrev_b32 v90, 16, v67
    v_and_b32 v91, s52, v67
    v_mul_f32 v84, s53, v84
    v_mul_f32 v85, s53, v85
    v_mul_f32 v86, s53, v86
    v_mul_f32 v87, s53, v87
    v_mul_f32 v88, s53, v88
    v_mul_f32 v89, s53, v89
    v_mul_f32 v90, s53, v90
    v_mul_f32 v91, s53, v91
    v_cvt_pk_bf16_f32 v64, v84, v85
    v_cvt_pk_bf16_f32 v65, v86, v87
    v_cvt_pk_bf16_f32 v66, v88, v89
    v_cvt_pk_bf16_f32 v67, v90, v91
    v_lshlrev_b32 v84, 16, v64
    v_and_b32 v85, s52, v64
    v_lshlrev_b32 v86, 16, v65
    v_and_b32 v87, s52, v65
    v_lshlrev_b32 v88, 16, v66
    v_and_b32 v89, s52, v66
    v_lshlrev_b32 v90, 16, v67
    v_and_b32 v91, s52, v67
    v_cndmask_b32 v84, v10, v84, s[56:57]
    v_cndmask_b32 v85, v10, v85, s[58:59]
    v_cndmask_b32 v86, v10, v86, s[60:61]
    v_cndmask_b32 v87, v10, v87, s[62:63]
    v_cndmask_b32 v88, v10, v88, s[64:65]
    v_cndmask_b32 v89, v10, v89, s[66:67]
    v_cndmask_b32 v90, v10, v90, s[68:69]
    v_cndmask_b32 v91, v10, v91, s[70:71]
    v_max3_f32 v92, v84, v85, v86
    v_max3_f32 v93, v87, v88, v89
    v_max3_f32 v92, v92, v90, v91
    v_max_f32 v92, v92, v93
    v_cvt_pk_bf16_f32 v112, v132, v133
    v_cvt_pk_bf16_f32 v113, v134, v135
    v_cvt_pk_bf16_f32 v114, v136, v137
    v_cvt_pk_bf16_f32 v115, v138, v139
    v_lshlrev_b32 v132, 16, v112
    v_and_b32 v133, s52, v112
    v_lshlrev_b32 v134, 16, v113
    v_and_b32 v135, s52, v113
    v_lshlrev_b32 v136, 16, v114
    v_and_b32 v137, s52, v114
    v_lshlrev_b32 v138, 16, v115
    v_and_b32 v139, s52, v115
    v_mul_f32 v132, s53, v132
    v_mul_f32 v133, s53, v133
    v_mul_f32 v134, s53, v134
    v_mul_f32 v135, s53, v135
    v_mul_f32 v136, s53, v136
    v_mul_f32 v137, s53, v137
    v_mul_f32 v138, s53, v138
    v_mul_f32 v139, s53, v139
    v_cvt_pk_bf16_f32 v112, v132, v133
    v_cvt_pk_bf16_f32 v113, v134, v135
    v_cvt_pk_bf16_f32 v114, v136, v137
    v_cvt_pk_bf16_f32 v115, v138, v139
    v_lshlrev_b32 v132, 16, v112
    v_and_b32 v133, s52, v112
    v_lshlrev_b32 v134, 16, v113
    v_and_b32 v135, s52, v113
    v_lshlrev_b32 v136, 16, v114
    v_and_b32 v137, s52, v114
    v_lshlrev_b32 v138, 16, v115
    v_and_b32 v139, s52, v115
    v_cndmask_b32 v132, v10, v132, s[74:75]
    v_cndmask_b32 v133, v10, v133, s[76:77]
    v_cndmask_b32 v134, v10, v134, s[78:79]
    v_cndmask_b32 v135, v10, v135, s[80:81]
    v_cndmask_b32 v136, v10, v136, s[64:65]
    v_cndmask_b32 v137, v10, v137, s[66:67]
    v_cndmask_b32 v138, v10, v138, s[68:69]
    v_cndmask_b32 v139, v10, v139, s[70:71]
    v_max3_f32 v140, v132, v133, v134
    v_max3_f32 v141, v135, v136, v137
    v_max3_f32 v140, v140, v138, v139
    v_max_f32 v140, v140, v141
    v_cvt_pk_bf16_f32 v160, v180, v181
    v_cvt_pk_bf16_f32 v161, v182, v183
    v_cvt_pk_bf16_f32 v162, v184, v185
    v_cvt_pk_bf16_f32 v163, v186, v187
    v_lshlrev_b32 v180, 16, v160
    v_and_b32 v181, s52, v160
    v_lshlrev_b32 v182, 16, v161
    v_and_b32 v183, s52, v161
    v_lshlrev_b32 v184, 16, v162
    v_and_b32 v185, s52, v162
    v_lshlrev_b32 v186, 16, v163
    v_and_b32 v187, s52, v163
    v_mul_f32 v180, s53, v180
    v_mul_f32 v181, s53, v181
    v_mul_f32 v182, s53, v182
    v_mul_f32 v183, s53, v183
    v_mul_f32 v184, s53, v184
    v_mul_f32 v185, s53, v185
    v_mul_f32 v186, s53, v186
    v_mul_f32 v187, s53, v187
    v_cvt_pk_bf16_f32 v160, v180, v181
    v_cvt_pk_bf16_f32 v161, v182, v183
    v_cvt_pk_bf16_f32 v162, v184, v185
    v_cvt_pk_bf16_f32 v163, v186, v187
    v_lshlrev_b32 v180, 16, v160
    v_and_b32 v181, s52, v160
    v_lshlrev_b32 v182, 16, v161
    v_and_b32 v183, s52, v161
    v_lshlrev_b32 v184, 16, v162
    v_and_b32 v185, s52, v162
    v_lshlrev_b32 v186, 16, v163
    v_and_b32 v187, s52, v163
    v_cndmask_b32 v180, v10, v180, s[56:57]
    v_cndmask_b32 v181, v10, v181, s[58:59]
    v_cndmask_b32 v182, v10, v182, s[60:61]
    v_cndmask_b32 v183, v10, v183, s[62:63]
    v_cndmask_b32 v184, v10, v184, s[64:65]
    v_cndmask_b32 v185, v10, v185, s[66:67]
    v_cndmask_b32 v186, v10, v186, s[68:69]
    v_cndmask_b32 v187, v10, v187, s[70:71]
    v_max3_f32 v188, v180, v181, v182
    v_max3_f32 v189, v183, v184, v185
    v_max3_f32 v188, v188, v186, v187
    v_max_f32 v188, v188, v189
    v_mov_b32 v45, v44
    v_mov_b32 v93, v92
    v_mov_b32 v141, v140
    v_mov_b32 v189, v188
    s_nop 0
    v_permlane16_swap_b32 v44, v45
    v_permlane16_swap_b32 v92, v93
    v_permlane16_swap_b32 v140, v141
    v_permlane16_swap_b32 v188, v189
    v_max_f32 v44, v44, v45
    v_max_f32 v92, v92, v93
    v_max_f32 v140, v140, v141
    v_max_f32 v188, v188, v189
    v_mov_b32 v45, v44
    v_mov_b32 v93, v92
    v_mov_b32 v141, v140
    v_mov_b32 v189, v188
    s_nop 0
    v_permlane32_swap_b32 v44, v45
    v_permlane32_swap_b32 v92, v93
    v_permlane32_swap_b32 v140, v141
    v_permlane32_swap_b32 v188, v189
    v_max_f32 v44, v44, v45
    v_max_f32 v92, v92, v93
    v_max_f32 v140, v140, v141
    v_max_f32 v188, v188, v189
    v_mul_f32 v45, s54, v44
    v_fma_f32 v36, v36, s54, -v45
    v_fma_f32 v37, v37, s54, -v45
    v_fma_f32 v38, v38, s54, -v45
    v_fma_f32 v39, v39, s54, -v45
    v_fma_f32 v40, v40, s54, -v45
    v_fma_f32 v41, v41, s54, -v45
    v_fma_f32 v42, v42, s54, -v45
    v_fma_f32 v43, v43, s54, -v45
    v_exp_f32 v36, v36
    v_exp_f32 v37, v37
    v_exp_f32 v38, v38
    v_exp_f32 v39, v39
    v_exp_f32 v40, v40
    v_exp_f32 v41, v41
    v_exp_f32 v42, v42
    v_exp_f32 v43, v43
    s_nop 0
    v_add_f32 v44, v36, v37
    v_add_f32 v45, v38, v39
    v_add_f32 v44, v44, v40
    v_add_f32 v45, v45, v41
    v_add_f32 v44, v44, v42
    v_add_f32 v45, v45, v43
    v_add_f32 v44, v44, v45
    v_mul_f32 v93, s54, v92
    v_fma_f32 v84, v84, s54, -v93
    v_fma_f32 v85, v85, s54, -v93
    v_fma_f32 v86, v86, s54, -v93
    v_fma_f32 v87, v87, s54, -v93
    v_fma_f32 v88, v88, s54, -v93
    v_fma_f32 v89, v89, s54, -v93
    v_fma_f32 v90, v90, s54, -v93
    v_fma_f32 v91, v91, s54, -v93
    v_exp_f32 v84, v84
    v_exp_f32 v85, v85
    v_exp_f32 v86, v86
    v_exp_f32 v87, v87
    v_exp_f32 v88, v88
    v_exp_f32 v89, v89
    v_exp_f32 v90, v90
    v_exp_f32 v91, v91
    s_nop 0
    v_add_f32 v92, v84, v85
    v_add_f32 v93, v86, v87
    v_add_f32 v92, v92, v88
    v_add_f32 v93, v93, v89
    v_add_f32 v92, v92, v90
    v_add_f32 v93, v93, v91
    v_add_f32 v92, v92, v93
    v_mul_f32 v141, s54, v140
    v_fma_f32 v132, v132, s54, -v141
    v_fma_f32 v133, v133, s54, -v141
    v_fma_f32 v134, v134, s54, -v141
    v_fma_f32 v135, v135, s54, -v141
    v_fma_f32 v136, v136, s54, -v141
    v_fma_f32 v137, v137, s54, -v141
    v_fma_f32 v138, v138, s54, -v141
    v_fma_f32 v139, v139, s54, -v141
    v_exp_f32 v132, v132
    v_exp_f32 v133, v133
    v_exp_f32 v134, v134
    v_exp_f32 v135, v135
    v_exp_f32 v136, v136
    v_exp_f32 v137, v137
    v_exp_f32 v138, v138
    v_exp_f32 v139, v139
    s_nop 0
    v_add_f32 v140, v132, v133
    v_add_f32 v141, v134, v135
    v_add_f32 v140, v140, v136
    v_add_f32 v141, v141, v137
    v_add_f32 v140, v140, v138
    v_add_f32 v141, v141, v139
    v_add_f32 v140, v140, v141
    v_mul_f32 v189, s54, v188
    v_fma_f32 v180, v180, s54, -v189
    v_fma_f32 v181, v181, s54, -v189
    v_fma_f32 v182, v182, s54, -v189
    v_fma_f32 v183, v183, s54, -v189
    v_fma_f32 v184, v184, s54, -v189
    v_fma_f32 v185, v185, s54, -v189
    v_fma_f32 v186, v186, s54, -v189
    v_fma_f32 v187, v187, s54, -v189
    v_exp_f32 v180, v180
    v_exp_f32 v181, v181
    v_exp_f32 v182, v182
    v_exp_f32 v183, v183
    v_exp_f32 v184, v184
    v_exp_f32 v185, v185
    v_exp_f32 v186, v186
    v_exp_f32 v187, v187
    s_nop 0
    v_add_f32 v188, v180, v181
    v_add_f32 v189, v182, v183
    v_add_f32 v188, v188, v184
    v_add_f32 v189, v189, v185
    v_add_f32 v188, v188, v186
    v_add_f32 v189, v189, v187
    v_add_f32 v188, v188, v189
    v_mov_b32 v45, v44
    v_mov_b32 v93, v92
    v_mov_b32 v141, v140
    v_mov_b32 v189, v188
    s_nop 0
    v_permlane16_swap_b32 v44, v45
    v_permlane16_swap_b32 v92, v93
    v_permlane16_swap_b32 v140, v141
    v_permlane16_swap_b32 v188, v189
    v_add_f32 v44, v44, v45
    v_add_f32 v92, v92, v93
    v_add_f32 v140, v140, v141
    v_add_f32 v188, v188, v189
    v_mov_b32 v45, v44
    v_mov_b32 v93, v92
    v_mov_b32 v141, v140
    v_mov_b32 v189, v188
    s_nop 0
    v_permlane32_swap_b32 v44, v45
    v_permlane32_swap_b32 v92, v93
    v_permlane32_swap_b32 v140, v141
    v_permlane32_swap_b32 v188, v189
    v_add_f32 v44, v44, v45
    v_add_f32 v92, v92, v93
    v_add_f32 v140, v140, v141
    v_add_f32 v188, v188, v189
    v_rcp_f32 v44, v44
    v_rcp_f32 v92, v92
    v_rcp_f32 v140, v140
    v_rcp_f32 v188, v188
    v_mul_f32 v36, v36, v44
    v_mul_f32 v37, v37, v44
    v_mul_f32 v38, v38, v44
    v_mul_f32 v39, v39, v44
    v_mul_f32 v40, v40, v44
    v_mul_f32 v41, v41, v44
    v_mul_f32 v42, v42, v44
    v_mul_f32 v43, v43, v44
    v_cvt_pk_bf16_f32 v16, v36, v37
    v_cvt_pk_bf16_f32 v17, v38, v39
    v_cvt_pk_bf16_f32 v18, v40, v41
    v_cvt_pk_bf16_f32 v19, v42, v43
    v_mul_f32 v84, v84, v92
    v_mul_f32 v85, v85, v92
    v_mul_f32 v86, v86, v92
    v_mul_f32 v87, v87, v92
    v_mul_f32 v88, v88, v92
    v_mul_f32 v89, v89, v92
    v_mul_f32 v90, v90, v92
    v_mul_f32 v91, v91, v92
    v_cvt_pk_bf16_f32 v64, v84, v85
    v_cvt_pk_bf16_f32 v65, v86, v87
    v_cvt_pk_bf16_f32 v66, v88, v89
    v_cvt_pk_bf16_f32 v67, v90, v91
    v_mul_f32 v132, v132, v140
    v_mul_f32 v133, v133, v140
    v_mul_f32 v134, v134, v140
    v_mul_f32 v135, v135, v140
    v_mul_f32 v136, v136, v140
    v_mul_f32 v137, v137, v140
    v_mul_f32 v138, v138, v140
    v_mul_f32 v139, v139, v140
    v_cvt_pk_bf16_f32 v112, v132, v133
    v_cvt_pk_bf16_f32 v113, v134, v135
    v_cvt_pk_bf16_f32 v114, v136, v137
    v_cvt_pk_bf16_f32 v115, v138, v139
    v_mul_f32 v180, v180, v188
    v_mul_f32 v181, v181, v188
    v_mul_f32 v182, v182, v188
    v_mul_f32 v183, v183, v188
    v_mul_f32 v184, v184, v188
    v_mul_f32 v185, v185, v188
    v_mul_f32 v186, v186, v188
    v_mul_f32 v187, v187, v188
    v_cvt_pk_bf16_f32 v160, v180, v181
    v_cvt_pk_bf16_f32 v161, v182, v183
    v_cvt_pk_bf16_f32 v162, v184, v185
    v_cvt_pk_bf16_f32 v163, v186, v187
    s_waitcnt lgkmcnt(0)
    s_nop 0
    v_mfma_f32_16x16x32_bf16 v[52:55], v[28:31], v[16:19], 0
    v_mfma_f32_16x16x32_bf16 v[56:59], v[32:35], v[16:19], 0
    v_mfma_f32_16x16x32_bf16 v[100:103], v[76:79], v[64:67], 0
    v_mfma_f32_16x16x32_bf16 v[104:107], v[80:83], v[64:67], 0
    v_mfma_f32_16x16x32_bf16 v[148:151], v[124:127], v[112:115], 0
    v_mfma_f32_16x16x32_bf16 v[152:155], v[128:131], v[112:115], 0
    v_mfma_f32_16x16x32_bf16 v[196:199], v[172:175], v[160:163], 0
    v_mfma_f32_16x16x32_bf16 v[200:203], v[176:179], v[160:163], 0
    s_nop 7
    v_cvt_pk_bf16_f32 v20, v52, v53
    v_cvt_pk_bf16_f32 v21, v54, v55
    v_cvt_pk_bf16_f32 v22, v56, v57
    v_cvt_pk_bf16_f32 v23, v58, v59
    v_cvt_pk_bf16_f32 v68, v100, v101
    v_cvt_pk_bf16_f32 v69, v102, v103
    v_cvt_pk_bf16_f32 v70, v104, v105
    v_cvt_pk_bf16_f32 v71, v106, v107
    v_cvt_pk_bf16_f32 v116, v148, v149
    v_cvt_pk_bf16_f32 v117, v150, v151
    v_cvt_pk_bf16_f32 v118, v152, v153
    v_cvt_pk_bf16_f32 v119, v154, v155
    v_cvt_pk_bf16_f32 v164, v196, v197
    v_cvt_pk_bf16_f32 v165, v198, v199
    v_cvt_pk_bf16_f32 v166, v200, v201
    v_cvt_pk_bf16_f32 v167, v202, v203
    v_permlane16_swap_b32 v20, v22
    v_permlane16_swap_b32 v21, v23
    v_permlane16_swap_b32 v68, v70
    v_permlane16_swap_b32 v69, v71
    v_permlane16_swap_b32 v116, v118
    v_permlane16_swap_b32 v117, v119
    v_permlane16_swap_b32 v164, v166
    v_permlane16_swap_b32 v165, v167
    v_and_b32 v6, 1, v3
    v_lshrrev_b32 v7, 1, v3
    v_lshl_add_u32 v6, v6, 1, v7
    v_lshlrev_b32 v6, 10, v6
    v_lshl_add_u32 v6, v4, 5, v6
    s_lshl_b32 s38, s31, 12
    s_add_u32 s38, s38, 102400
    v_add_u32 v6, s38, v6
    v_lshlrev_b32 v11, 4, v2
    v_add_u32 v7, s38, v11
    ds_write_b128 v6, v[20:23] offset:0
    ds_write_b128 v6, v[68:71] offset:512
    ds_write_b128 v6, v[116:119] offset:16
    ds_write_b128 v6, v[164:167] offset:528
    s_waitcnt lgkmcnt(0)
    ds_read_b128 v[16:19], v7 offset:0
    ds_read_b128 v[20:23], v7 offset:1024
    ds_read_b128 v[24:27], v7 offset:2048
    ds_read_b128 v[28:31], v7 offset:3072
    s_add_u32 s38, s55, 0
    s_waitcnt lgkmcnt(3)
    buffer_store_dwordx4 v[16:19], v11, s[16:19], s38 offen sc1
    s_add_u32 s38, s55, 32768
    s_waitcnt lgkmcnt(2)
    buffer_store_dwordx4 v[20:23], v11, s[16:19], s38 offen sc1
    s_add_u32 s38, s55, 65536
    s_waitcnt lgkmcnt(1)
    buffer_store_dwordx4 v[24:27], v11, s[16:19], s38 offen sc1
    s_add_u32 s38, s55, 98304
    s_waitcnt lgkmcnt(0)
    buffer_store_dwordx4 v[28:31], v11, s[16:19], s38 offen sc1
    s_lshl_b32 s38, s32, 4
    s_add_u32 s38, s38, s33
    s_lshl_b32 s38, s38, 7
    s_add_u32 s54, s38, 0x104000
    s_lshl_b32 s32, s32, 1
    s_and_b32 s38, s33, 1
    s_add_u32 s32, s32, s38
    s_lshr_b32 s33, s33, 1
    s_mov_b32 s8, s4
    s_and_b32 s9, s5, 0xffff
    s_mov_b32 s10, 0x200000
    s_mov_b32 s11, 0x00020000
    s_add_u32 s12, s34, 0x1000000
    s_addc_u32 s13, s35, 0
    s_and_b32 s13, s13, 0xffff
    s_mov_b32 s14, 0x400000
    s_mov_b32 s15, 0x00020000
    s_mov_b32 s16, s6
    s_and_b32 s17, s7, 0xffff
    s_mov_b32 s18, 0xe00000
    s_mov_b32 s19, 0x00020000
    s_add_u32 s20, s34, 0x800000
    s_addc_u32 s21, s35, 0
    s_and_b32 s21, s21, 0xffff
    s_mov_b32 s22, 0x700000
    s_mov_b32 s23, 0x00020000
    s_add_u32 s24, s34, 0x1400000
    s_addc_u32 s25, s35, 0
    s_and_b32 s25, s25, 0xffff
    s_mov_b32 s26, 0x200000
    s_mov_b32 s27, 0x00020000
    s_lshl_b32 s49, s32, 3
    s_add_u32 s49, s49, s33
    s_waitcnt vmcnt(0)
    v_readfirstlane_b32 s3, v1
    s_nop 3
    s_cmp_lg_u32 s3, 0
    s_cbranch_scc1 L_aepok_21
    s_mov_b32 s96, s82
    s_and_b32 s97, s83, 0xffff
    s_mov_b32 s98, 0x100
    s_mov_b32 s99, 0x00020000
    v_mov_b32 v6, 0
    s_mov_b32 s87, 0x40000
L_aep_22:
    buffer_load_dword v5, v6, s[96:99], 0 offen sc1
    s_waitcnt vmcnt(0)
    v_cmp_eq_u32 vcc, 0, v5
    s_sub_u32 s87, s87, 1
    s_cbranch_scc1 L_aepd_23
    s_cbranch_vccz L_aepd_23
    s_sleep 2
    s_branch L_aep_22
L_aepd_23:
    v_readfirstlane_b32 s3, v5
    s_nop 4
L_aepok_21:
    v_mov_b32 v6, 0
    s_sub_u32 s39, s31, 4
    s_waitcnt vmcnt(0)
    s_barrier
    s_cmp_lt_u32 s31, 4
    s_cbranch_scc1 L_a_fcons
    v_lshlrev_b32 v5, 4, v2
    s_lshl_b32 s38, s39, 14
    s_lshl_b32 s44, s33, 11
    s_add_u32 s38, s38, s44
    v_add_u32 v9, s38, v5
    s_and_b32 s38, s39, 1
    s_lshl_b32 s38, s38, 2
    v_or_b32 v6, s38, v3
    v_lshlrev_b32 v6, 1, v6
    v_xor_b32 v6, v6, v4
    v_lshlrev_b32 v6, 4, v6
    s_lshl_b32 s38, s39, 3
    v_add_u32 v7, s38, v3
    s_lshl_b32 s44, s32, 8
    v_lshl_add_u32 v20, v7, 12, v6
    v_add_u32 v12, s44, v20
    v_add_u32 v13, 15360, v12
    s_lshl_b32 s44, s39, 11
    v_lshlrev_b32 v14, 7, v4
    s_lshl_b32 s46, s33, 11
    s_add_u32 s46, s46, 0x108000
    s_lshl_b32 s38, s39, 15
    s_lshl_b32 s40, s32, 11
    s_add_u32 s38, s38, s40
    v_add_u32 v8, s38, v5
    s_lshl_b32 s38, s33, 8
    v_lshl_add_u32 v10, v7, 11, v6
    v_add_u32 v10, s38, v10
    v_add_u32 v11, 7168, v10
    s_lshl_b32 s38, s33, 1
    s_and_b32 s40, s32, 1
    s_add_u32 s38, s38, s40
    s_mov_b32 s38, 0
    s_lshl_b32 s40, s38, 18
    s_lshl_b32 s41, s38, 17
    v_min_u32 v18, 3, v2
    v_add_u32 v18, s38, v18
    v_and_b32 v18, 15, v18
    v_lshlrev_b32 v18, 7, v18
    s_mov_b32 s42, 34
    s_lshl_b32 s43, s42, 17
    s_lshl_b32 s42, s42, 16
    s_lshr_b32 s45, s32, 1
    s_lshl_b32 s45, s45, 11
    s_add_u32 s45, s45, 0x104000
    s_add_u32 m0, s44, 8192
    s_nop 0
    buffer_load_dwordx4 v10, s[8:11], s41 offen lds
    buffer_load_dwordx4 v11, s[8:11], s41 offen offset:1024 lds
    s_add_u32 s41, s41, 65536
    s_and_b32 s41, s41, 0x1fffff
    s_add_u32 m0, s44, 24576
    s_nop 0
    buffer_load_dwordx4 v10, s[8:11], s41 offen lds
    buffer_load_dwordx4 v11, s[8:11], s41 offen offset:1024 lds
    s_add_u32 s41, s41, 65536
    s_and_b32 s41, s41, 0x1fffff
    s_add_u32 m0, s44, 40960
    s_nop 0
    buffer_load_dwordx4 v10, s[8:11], s41 offen lds
    buffer_load_dwordx4 v11, s[8:11], s41 offen offset:1024 lds
    s_add_u32 s41, s41, 65536
    s_and_b32 s41, s41, 0x1fffff
    s_add_u32 m0, s44, 57344
    s_nop 0
    buffer_load_dwordx4 v10, s[8:11], s41 offen lds
    buffer_load_dwordx4 v11, s[8:11], s41 offen offset:1024 lds
    s_add_u32 s41, s41, 65536
    s_and_b32 s41, s41, 0x1fffff
    s_add_u32 m0, s44, 73728
    s_nop 0
    buffer_load_dwordx4 v10, s[8:11], s41 offen lds
    buffer_load_dwordx4 v11, s[8:11], s41 offen offset:1024 lds
    s_add_u32 s41, s41, 65536
    s_and_b32 s41, s41, 0x1fffff
    s_add_u32 m0, s44, 90112
    s_nop 0
    buffer_load_dwordx4 v10, s[8:11], s41 offen lds
    buffer_load_dwordx4 v11, s[8:11], s41 offen offset:1024 lds
    s_add_u32 s41, s41, 65536
    s_and_b32 s41, s41, 0x1fffff
    s_add_u32 m0, s44, 106496
    s_nop 0
    buffer_load_dwordx4 v10, s[8:11], s41 offen lds
    buffer_load_dwordx4 v11, s[8:11], s41 offen offset:1024 lds
    s_add_u32 s41, s41, 65536
    s_and_b32 s41, s41, 0x1fffff
    s_add_u32 m0, s44, 122880
    s_nop 0
    buffer_load_dwordx4 v10, s[8:11], s41 offen lds
    buffer_load_dwordx4 v11, s[8:11], s41 offen offset:1024 lds
    s_add_u32 s41, s41, 65536
    s_and_b32 s41, s41, 0x1fffff
    s_cmp_lg_u32 s39, 0
    s_cbranch_scc1 L_fpolls_24
    s_mov_b32 s87, 0x40000
L_fpoll_25:
    buffer_load_dword v15, v18, s[24:27], s45 offen sc1
    s_waitcnt vmcnt(0)
    v_cmp_ne_u32 vcc, s3, v15
    s_sub_u32 s87, s87, 1
    s_cbranch_scc1 L_fpolld_26
    s_cbranch_vccz L_fpolld_26
    s_sleep 2
    s_branch L_fpoll_25
L_fpolld_26:
L_fpolls_24:
    s_barrier
    s_add_u32 m0, s44, 0
    s_nop 0
    buffer_load_dwordx4 v8, s[12:15], s40 offen sc1 lds
    buffer_load_dwordx4 v8, s[12:15], s40 offen offset:1024 sc1 lds
    s_add_u32 s40, s40, 131072
    s_and_b32 s40, s40, 0x3fffff
    s_add_u32 m0, s44, 16384
    s_nop 0
    buffer_load_dwordx4 v8, s[12:15], s40 offen sc1 lds
    buffer_load_dwordx4 v8, s[12:15], s40 offen offset:1024 sc1 lds
    s_add_u32 s40, s40, 131072
    s_and_b32 s40, s40, 0x3fffff
    s_waitcnt vmcnt(2)
    s_barrier
    s_add_u32 m0, s44, 32768
    s_nop 0
    buffer_load_dwordx4 v8, s[12:15], s40 offen sc1 lds
    buffer_load_dwordx4 v8, s[12:15], s40 offen offset:1024 sc1 lds
    s_add_u32 s40, s40, 131072
    s_and_b32 s40, s40, 0x3fffff
    s_add_u32 m0, s44, 49152
    s_nop 0
    buffer_load_dwordx4 v8, s[12:15], s40 offen sc1 lds
    buffer_load_dwordx4 v8, s[12:15], s40 offen offset:1024 sc1 lds
    s_add_u32 s40, s40, 131072
    s_and_b32 s40, s40, 0x3fffff
    s_add_u32 m0, s44, 65536
    s_nop 0
    buffer_load_dwordx4 v8, s[12:15], s40 offen sc1 lds
    buffer_load_dwordx4 v8, s[12:15], s40 offen offset:1024 sc1 lds
    s_add_u32 s40, s40, 131072
    s_and_b32 s40, s40, 0x3fffff
    s_add_u32 m0, s44, 81920
    s_nop 0
    buffer_load_dwordx4 v8, s[12:15], s40 offen sc1 lds
    buffer_load_dwordx4 v8, s[12:15], s40 offen offset:1024 sc1 lds
    s_add_u32 s40, s40, 131072
    s_and_b32 s40, s40, 0x3fffff
    s_add_u32 m0, s44, 98304
    s_nop 0
    buffer_load_dwordx4 v8, s[12:15], s40 offen sc1 lds
    buffer_load_dwordx4 v8, s[12:15], s40 offen offset:1024 sc1 lds
    s_add_u32 s40, s40, 131072
    s_and_b32 s40, s40, 0x3fffff
    s_add_u32 m0, s44, 114688
    s_nop 0
    buffer_load_dwordx4 v8, s[12:15], s40 offen sc1 lds
    buffer_load_dwordx4 v8, s[12:15], s40 offen offset:1024 sc1 lds
    s_add_u32 s40, s40, 131072
    s_and_b32 s40, s40, 0x3fffff
    buffer_load_dword v19, v14, s[24:27], s45 offen sc1
    s_waitcnt vmcnt(11)
    s_barrier
    s_add_u32 m0, s44, 8192
    s_nop 0
    buffer_load_dwordx4 v10, s[8:11], s41 offen lds
    buffer_load_dwordx4 v11, s[8:11], s41 offen offset:1024 lds
    s_add_u32 s41, s41, 65536
    s_and_b32 s41, s41, 0x1fffff
    s_waitcnt vmcnt(9)
    s_waitcnt vmcnt(2)
    v_cmp_ne_u32 vcc, s3, v19
    s_nop 0
    s_cbranch_vccz L_ook_27
    s_mov_b32 s87, 0x40000
L_fpollo_28:
    buffer_load_dword v15, v14, s[24:27], s45 offen sc1
    s_waitcnt vmcnt(0)
    v_cmp_ne_u32 vcc, s3, v15
    s_sub_u32 s87, s87, 1
    s_cbranch_scc1 L_fpollod_29
    s_cbranch_vccz L_fpollod_29
    s_sleep 2
    s_branch L_fpollo_28
L_fpollod_29:
L_ook_27:
    s_barrier
    s_add_u32 m0, s44, 0
    s_nop 0
    buffer_load_dwordx4 v8, s[12:15], s40 offen sc1 lds
    buffer_load_dwordx4 v8, s[12:15], s40 offen offset:1024 sc1 lds
    s_add_u32 s40, s40, 131072
    s_and_b32 s40, s40, 0x3fffff
    s_add_u32 m0, s44, 16384
    s_nop 0
    buffer_load_dwordx4 v8, s[12:15], s40 offen sc1 lds
    buffer_load_dwordx4 v8, s[12:15], s40 offen offset:1024 sc1 lds
    s_add_u32 s40, s40, 131072
    s_and_b32 s40, s40, 0x3fffff
    s_add_u32 m0, s44, 24576
    s_nop 0
    buffer_load_dwordx4 v10, s[8:11], s41 offen lds
    buffer_load_dwordx4 v11, s[8:11], s41 offen offset:1024 lds
    s_add_u32 s41, s41, 65536
    s_and_b32 s41, s41, 0x1fffff
    s_add_u32 m0, s44, 32768
    s_nop 0
    buffer_load_dwordx4 v8, s[12:15], s40 offen sc1 lds
    buffer_load_dwordx4 v8, s[12:15], s40 offen offset:1024 sc1 lds
    s_add_u32 s40, s40, 131072
    s_and_b32 s40, s40, 0x3fffff
    s_add_u32 m0, s44, 40960
    s_nop 0
    buffer_load_dwordx4 v10, s[8:11], s41 offen lds
    buffer_load_dwordx4 v11, s[8:11], s41 offen offset:1024 lds
    s_add_u32 s41, s41, 65536
    s_and_b32 s41, s41, 0x1fffff
    s_waitcnt vmcnt(15)
    s_barrier
    s_add_u32 m0, s44, 49152
    s_nop 0
    buffer_load_dwordx4 v8, s[12:15], s40 offen sc1 lds
    buffer_load_dwordx4 v8, s[12:15], s40 offen offset:1024 sc1 lds
    s_add_u32 s40, s40, 131072
    s_and_b32 s40, s40, 0x3fffff
    s_add_u32 m0, s44, 57344
    s_nop 0
    buffer_load_dwordx4 v10, s[8:11], s41 offen lds
    buffer_load_dwordx4 v11, s[8:11], s41 offen offset:1024 lds
    s_add_u32 s41, s41, 65536
    s_and_b32 s41, s41, 0x1fffff
    s_add_u32 m0, s44, 65536
    s_nop 0
    buffer_load_dwordx4 v8, s[12:15], s40 offen sc1 lds
    buffer_load_dwordx4 v8, s[12:15], s40 offen offset:1024 sc1 lds
    s_add_u32 s40, s40, 131072
    s_and_b32 s40, s40, 0x3fffff
    s_add_u32 m0, s44, 73728
    s_nop 0
    buffer_load_dwordx4 v10, s[8:11], s41 offen lds
    buffer_load_dwordx4 v11, s[8:11], s41 offen offset:1024 lds
    s_add_u32 s41, s41, 65536
    s_and_b32 s41, s41, 0x1fffff
    s_waitcnt vmcnt(16)
    s_barrier
    s_add_u32 m0, s44, 81920
    s_nop 0
    buffer_load_dwordx4 v8, s[12:15], s40 offen sc1 lds
    buffer_load_dwordx4 v8, s[12:15], s40 offen offset:1024 sc1 lds
    s_add_u32 s40, s40, 131072
    s_and_b32 s40, s40, 0x3fffff
    s_add_u32 m0, s44, 90112
    s_nop 0
    buffer_load_dwordx4 v10, s[8:11], s41 offen lds
    buffer_load_dwordx4 v11, s[8:11], s41 offen offset:1024 lds
    s_add_u32 s41, s41, 65536
    s_and_b32 s41, s41, 0x1fffff
    s_add_u32 m0, s44, 98304
    s_nop 0
    buffer_load_dwordx4 v8, s[12:15], s40 offen sc1 lds
    buffer_load_dwordx4 v8, s[12:15], s40 offen offset:1024 sc1 lds
    s_add_u32 s40, s40, 131072
    s_and_b32 s40, s40, 0x3fffff
    s_add_u32 m0, s44, 106496
    s_nop 0
    buffer_load_dwordx4 v10, s[8:11], s41 offen lds
    buffer_load_dwordx4 v11, s[8:11], s41 offen offset:1024 lds
    s_add_u32 s41, s41, 65536
    s_and_b32 s41, s41, 0x1fffff
    s_waitcnt vmcnt(16)
    s_barrier
    s_add_u32 m0, s44, 114688
    s_nop 0
    buffer_load_dwordx4 v8, s[12:15], s40 offen sc1 lds
    buffer_load_dwordx4 v8, s[12:15], s40 offen offset:1024 sc1 lds
    s_add_u32 s40, s40, 131072
    s_and_b32 s40, s40, 0x3fffff
    s_add_u32 m0, s44, 122880
    s_nop 0
    buffer_load_dwordx4 v10, s[8:11], s41 offen lds
    buffer_load_dwordx4 v11, s[8:11], s41 offen offset:1024 lds
    s_add_u32 s41, s41, 65536
    s_and_b32 s41, s41, 0x1fffff
    s_add_u32 m0, s44, 0
    s_nop 0
    buffer_load_dwordx4 v8, s[12:15], s40 offen sc1 lds
    buffer_load_dwordx4 v8, s[12:15], s40 offen offset:1024 sc1 lds
    s_add_u32 s40, s40, 131072
    s_and_b32 s40, s40, 0x3fffff
    s_add_u32 m0, s44, 8192
    s_nop 0
    buffer_load_dwordx4 v10, s[8:11], s41 offen lds
    buffer_load_dwordx4 v11, s[8:11], s41 offen offset:1024 lds
    s_add_u32 s41, s41, 65536
    s_and_b32 s41, s41, 0x1fffff
    s_waitcnt vmcnt(16)
    s_barrier
    s_add_u32 m0, s44, 16384
    s_nop 0
    buffer_load_dwordx4 v8, s[12:15], s40 offen sc1 lds
    buffer_load_dwordx4 v8, s[12:15], s40 offen offset:1024 sc1 lds
    s_add_u32 s40, s40, 131072
    s_and_b32 s40, s40, 0x3fffff
    s_add_u32 m0, s44, 24576
    s_nop 0
    buffer_load_dwordx4 v10, s[8:11], s41 offen lds
    buffer_load_dwordx4 v11, s[8:11], s41 offen offset:1024 lds
    s_add_u32 s41, s41, 65536
    s_and_b32 s41, s41, 0x1fffff
    s_add_u32 m0, s44, 32768
    s_nop 0
    buffer_load_dwordx4 v8, s[12:15], s40 offen sc1 lds
    buffer_load_dwordx4 v8, s[12:15], s40 offen offset:1024 sc1 lds
    s_add_u32 s40, s40, 131072
    s_and_b32 s40, s40, 0x3fffff
    s_add_u32 m0, s44, 40960
    s_nop 0
    buffer_load_dwordx4 v10, s[8:11], s41 offen lds
    buffer_load_dwordx4 v11, s[8:11], s41 offen offset:1024 lds
    s_add_u32 s41, s41, 65536
    s_and_b32 s41, s41, 0x1fffff
    s_waitcnt vmcnt(16)
    s_barrier
    s_add_u32 m0, s44, 49152
    s_nop 0
    buffer_load_dwordx4 v8, s[12:15], s40 offen sc1 lds
    buffer_load_dwordx4 v8, s[12:15], s40 offen offset:1024 sc1 lds
    s_add_u32 s40, s40, 131072
    s_and_b32 s40, s40, 0x3fffff
    s_add_u32 m0, s44, 57344
    s_nop 0
    buffer_load_dwordx4 v10, s[8:11], s41 offen lds
    buffer_load_dwordx4 v11, s[8:11], s41 offen offset:1024 lds
    s_add_u32 s41, s41, 65536
    s_and_b32 s41, s41, 0x1fffff
    s_add_u32 m0, s44, 65536
    s_nop 0
    buffer_load_dwordx4 v8, s[12:15], s40 offen sc1 lds
    buffer_load_dwordx4 v8, s[12:15], s40 offen offset:1024 sc1 lds
    s_add_u32 s40, s40, 131072
    s_and_b32 s40, s40, 0x3fffff
    s_add_u32 m0, s44, 73728
    s_nop 0
    buffer_load_dwordx4 v10, s[8:11], s41 offen lds
    buffer_load_dwordx4 v11, s[8:11], s41 offen offset:1024 lds
    s_add_u32 s41, s41, 65536
    s_and_b32 s41, s41, 0x1fffff
    s_waitcnt vmcnt(16)
    s_barrier
    s_add_u32 m0, s44, 81920
    s_nop 0
    buffer_load_dwordx4 v8, s[12:15], s40 offen sc1 lds
    buffer_load_dwordx4 v8, s[12:15], s40 offen offset:1024 sc1 lds
    s_add_u32 s40, s40, 131072
    s_and_b32 s40, s40, 0x3fffff
    s_add_u32 m0, s44, 90112
    s_nop 0
    buffer_load_dwordx4 v10, s[8:11], s41 offen lds
    buffer_load_dwordx4 v11, s[8:11], s41 offen offset:1024 lds
    s_add_u32 s41, s41, 65536
    s_and_b32 s41, s41, 0x1fffff
    s_add_u32 m0, s44, 98304
    s_nop 0
    buffer_load_dwordx4 v8, s[12:15], s40 offen sc1 lds
    buffer_load_dwordx4 v8, s[12:15], s40 offen offset:1024 sc1 lds
    s_add_u32 s40, s40, 131072
    s_and_b32 s40, s40, 0x3fffff
    s_add_u32 m0, s44, 106496
    s_nop 0
    buffer_load_dwordx4 v10, s[8:11], s41 offen lds
    buffer_load_dwordx4 v11, s[8:11], s41 offen offset:1024 lds
    s_add_u32 s41, s41, 65536
    s_and_b32 s41, s41, 0x1fffff
    s_waitcnt vmcnt(16)
    s_barrier
    s_add_u32 m0, s44, 114688
    s_nop 0
    buffer_load_dwordx4 v8, s[12:15], s40 offen sc1 lds
    buffer_load_dwordx4 v8, s[12:15], s40 offen offset:1024 sc1 lds
    s_add_u32 s40, s40, 131072
    s_and_b32 s40, s40, 0x3fffff
    s_add_u32 m0, s44, 122880
    s_nop 0
    buffer_load_dwordx4 v10, s[8:11], s41 offen lds
    buffer_load_dwordx4 v11, s[8:11], s41 offen offset:1024 lds
    s_add_u32 s41, s41, 65536
    s_and_b32 s41, s41, 0x1fffff
    s_add_u32 m0, s44, 0
    s_nop 0
    buffer_load_dwordx4 v8, s[12:15], s40 offen sc1 lds
    buffer_load_dwordx4 v8, s[12:15], s40 offen offset:1024 sc1 lds
    s_add_u32 s40, s40, 131072
    s_and_b32 s40, s40, 0x3fffff
    s_add_u32 m0, s44, 8192
    s_nop 0
    buffer_load_dwordx4 v10, s[8:11], s41 offen lds
    buffer_load_dwordx4 v11, s[8:11], s41 offen offset:1024 lds
    s_add_u32 s41, s41, 65536
    s_and_b32 s41, s41, 0x1fffff
    s_waitcnt vmcnt(16)
    s_barrier
    s_add_u32 m0, s44, 16384
    s_nop 0
    buffer_load_dwordx4 v8, s[12:15], s40 offen sc1 lds
    buffer_load_dwordx4 v8, s[12:15], s40 offen offset:1024 sc1 lds
    s_add_u32 s40, s40, 131072
    s_and_b32 s40, s40, 0x3fffff
    s_add_u32 m0, s44, 24576
    s_nop 0
    buffer_load_dwordx4 v10, s[8:11], s41 offen lds
    buffer_load_dwordx4 v11, s[8:11], s41 offen offset:1024 lds
    s_add_u32 s41, s41, 65536
    s_and_b32 s41, s41, 0x1fffff
    s_add_u32 m0, s44, 32768
    s_nop 0
    buffer_load_dwordx4 v8, s[12:15], s40 offen sc1 lds
    buffer_load_dwordx4 v8, s[12:15], s40 offen offset:1024 sc1 lds
    s_add_u32 s40, s40, 131072
    s_and_b32 s40, s40, 0x3fffff
    s_add_u32 m0, s44, 40960
    s_nop 0
    buffer_load_dwordx4 v10, s[8:11], s41 offen lds
    buffer_load_dwordx4 v11, s[8:11], s41 offen offset:1024 lds
    s_add_u32 s41, s41, 65536
    s_and_b32 s41, s41, 0x1fffff
    s_waitcnt vmcnt(16)
    s_barrier
    s_add_u32 m0, s44, 49152
    s_nop 0
    buffer_load_dwordx4 v8, s[12:15], s40 offen sc1 lds
    buffer_load_dwordx4 v8, s[12:15], s40 offen offset:1024 sc1 lds
    s_add_u32 s40, s40, 131072
    s_and_b32 s40, s40, 0x3fffff
    s_add_u32 m0, s44, 57344
    s_nop 0
    buffer_load_dwordx4 v10, s[8:11], s41 offen lds
    buffer_load_dwordx4 v11, s[8:11], s41 offen offset:1024 lds
    s_add_u32 s41, s41, 65536
    s_and_b32 s41, s41, 0x1fffff
    s_add_u32 m0, s44, 65536
    s_nop 0
    buffer_load_dwordx4 v8, s[12:15], s40 offen sc1 lds
    buffer_load_dwordx4 v8, s[12:15], s40 offen offset:1024 sc1 lds
    s_add_u32 s40, s40, 131072
    s_and_b32 s40, s40, 0x3fffff
    s_add_u32 m0, s44, 73728
    s_nop 0
    buffer_load_dwordx4 v10, s[8:11], s41 offen lds
    buffer_load_dwordx4 v11, s[8:11], s41 offen offset:1024 lds
    s_add_u32 s41, s41, 65536
    s_and_b32 s41, s41, 0x1fffff
    buffer_load_dword v17, v14, s[24:27], s46 offen sc1
    s_waitcnt vmcnt(17)
    s_barrier
    s_add_u32 m0, s44, 81920
    s_nop 0
    buffer_load_dwordx4 v8, s[12:15], s40 offen sc1 lds
    buffer_load_dwordx4 v8, s[12:15], s40 offen offset:1024 sc1 lds
    s_add_u32 s40, s40, 131072
    s_and_b32 s40, s40, 0x3fffff
    s_add_u32 m0, s44, 90112
    s_nop 0
    buffer_load_dwordx4 v10, s[8:11], s41 offen lds
    buffer_load_dwordx4 v11, s[8:11], s41 offen offset:1024 lds
    s_add_u32 s41, s41, 65536
    s_and_b32 s41, s41, 0x1fffff
    s_add_u32 m0, s44, 98304
    s_nop 0
    buffer_load_dwordx4 v8, s[12:15], s40 offen sc1 lds
    buffer_load_dwordx4 v8, s[12:15], s40 offen offset:1024 sc1 lds
    s_add_u32 s40, s40, 131072
    s_and_b32 s40, s40, 0x3fffff
    s_add_u32 m0, s44, 106496
    s_nop 0
    buffer_load_dwordx4 v10, s[8:11], s41 offen lds
    buffer_load_dwordx4 v11, s[8:11], s41 offen offset:1024 lds
    s_add_u32 s41, s41, 65536
    s_and_b32 s41, s41, 0x1fffff
    s_waitcnt vmcnt(17)
    s_waitcnt vmcnt(8)
    v_cmp_ne_u32 vcc, s3, v17
    s_nop 0
    s_cbranch_vccz L_uok_30
    s_mov_b32 s87, 0x40000
L_fpollu_31:
    buffer_load_dword v15, v14, s[24:27], s46 offen sc1
    s_waitcnt vmcnt(0)
    v_cmp_ne_u32 vcc, s3, v15
    s_sub_u32 s87, s87, 1
    s_cbranch_scc1 L_fpollud_32
    s_cbranch_vccz L_fpollud_32
    s_sleep 2
    s_branch L_fpollu_31
L_fpollud_32:
L_uok_30:
    s_barrier
    s_add_u32 m0, s44, 114688
    s_nop 0
    buffer_load_dwordx4 v8, s[12:15], s40 offen sc1 lds
    buffer_load_dwordx4 v8, s[12:15], s40 offen offset:1024 sc1 lds
    s_add_u32 s40, s40, 131072
    s_and_b32 s40, s40, 0x3fffff
    s_add_u32 m0, s44, 122880
    s_nop 0
    buffer_load_dwordx4 v10, s[8:11], s41 offen lds
    buffer_load_dwordx4 v11, s[8:11], s41 offen offset:1024 lds
    s_add_u32 s41, s41, 65536
    s_and_b32 s41, s41, 0x1fffff
    s_add_u32 m0, s44, 0
    s_nop 0
    buffer_load_dwordx4 v9, s[20:23], s42 offen sc1 lds
    buffer_load_dwordx4 v9, s[20:23], s42 offen offset:1024 sc1 lds
    s_add_u32 s42, s42, 65536
    s_cmp_eq_u32 s42, 0x700000
    s_cselect_b32 s42, 0, s42
    s_add_u32 m0, s44, 8192
    s_nop 0
    buffer_load_dwordx4 v12, s[16:19], s43 offen lds
    buffer_load_dwordx4 v13, s[16:19], s43 offen offset:1024 lds
    s_add_u32 s43, s43, 131072
    s_cmp_eq_u32 s43, 0xe00000
    s_cselect_b32 s43, 0, s43
    s_waitcnt vmcnt(17)
    s_barrier
    s_add_u32 m0, s44, 16384
    s_nop 0
    buffer_load_dwordx4 v9, s[20:23], s42 offen sc1 lds
    buffer_load_dwordx4 v9, s[20:23], s42 offen offset:1024 sc1 lds
    s_add_u32 s42, s42, 65536
    s_cmp_eq_u32 s42, 0x700000
    s_cselect_b32 s42, 0, s42
    s_add_u32 m0, s44, 24576
    s_nop 0
    buffer_load_dwordx4 v12, s[16:19], s43 offen lds
    buffer_load_dwordx4 v13, s[16:19], s43 offen offset:1024 lds
    s_add_u32 s43, s43, 131072
    s_cmp_eq_u32 s43, 0xe00000
    s_cselect_b32 s43, 0, s43
    s_add_u32 m0, s44, 32768
    s_nop 0
    buffer_load_dwordx4 v9, s[20:23], s42 offen sc1 lds
    buffer_load_dwordx4 v9, s[20:23], s42 offen offset:1024 sc1 lds
    s_add_u32 s42, s42, 65536
    s_cmp_eq_u32 s42, 0x700000
    s_cselect_b32 s42, 0, s42
    s_add_u32 m0, s44, 40960
    s_nop 0
    buffer_load_dwordx4 v12, s[16:19], s43 offen lds
    buffer_load_dwordx4 v13, s[16:19], s43 offen offset:1024 lds
    s_add_u32 s43, s43, 131072
    s_cmp_eq_u32 s43, 0xe00000
    s_cselect_b32 s43, 0, s43
    s_mov_b32 s30, 2
L_fp0_33:
    s_waitcnt vmcnt(16)
    s_barrier
    s_add_u32 m0, s44, 49152
    s_nop 0
    buffer_load_dwordx4 v9, s[20:23], s42 offen sc1 lds
    buffer_load_dwordx4 v9, s[20:23], s42 offen offset:1024 sc1 lds
    s_add_u32 s42, s42, 65536
    s_cmp_eq_u32 s42, 0x700000
    s_cselect_b32 s42, 0, s42
    s_add_u32 m0, s44, 57344
    s_nop 0
    buffer_load_dwordx4 v12, s[16:19], s43 offen lds
    buffer_load_dwordx4 v13, s[16:19], s43 offen offset:1024 lds
    s_add_u32 s43, s43, 131072
    s_cmp_eq_u32 s43, 0xe00000
    s_cselect_b32 s43, 0, s43
    s_add_u32 m0, s44, 65536
    s_nop 0
    buffer_load_dwordx4 v9, s[20:23], s42 offen sc1 lds
    buffer_load_dwordx4 v9, s[20:23], s42 offen offset:1024 sc1 lds
    s_add_u32 s42, s42, 65536
    s_cmp_eq_u32 s42, 0x700000
    s_cselect_b32 s42, 0, s42
    s_add_u32 m0, s44, 73728
    s_nop 0
    buffer_load_dwordx4 v12, s[16:19], s43 offen lds
    buffer_load_dwordx4 v13, s[16:19], s43 offen offset:1024 lds
    s_add_u32 s43, s43, 131072
    s_cmp_eq_u32 s43, 0xe00000
    s_cselect_b32 s43, 0, s43
    s_waitcnt vmcnt(16)
    s_barrier
    s_add_u32 m0, s44, 81920
    s_nop 0
    buffer_load_dwordx4 v9, s[20:23], s42 offen sc1 lds
    buffer_load_dwordx4 v9, s[20:23], s42 offen offset:1024 sc1 lds
    s_add_u32 s42, s42, 65536
    s_cmp_eq_u32 s42, 0x700000
    s_cselect_b32 s42, 0, s42
    s_add_u32 m0, s44, 90112
    s_nop 0
    buffer_load_dwordx4 v12, s[16:19], s43 offen lds
    buffer_load_dwordx4 v13, s[16:19], s43 offen offset:1024 lds
    s_add_u32 s43, s43, 131072
    s_cmp_eq_u32 s43, 0xe00000
    s_cselect_b32 s43, 0, s43
    s_add_u32 m0, s44, 98304
    s_nop 0
    buffer_load_dwordx4 v9, s[20:23], s42 offen sc1 lds
    buffer_load_dwordx4 v9, s[20:23], s42 offen offset:1024 sc1 lds
    s_add_u32 s42, s42, 65536
    s_cmp_eq_u32 s42, 0x700000
    s_cselect_b32 s42, 0, s42
    s_add_u32 m0, s44, 106496
    s_nop 0
    buffer_load_dwordx4 v12, s[16:19], s43 offen lds
    buffer_load_dwordx4 v13, s[16:19], s43 offen offset:1024 lds
    s_add_u32 s43, s43, 131072
    s_cmp_eq_u32 s43, 0xe00000
    s_cselect_b32 s43, 0, s43
    s_waitcnt vmcnt(16)
    s_barrier
    s_add_u32 m0, s44, 114688
    s_nop 0
    buffer_load_dwordx4 v9, s[20:23], s42 offen sc1 lds
    buffer_load_dwordx4 v9, s[20:23], s42 offen offset:1024 sc1 lds
    s_add_u32 s42, s42, 65536
    s_cmp_eq_u32 s42, 0x700000
    s_cselect_b32 s42, 0, s42
    s_add_u32 m0, s44, 122880
    s_nop 0
    buffer_load_dwordx4 v12, s[16:19], s43 offen lds
    buffer_load_dwordx4 v13, s[16:19], s43 offen offset:1024 lds
    s_add_u32 s43, s43, 131072
    s_cmp_eq_u32 s43, 0xe00000
    s_cselect_b32 s43, 0, s43
    s_add_u32 m0, s44, 0
    s_nop 0
    buffer_load_dwordx4 v9, s[20:23], s42 offen sc1 lds
    buffer_load_dwordx4 v9, s[20:23], s42 offen offset:1024 sc1 lds
    s_add_u32 s42, s42, 65536
    s_cmp_eq_u32 s42, 0x700000
    s_cselect_b32 s42, 0, s42
    s_add_u32 m0, s44, 8192
    s_nop 0
    buffer_load_dwordx4 v12, s[16:19], s43 offen lds
    buffer_load_dwordx4 v13, s[16:19], s43 offen offset:1024 lds
    s_add_u32 s43, s43, 131072
    s_cmp_eq_u32 s43, 0xe00000
    s_cselect_b32 s43, 0, s43
    s_waitcnt vmcnt(16)
    s_barrier
    s_add_u32 m0, s44, 16384
    s_nop 0
    buffer_load_dwordx4 v9, s[20:23], s42 offen sc1 lds
    buffer_load_dwordx4 v9, s[20:23], s42 offen offset:1024 sc1 lds
    s_add_u32 s42, s42, 65536
    s_cmp_eq_u32 s42, 0x700000
    s_cselect_b32 s42, 0, s42
    s_add_u32 m0, s44, 24576
    s_nop 0
    buffer_load_dwordx4 v12, s[16:19], s43 offen lds
    buffer_load_dwordx4 v13, s[16:19], s43 offen offset:1024 lds
    s_add_u32 s43, s43, 131072
    s_cmp_eq_u32 s43, 0xe00000
    s_cselect_b32 s43, 0, s43
    s_add_u32 m0, s44, 32768
    s_nop 0
    buffer_load_dwordx4 v9, s[20:23], s42 offen sc1 lds
    buffer_load_dwordx4 v9, s[20:23], s42 offen offset:1024 sc1 lds
    s_add_u32 s42, s42, 65536
    s_cmp_eq_u32 s42, 0x700000
    s_cselect_b32 s42, 0, s42
    s_add_u32 m0, s44, 40960
    s_nop 0
    buffer_load_dwordx4 v12, s[16:19], s43 offen lds
    buffer_load_dwordx4 v13, s[16:19], s43 offen offset:1024 lds
    s_add_u32 s43, s43, 131072
    s_cmp_eq_u32 s43, 0xe00000
    s_cselect_b32 s43, 0, s43
    s_sub_u32 s30, s30, 1
    s_cmp_lg_u32 s30, 0
    s_cbranch_scc1 L_fp0_33
    s_waitcnt vmcnt(16)
    s_barrier
    s_add_u32 m0, s44, 49152
    s_nop 0
    buffer_load_dwordx4 v9, s[20:23], s42 offen sc1 lds
    buffer_load_dwordx4 v9, s[20:23], s42 offen offset:1024 sc1 lds
    s_add_u32 s42, s42, 65536
    s_cmp_eq_u32 s42, 0x700000
    s_cselect_b32 s42, 0, s42
    s_add_u32 m0, s44, 57344
    s_nop 0
    buffer_load_dwordx4 v12, s[16:19], s43 offen lds
    buffer_load_dwordx4 v13, s[16:19], s43 offen offset:1024 lds
    s_add_u32 s43, s43, 131072
    s_cmp_eq_u32 s43, 0xe00000
    s_cselect_b32 s43, 0, s43
    s_add_u32 m0, s44, 65536
    s_nop 0
    buffer_load_dwordx4 v9, s[20:23], s42 offen sc1 lds
    buffer_load_dwordx4 v9, s[20:23], s42 offen offset:1024 sc1 lds
    s_add_u32 s42, s42, 65536
    s_cmp_eq_u32 s42, 0x700000
    s_cselect_b32 s42, 0, s42
    s_add_u32 m0, s44, 73728
    s_nop 0
    buffer_load_dwordx4 v12, s[16:19], s43 offen lds
    buffer_load_dwordx4 v13, s[16:19], s43 offen offset:1024 lds
    s_add_u32 s43, s43, 131072
    s_cmp_eq_u32 s43, 0xe00000
    s_cselect_b32 s43, 0, s43
    s_waitcnt vmcnt(16)
    s_barrier
    s_add_u32 m0, s44, 81920
    s_nop 0
    buffer_load_dwordx4 v9, s[20:23], s42 offen sc1 lds
    buffer_load_dwordx4 v9, s[20:23], s42 offen offset:1024 sc1 lds
    s_add_u32 s42, s42, 65536
    s_cmp_eq_u32 s42, 0x700000
    s_cselect_b32 s42, 0, s42
    s_add_u32 s42, s42, 0x220000
    s_sub_u32 s38, s42, 0x700000
    s_cmp_ge_u32 s42, 0x700000
    s_cselect_b32 s42, s38, s42
    s_add_u32 m0, s44, 90112
    s_nop 0
    buffer_load_dwordx4 v12, s[16:19], s43 offen lds
    buffer_load_dwordx4 v13, s[16:19], s43 offen offset:1024 lds
    s_add_u32 s43, s43, 131072
    s_cmp_eq_u32 s43, 0xe00000
    s_cselect_b32 s43, 0, s43
    s_add_u32 s43, s43, 0x440000
    s_sub_u32 s38, s43, 0xe00000
    s_cmp_ge_u32 s43, 0xe00000
    s_cselect_b32 s43, s38, s43
    s_add_u32 m0, s44, 98304
    s_nop 0
    buffer_load_dwordx4 v9, s[20:23], s42 offen sc1 lds
    buffer_load_dwordx4 v9, s[20:23], s42 offen offset:1024 sc1 lds
    s_add_u32 s42, s42, 65536
    s_cmp_eq_u32 s42, 0x700000
    s_cselect_b32 s42, 0, s42
    s_add_u32 m0, s44, 106496
    s_nop 0
    buffer_load_dwordx4 v12, s[16:19], s43 offen lds
    buffer_load_dwordx4 v13, s[16:19], s43 offen offset:1024 lds
    s_add_u32 s43, s43, 131072
    s_cmp_eq_u32 s43, 0xe00000
    s_cselect_b32 s43, 0, s43
    s_mov_b32 s30, 2
L_fp0_34:
    s_waitcnt vmcnt(16)
    s_barrier
    s_add_u32 m0, s44, 114688
    s_nop 0
    buffer_load_dwordx4 v9, s[20:23], s42 offen sc1 lds
    buffer_load_dwordx4 v9, s[20:23], s42 offen offset:1024 sc1 lds
    s_add_u32 s42, s42, 65536
    s_cmp_eq_u32 s42, 0x700000
    s_cselect_b32 s42, 0, s42
    s_add_u32 m0, s44, 122880
    s_nop 0
    buffer_load_dwordx4 v12, s[16:19], s43 offen lds
    buffer_load_dwordx4 v13, s[16:19], s43 offen offset:1024 lds
    s_add_u32 s43, s43, 131072
    s_cmp_eq_u32 s43, 0xe00000
    s_cselect_b32 s43, 0, s43
    s_add_u32 m0, s44, 0
    s_nop 0
    buffer_load_dwordx4 v9, s[20:23], s42 offen sc1 lds
    buffer_load_dwordx4 v9, s[20:23], s42 offen offset:1024 sc1 lds
    s_add_u32 s42, s42, 65536
    s_cmp_eq_u32 s42, 0x700000
    s_cselect_b32 s42, 0, s42
    s_add_u32 m0, s44, 8192
    s_nop 0
    buffer_load_dwordx4 v12, s[16:19], s43 offen lds
    buffer_load_dwordx4 v13, s[16:19], s43 offen offset:1024 lds
    s_add_u32 s43, s43, 131072
    s_cmp_eq_u32 s43, 0xe00000
    s_cselect_b32 s43, 0, s43
    s_waitcnt vmcnt(16)
    s_barrier
    s_add_u32 m0, s44, 16384
    s_nop 0
    buffer_load_dwordx4 v9, s[20:23], s42 offen sc1 lds
    buffer_load_dwordx4 v9, s[20:23], s42 offen offset:1024 sc1 lds
    s_add_u32 s42, s42, 65536
    s_cmp_eq_u32 s42, 0x700000
    s_cselect_b32 s42, 0, s42
    s_add_u32 m0, s44, 24576
    s_nop 0
    buffer_load_dwordx4 v12, s[16:19], s43 offen lds
    buffer_load_dwordx4 v13, s[16:19], s43 offen offset:1024 lds
    s_add_u32 s43, s43, 131072
    s_cmp_eq_u32 s43, 0xe00000
    s_cselect_b32 s43, 0, s43
    s_add_u32 m0, s44, 32768
    s_nop 0
    buffer_load_dwordx4 v9, s[20:23], s42 offen sc1 lds
    buffer_load_dwordx4 v9, s[20:23], s42 offen offset:1024 sc1 lds
    s_add_u32 s42, s42, 65536
    s_cmp_eq_u32 s42, 0x700000
    s_cselect_b32 s42, 0, s42
    s_add_u32 m0, s44, 40960
    s_nop 0
    buffer_load_dwordx4 v12, s[16:19], s43 offen lds
    buffer_load_dwordx4 v13, s[16:19], s43 offen offset:1024 lds
    s_add_u32 s43, s43, 131072
    s_cmp_eq_u32 s43, 0xe00000
    s_cselect_b32 s43, 0, s43
    s_waitcnt vmcnt(16)
    s_barrier
    s_add_u32 m0, s44, 49152
    s_nop 0
    buffer_load_dwordx4 v9, s[20:23], s42 offen sc1 lds
    buffer_load_dwordx4 v9, s[20:23], s42 offen offset:1024 sc1 lds
    s_add_u32 s42, s42, 65536
    s_cmp_eq_u32 s42, 0x700000
    s_cselect_b32 s42, 0, s42
    s_add_u32 m0, s44, 57344
    s_nop 0
    buffer_load_dwordx4 v12, s[16:19], s43 offen lds
    buffer_load_dwordx4 v13, s[16:19], s43 offen offset:1024 lds
    s_add_u32 s43, s43, 131072
    s_cmp_eq_u32 s43, 0xe00000
    s_cselect_b32 s43, 0, s43
    s_add_u32 m0, s44, 65536
    s_nop 0
    buffer_load_dwordx4 v9, s[20:23], s42 offen sc1 lds
    buffer_load_dwordx4 v9, s[20:23], s42 offen offset:1024 sc1 lds
    s_add_u32 s42, s42, 65536
    s_cmp_eq_u32 s42, 0x700000
    s_cselect_b32 s42, 0, s42
    s_add_u32 m0, s44, 73728
    s_nop 0
    buffer_load_dwordx4 v12, s[16:19], s43 offen lds
    buffer_load_dwordx4 v13, s[16:19], s43 offen offset:1024 lds
    s_add_u32 s43, s43, 131072
    s_cmp_eq_u32 s43, 0xe00000
    s_cselect_b32 s43, 0, s43
    s_waitcnt vmcnt(16)
    s_barrier
    s_add_u32 m0, s44, 81920
    s_nop 0
    buffer_load_dwordx4 v9, s[20:23], s42 offen sc1 lds
    buffer_load_dwordx4 v9, s[20:23], s42 offen offset:1024 sc1 lds
    s_add_u32 s42, s42, 65536
    s_cmp_eq_u32 s42, 0x700000
    s_cselect_b32 s42, 0, s42
    s_add_u32 m0, s44, 90112
    s_nop 0
    buffer_load_dwordx4 v12, s[16:19], s43 offen lds
    buffer_load_dwordx4 v13, s[16:19], s43 offen offset:1024 lds
    s_add_u32 s43, s43, 131072
    s_cmp_eq_u32 s43, 0xe00000
    s_cselect_b32 s43, 0, s43
    s_add_u32 m0, s44, 98304
    s_nop 0
    buffer_load_dwordx4 v9, s[20:23], s42 offen sc1 lds
    buffer_load_dwordx4 v9, s[20:23], s42 offen offset:1024 sc1 lds
    s_add_u32 s42, s42, 65536
    s_cmp_eq_u32 s42, 0x700000
    s_cselect_b32 s42, 0, s42
    s_add_u32 m0, s44, 106496
    s_nop 0
    buffer_load_dwordx4 v12, s[16:19], s43 offen lds
    buffer_load_dwordx4 v13, s[16:19], s43 offen offset:1024 lds
    s_add_u32 s43, s43, 131072
    s_cmp_eq_u32 s43, 0xe00000
    s_cselect_b32 s43, 0, s43
    s_sub_u32 s30, s30, 1
    s_cmp_lg_u32 s30, 0
    s_cbranch_scc1 L_fp0_34
    s_waitcnt vmcnt(16)
    s_barrier
    s_add_u32 m0, s44, 114688
    s_nop 0
    buffer_load_dwordx4 v9, s[20:23], s42 offen sc1 lds
    buffer_load_dwordx4 v9, s[20:23], s42 offen offset:1024 sc1 lds
    s_add_u32 s42, s42, 65536
    s_cmp_eq_u32 s42, 0x700000
    s_cselect_b32 s42, 0, s42
    s_add_u32 m0, s44, 122880
    s_nop 0
    buffer_load_dwordx4 v12, s[16:19], s43 offen lds
    buffer_load_dwordx4 v13, s[16:19], s43 offen offset:1024 lds
    s_add_u32 s43, s43, 131072
    s_cmp_eq_u32 s43, 0xe00000
    s_cselect_b32 s43, 0, s43
    s_add_u32 m0, s44, 0
    s_nop 0
    buffer_load_dwordx4 v9, s[20:23], s42 offen sc1 lds
    buffer_load_dwordx4 v9, s[20:23], s42 offen offset:1024 sc1 lds
    s_add_u32 s42, s42, 65536
    s_cmp_eq_u32 s42, 0x700000
    s_cselect_b32 s42, 0, s42
    s_add_u32 m0, s44, 8192
    s_nop 0
    buffer_load_dwordx4 v12, s[16:19], s43 offen lds
    buffer_load_dwordx4 v13, s[16:19], s43 offen offset:1024 lds
    s_add_u32 s43, s43, 131072
    s_cmp_eq_u32 s43, 0xe00000
    s_cselect_b32 s43, 0, s43
    s_waitcnt vmcnt(16)
    s_barrier
    s_add_u32 m0, s44, 16384
    s_nop 0
    buffer_load_dwordx4 v9, s[20:23], s42 offen sc1 lds
    buffer_load_dwordx4 v9, s[20:23], s42 offen offset:1024 sc1 lds
    s_add_u32 s42, s42, 65536
    s_cmp_eq_u32 s42, 0x700000
    s_cselect_b32 s42, 0, s42
    s_add_u32 m0, s44, 24576
    s_nop 0
    buffer_load_dwordx4 v12, s[16:19], s43 offen lds
    buffer_load_dwordx4 v13, s[16:19], s43 offen offset:1024 lds
    s_add_u32 s43, s43, 131072
    s_cmp_eq_u32 s43, 0xe00000
    s_cselect_b32 s43, 0, s43
    s_add_u32 m0, s44, 32768
    s_nop 0
    buffer_load_dwordx4 v9, s[20:23], s42 offen sc1 lds
    buffer_load_dwordx4 v9, s[20:23], s42 offen offset:1024 sc1 lds
    s_add_u32 s42, s42, 65536
    s_cmp_eq_u32 s42, 0x700000
    s_cselect_b32 s42, 0, s42
    s_add_u32 m0, s44, 40960
    s_nop 0
    buffer_load_dwordx4 v12, s[16:19], s43 offen lds
    buffer_load_dwordx4 v13, s[16:19], s43 offen offset:1024 lds
    s_add_u32 s43, s43, 131072
    s_cmp_eq_u32 s43, 0xe00000
    s_cselect_b32 s43, 0, s43
    s_waitcnt vmcnt(16)
    s_barrier
    s_add_u32 m0, s44, 49152
    s_nop 0
    buffer_load_dwordx4 v9, s[20:23], s42 offen sc1 lds
    buffer_load_dwordx4 v9, s[20:23], s42 offen offset:1024 sc1 lds
    s_add_u32 s42, s42, 65536
    s_cmp_eq_u32 s42, 0x700000
    s_cselect_b32 s42, 0, s42
    s_add_u32 m0, s44, 57344
    s_nop 0
    buffer_load_dwordx4 v12, s[16:19], s43 offen lds
    buffer_load_dwordx4 v13, s[16:19], s43 offen offset:1024 lds
    s_add_u32 s43, s43, 131072
    s_cmp_eq_u32 s43, 0xe00000
    s_cselect_b32 s43, 0, s43
    s_waitcnt vmcnt(12)
    s_barrier
    s_waitcnt vmcnt(4)
    s_barrier
    s_waitcnt vmcnt(0)
    s_barrier
    s_endpgm
L_a_fcons:
    s_cmp_lg_u32 s31, 0
    s_cbranch_scc1 L_a_noflag
    v_mov_b32 v5, s3
    s_mov_b64 exec, 1
    buffer_store_dword v5, v6, s[24:27], s54 offen sc1
    s_mov_b64 exec, -1
L_a_noflag:
    s_and_b32 s46, s31, 1
    s_lshr_b32 s47, s31, 1
    s_add_u32 s60, s34, 0x1600000
    s_addc_u32 s61, s35, 0
    s_and_b32 s61, s61, 0xffff
    s_mov_b32 s62, 0x1000000
    s_mov_b32 s63, 0x00020000
    v_lshlrev_b32 v5, 11, v3
    v_lshl_add_u32 v5, v4, 4, v5
    s_lshl_b32 s38, s47, 10
    v_add_u32 v6, s38, v5
    v_add_u32 v72, 0, v6
    v_add_u32 v73, 65536, v6
    s_lshl_b32 s38, s46, 10
    v_add_u32 v6, s38, v5
    v_add_u32 v74, 0, v6
    v_add_u32 v75, 65536, v6
    v_lshrrev_b32 v5, 2, v4
    v_lshl_add_u32 v6, v3, 3, v5
    v_and_b32 v7, 1, v3
    v_lshl_add_u32 v5, v7, 2, v5
    v_and_b32 v7, 3, v4
    v_lshlrev_b32 v7, 3, v7
    v_lshl_add_u32 v6, v6, 8, v7
    v_add_u32 v6, 8192, v6
    s_lshl_b32 s38, s46, 2
    s_add_u32 s38, s38, 0
    v_xor_b32 v7, s38, v5
    v_lshl_add_u32 v7, v7, 5, v6
    v_add_u32 v76, 0, v7
    v_add_u32 v80, 65536, v7
    s_lshl_b32 s38, s46, 2
    s_add_u32 s38, s38, 1
    v_xor_b32 v7, s38, v5
    v_lshl_add_u32 v7, v7, 5, v6
    v_add_u32 v77, 0, v7
    v_add_u32 v81, 65536, v7
    s_lshl_b32 s38, s46, 2
    s_add_u32 s38, s38, 2
    v_xor_b32 v7, s38, v5
    v_lshl_add_u32 v7, v7, 5, v6
    v_add_u32 v78, 0, v7
    v_add_u32 v82, 65536, v7
    s_lshl_b32 s38, s46, 2
    s_add_u32 s38, s38, 3
    v_xor_b32 v7, s38, v5
    v_lshl_add_u32 v7, v7, 5, v6
    v_add_u32 v79, 0, v7
    v_add_u32 v83, 65536, v7
    s_lshl_b32 s38, s47, 2
    s_add_u32 s38, s38, 0
    v_xor_b32 v7, s38, v5
    v_lshl_add_u32 v7, v7, 5, v6
    v_add_u32 v84, 0, v7
    v_add_u32 v88, 65536, v7
    s_lshl_b32 s38, s47, 2
    s_add_u32 s38, s38, 1
    v_xor_b32 v7, s38, v5
    v_lshl_add_u32 v7, v7, 5, v6
    v_add_u32 v85, 0, v7
    v_add_u32 v89, 65536, v7
    s_lshl_b32 s38, s47, 2
    s_add_u32 s38, s38, 2
    v_xor_b32 v7, s38, v5
    v_lshl_add_u32 v7, v7, 5, v6
    v_add_u32 v86, 0, v7
    v_add_u32 v90, 65536, v7
    s_lshl_b32 s38, s47, 2
    s_add_u32 s38, s38, 3
    v_xor_b32 v7, s38, v5
    v_lshl_add_u32 v7, v7, 5, v6
    v_add_u32 v87, 0, v7
    v_add_u32 v91, 65536, v7
    v_mov_b32 v128, 0
    v_mov_b32 v129, 0
    v_mov_b32 v130, 0
    v_mov_b32 v131, 0
    v_mov_b32 v132, 0
    v_mov_b32 v133, 0
    v_mov_b32 v134, 0
    v_mov_b32 v135, 0
    v_mov_b32 v136, 0
    v_mov_b32 v137, 0
    v_mov_b32 v138, 0
    v_mov_b32 v139, 0
    v_mov_b32 v140, 0
    v_mov_b32 v141, 0
    v_mov_b32 v142, 0
    v_mov_b32 v143, 0
    v_mov_b32 v144, 0
    v_mov_b32 v145, 0
    v_mov_b32 v146, 0
    v_mov_b32 v147, 0
    v_mov_b32 v148, 0
    v_mov_b32 v149, 0
    v_mov_b32 v150, 0
    v_mov_b32 v151, 0
    v_mov_b32 v152, 0
    v_mov_b32 v153, 0
    v_mov_b32 v154, 0
    v_mov_b32 v155, 0
    v_mov_b32 v156, 0
    v_mov_b32 v157, 0
    v_mov_b32 v158, 0
    v_mov_b32 v159, 0
    v_mov_b32 v160, 0
    v_mov_b32 v161, 0
    v_mov_b32 v162, 0
    v_mov_b32 v163, 0
    v_mov_b32 v164, 0
    v_mov_b32 v165, 0
    v_mov_b32 v166, 0
    v_mov_b32 v167, 0
    v_mov_b32 v168, 0
    v_mov_b32 v169, 0
    v_mov_b32 v170, 0
    v_mov_b32 v171, 0
    v_mov_b32 v172, 0
    v_mov_b32 v173, 0
    v_mov_b32 v174, 0
    v_mov_b32 v175, 0
    v_mov_b32 v176, 0
    v_mov_b32 v177, 0
    v_mov_b32 v178, 0
    v_mov_b32 v179, 0
    v_mov_b32 v180, 0
    v_mov_b32 v181, 0
    v_mov_b32 v182, 0
    v_mov_b32 v183, 0
    v_mov_b32 v184, 0
    v_mov_b32 v185, 0
    v_mov_b32 v186, 0
    v_mov_b32 v187, 0
    v_mov_b32 v188, 0
    v_mov_b32 v189, 0
    v_mov_b32 v190, 0
    v_mov_b32 v191, 0
    v_mov_b32 v192, 0
    v_mov_b32 v193, 0
    v_mov_b32 v194, 0
    v_mov_b32 v195, 0
    v_mov_b32 v196, 0
    v_mov_b32 v197, 0
    v_mov_b32 v198, 0
    v_mov_b32 v199, 0
    v_mov_b32 v200, 0
    v_mov_b32 v201, 0
    v_mov_b32 v202, 0
    v_mov_b32 v203, 0
    v_mov_b32 v204, 0
    v_mov_b32 v205, 0
    v_mov_b32 v206, 0
    v_mov_b32 v207, 0
    v_mov_b32 v208, 0
    v_mov_b32 v209, 0
    v_mov_b32 v210, 0
    v_mov_b32 v211, 0
    v_mov_b32 v212, 0
    v_mov_b32 v213, 0
    v_mov_b32 v214, 0
    v_mov_b32 v215, 0
    v_mov_b32 v216, 0
    v_mov_b32 v217, 0
    v_mov_b32 v218, 0
    v_mov_b32 v219, 0
    v_mov_b32 v220, 0
    v_mov_b32 v221, 0
    v_mov_b32 v222, 0
    v_mov_b32 v223, 0
    v_mov_b32 v224, 0
    v_mov_b32 v225, 0
    v_mov_b32 v226, 0
    v_mov_b32 v227, 0
    v_mov_b32 v228, 0
    v_mov_b32 v229, 0
    v_mov_b32 v230, 0
    v_mov_b32 v231, 0
    v_mov_b32 v232, 0
    v_mov_b32 v233, 0
    v_mov_b32 v234, 0
    v_mov_b32 v235, 0
    v_mov_b32 v236, 0
    v_mov_b32 v237, 0
    v_mov_b32 v238, 0
    v_mov_b32 v239, 0
    v_mov_b32 v240, 0
    v_mov_b32 v241, 0
    v_mov_b32 v242, 0
    v_mov_b32 v243, 0
    v_mov_b32 v244, 0
    v_mov_b32 v245, 0
    v_mov_b32 v246, 0
    v_mov_b32 v247, 0
    v_mov_b32 v248, 0
    v_mov_b32 v249, 0
    v_mov_b32 v250, 0
    v_mov_b32 v251, 0
    v_mov_b32 v252, 0
    v_mov_b32 v253, 0
    v_mov_b32 v254, 0
    v_mov_b32 v255, 0
    s_lshl_b32 s50, s49, 9
    s_lshl_b32 s38, s46, 7
    s_add_u32 s50, s50, s38
    s_add_u32 s50, s50, 0x110000
    s_lshl_b32 s51, s49, 16
    s_lshl_b32 s38, s31, 13
    s_add_u32 s51, s51, s38
    s_mov_b32 s52, s84
    s_and_b32 s53, s85, 0xffff
    s_mov_b32 s54, 0x1000
    s_mov_b32 s55, 0x00020000
    s_mov_b32 s56, s100
    s_and_b32 s57, s101, 0xffff
    s_mov_b32 s58, 0x400000
    s_mov_b32 s59, 0x00020000
    s_mov_b32 s66, 0xffff0000
    s_lshl_b32 s38, s32, 7
    s_lshl_b32 s39, s47, 6
    s_add_u32 s38, s38, s39
    v_add_u32 v1, s38, v4
    v_lshlrev_b32 v5, 3, v1
    v_lshlrev_b32 v6, 1, v1
    v_lshlrev_b32 v1, 11, v1
    v_and_b32 v7, 1, v3
    v_lshl_add_u32 v1, v7, 5, v1
    v_lshrrev_b32 v7, 1, v3
    v_lshl_add_u32 v1, v7, 4, v1
    s_lshl_b32 s38, s33, 8
    s_lshl_b32 s39, s46, 7
    s_add_u32 s67, s38, s39
    s_setprio 1
    s_barrier
    s_barrier
    .p2align 6
    ds_read_b128 v[8:11], v72 offset:0
    ds_read_b64_tr_b16 v[24:25], v76 offset:0
    ds_read_b64_tr_b16 v[26:27], v76 offset:1024
    ds_read_b128 v[12:15], v72 offset:256
    ds_read_b64_tr_b16 v[28:29], v77 offset:0
    ds_read_b64_tr_b16 v[30:31], v77 offset:1024
    ds_read_b128 v[16:19], v72 offset:512
    ds_read_b64_tr_b16 v[32:33], v78 offset:0
    ds_read_b64_tr_b16 v[34:35], v78 offset:1024
    ds_read_b128 v[20:23], v72 offset:768
    ds_read_b64_tr_b16 v[36:37], v79 offset:0
    ds_read_b64_tr_b16 v[38:39], v79 offset:1024
    s_mov_b32 s30, 3
    s_nop 0
L_fc0_35:
    s_waitcnt lgkmcnt(0)
    s_barrier
    v_mfma_f32_16x16x32_bf16 v[128:131], v[24:27], v[8:11], v[128:131]
    ds_read_b128 v[40:43], v72 offset:16384
    v_mfma_f32_16x16x32_bf16 v[132:135], v[24:27], v[12:15], v[132:135]
    ds_read_b64_tr_b16 v[56:57], v76 offset:16384
    v_mfma_f32_16x16x32_bf16 v[136:139], v[24:27], v[16:19], v[136:139]
    ds_read_b64_tr_b16 v[58:59], v76 offset:17408
    v_mfma_f32_16x16x32_bf16 v[140:143], v[24:27], v[20:23], v[140:143]
    ds_read_b128 v[44:47], v72 offset:16640
    v_mfma_f32_16x16x32_bf16 v[156:159], v[28:31], v[20:23], v[156:159]
    ds_read_b64_tr_b16 v[60:61], v77 offset:16384
    v_mfma_f32_16x16x32_bf16 v[152:155], v[28:31], v[16:19], v[152:155]
    ds_read_b64_tr_b16 v[62:63], v77 offset:17408
    v_mfma_f32_16x16x32_bf16 v[148:151], v[28:31], v[12:15], v[148:151]
    ds_read_b128 v[48:51], v72 offset:16896
    v_mfma_f32_16x16x32_bf16 v[144:147], v[28:31], v[8:11], v[144:147]
    ds_read_b64_tr_b16 v[64:65], v78 offset:16384
    v_mfma_f32_16x16x32_bf16 v[160:163], v[32:35], v[8:11], v[160:163]
    ds_read_b64_tr_b16 v[66:67], v78 offset:17408
    v_mfma_f32_16x16x32_bf16 v[164:167], v[32:35], v[12:15], v[164:167]
    ds_read_b128 v[52:55], v72 offset:17152
    v_mfma_f32_16x16x32_bf16 v[168:171], v[32:35], v[16:19], v[168:171]
    ds_read_b64_tr_b16 v[68:69], v79 offset:16384
    v_mfma_f32_16x16x32_bf16 v[172:175], v[32:35], v[20:23], v[172:175]
    ds_read_b64_tr_b16 v[70:71], v79 offset:17408
    v_mfma_f32_16x16x32_bf16 v[188:191], v[36:39], v[20:23], v[188:191]
    v_mfma_f32_16x16x32_bf16 v[184:187], v[36:39], v[16:19], v[184:187]
    v_mfma_f32_16x16x32_bf16 v[180:183], v[36:39], v[12:15], v[180:183]
    v_mfma_f32_16x16x32_bf16 v[176:179], v[36:39], v[8:11], v[176:179]
    s_waitcnt lgkmcnt(0)
    s_nop 0
    v_mfma_f32_16x16x32_bf16 v[128:131], v[56:59], v[40:43], v[128:131]
    ds_read_b128 v[8:11], v72 offset:32768
    v_mfma_f32_16x16x32_bf16 v[132:135], v[56:59], v[44:47], v[132:135]
    ds_read_b64_tr_b16 v[24:25], v76 offset:32768
    v_mfma_f32_16x16x32_bf16 v[136:139], v[56:59], v[48:51], v[136:139]
    ds_read_b64_tr_b16 v[26:27], v76 offset:33792
    v_mfma_f32_16x16x32_bf16 v[140:143], v[56:59], v[52:55], v[140:143]
    ds_read_b128 v[12:15], v72 offset:33024
    v_mfma_f32_16x16x32_bf16 v[156:159], v[60:63], v[52:55], v[156:159]
    ds_read_b64_tr_b16 v[28:29], v77 offset:32768
    v_mfma_f32_16x16x32_bf16 v[152:155], v[60:63], v[48:51], v[152:155]
    ds_read_b64_tr_b16 v[30:31], v77 offset:33792
    v_mfma_f32_16x16x32_bf16 v[148:151], v[60:63], v[44:47], v[148:151]
    ds_read_b128 v[16:19], v72 offset:33280
    v_mfma_f32_16x16x32_bf16 v[144:147], v[60:63], v[40:43], v[144:147]
    ds_read_b64_tr_b16 v[32:33], v78 offset:32768
    v_mfma_f32_16x16x32_bf16 v[160:163], v[64:67], v[40:43], v[160:163]
    ds_read_b64_tr_b16 v[34:35], v78 offset:33792
    v_mfma_f32_16x16x32_bf16 v[164:167], v[64:67], v[44:47], v[164:167]
    ds_read_b128 v[20:23], v72 offset:33536
    v_mfma_f32_16x16x32_bf16 v[168:171], v[64:67], v[48:51], v[168:171]
    ds_read_b64_tr_b16 v[36:37], v79 offset:32768
    v_mfma_f32_16x16x32_bf16 v[172:175], v[64:67], v[52:55], v[172:175]
    ds_read_b64_tr_b16 v[38:39], v79 offset:33792
    v_mfma_f32_16x16x32_bf16 v[188:191], v[68:71], v[52:55], v[188:191]
    v_mfma_f32_16x16x32_bf16 v[184:187], v[68:71], v[48:51], v[184:187]
    v_mfma_f32_16x16x32_bf16 v[180:183], v[68:71], v[44:47], v[180:183]
    v_mfma_f32_16x16x32_bf16 v[176:179], v[68:71], v[40:43], v[176:179]
    s_waitcnt lgkmcnt(0)
    s_barrier
    v_mfma_f32_16x16x32_bf16 v[128:131], v[24:27], v[8:11], v[128:131]
    ds_read_b128 v[40:43], v72 offset:49152
    v_mfma_f32_16x16x32_bf16 v[132:135], v[24:27], v[12:15], v[132:135]
    ds_read_b64_tr_b16 v[56:57], v76 offset:49152
    v_mfma_f32_16x16x32_bf16 v[136:139], v[24:27], v[16:19], v[136:139]
    ds_read_b64_tr_b16 v[58:59], v76 offset:50176
    v_mfma_f32_16x16x32_bf16 v[140:143], v[24:27], v[20:23], v[140:143]
    ds_read_b128 v[44:47], v72 offset:49408
    v_mfma_f32_16x16x32_bf16 v[156:159], v[28:31], v[20:23], v[156:159]
    ds_read_b64_tr_b16 v[60:61], v77 offset:49152
    v_mfma_f32_16x16x32_bf16 v[152:155], v[28:31], v[16:19], v[152:155]
    ds_read_b64_tr_b16 v[62:63], v77 offset:50176
    v_mfma_f32_16x16x32_bf16 v[148:151], v[28:31], v[12:15], v[148:151]
    ds_read_b128 v[48:51], v72 offset:49664
    v_mfma_f32_16x16x32_bf16 v[144:147], v[28:31], v[8:11], v[144:147]
    ds_read_b64_tr_b16 v[64:65], v78 offset:49152
    v_mfma_f32_16x16x32_bf16 v[160:163], v[32:35], v[8:11], v[160:163]
    ds_read_b64_tr_b16 v[66:67], v78 offset:50176
    v_mfma_f32_16x16x32_bf16 v[164:167], v[32:35], v[12:15], v[164:167]
    ds_read_b128 v[52:55], v72 offset:49920
    v_mfma_f32_16x16x32_bf16 v[168:171], v[32:35], v[16:19], v[168:171]
    ds_read_b64_tr_b16 v[68:69], v79 offset:49152
    v_mfma_f32_16x16x32_bf16 v[172:175], v[32:35], v[20:23], v[172:175]
    ds_read_b64_tr_b16 v[70:71], v79 offset:50176
    v_mfma_f32_16x16x32_bf16 v[188:191], v[36:39], v[20:23], v[188:191]
    v_mfma_f32_16x16x32_bf16 v[184:187], v[36:39], v[16:19], v[184:187]
    v_mfma_f32_16x16x32_bf16 v[180:183], v[36:39], v[12:15], v[180:183]
    v_mfma_f32_16x16x32_bf16 v[176:179], v[36:39], v[8:11], v[176:179]
    s_waitcnt lgkmcnt(0)
    s_nop 0
    v_mfma_f32_16x16x32_bf16 v[128:131], v[56:59], v[40:43], v[128:131]
    ds_read_b128 v[8:11], v73 offset:0
    v_mfma_f32_16x16x32_bf16 v[132:135], v[56:59], v[44:47], v[132:135]
    ds_read_b64_tr_b16 v[24:25], v80 offset:0
    v_mfma_f32_16x16x32_bf16 v[136:139], v[56:59], v[48:51], v[136:139]
    ds_read_b64_tr_b16 v[26:27], v80 offset:1024
    v_mfma_f32_16x16x32_bf16 v[140:143], v[56:59], v[52:55], v[140:143]
    ds_read_b128 v[12:15], v73 offset:256
    v_mfma_f32_16x16x32_bf16 v[156:159], v[60:63], v[52:55], v[156:159]
    ds_read_b64_tr_b16 v[28:29], v81 offset:0
    v_mfma_f32_16x16x32_bf16 v[152:155], v[60:63], v[48:51], v[152:155]
    ds_read_b64_tr_b16 v[30:31], v81 offset:1024
    v_mfma_f32_16x16x32_bf16 v[148:151], v[60:63], v[44:47], v[148:151]
    ds_read_b128 v[16:19], v73 offset:512
    v_mfma_f32_16x16x32_bf16 v[144:147], v[60:63], v[40:43], v[144:147]
    ds_read_b64_tr_b16 v[32:33], v82 offset:0
    v_mfma_f32_16x16x32_bf16 v[160:163], v[64:67], v[40:43], v[160:163]
    ds_read_b64_tr_b16 v[34:35], v82 offset:1024
    v_mfma_f32_16x16x32_bf16 v[164:167], v[64:67], v[44:47], v[164:167]
    ds_read_b128 v[20:23], v73 offset:768
    v_mfma_f32_16x16x32_bf16 v[168:171], v[64:67], v[48:51], v[168:171]
    ds_read_b64_tr_b16 v[36:37], v83 offset:0
    v_mfma_f32_16x16x32_bf16 v[172:175], v[64:67], v[52:55], v[172:175]
    ds_read_b64_tr_b16 v[38:39], v83 offset:1024
    v_mfma_f32_16x16x32_bf16 v[188:191], v[68:71], v[52:55], v[188:191]
    v_mfma_f32_16x16x32_bf16 v[184:187], v[68:71], v[48:51], v[184:187]
    v_mfma_f32_16x16x32_bf16 v[180:183], v[68:71], v[44:47], v[180:183]
    v_mfma_f32_16x16x32_bf16 v[176:179], v[68:71], v[40:43], v[176:179]
    s_waitcnt lgkmcnt(0)
    s_barrier
    v_mfma_f32_16x16x32_bf16 v[128:131], v[24:27], v[8:11], v[128:131]
    ds_read_b128 v[40:43], v73 offset:16384
    v_mfma_f32_16x16x32_bf16 v[132:135], v[24:27], v[12:15], v[132:135]
    ds_read_b64_tr_b16 v[56:57], v80 offset:16384
    v_mfma_f32_16x16x32_bf16 v[136:139], v[24:27], v[16:19], v[136:139]
    ds_read_b64_tr_b16 v[58:59], v80 offset:17408
    v_mfma_f32_16x16x32_bf16 v[140:143], v[24:27], v[20:23], v[140:143]
    ds_read_b128 v[44:47], v73 offset:16640
    v_mfma_f32_16x16x32_bf16 v[156:159], v[28:31], v[20:23], v[156:159]
    ds_read_b64_tr_b16 v[60:61], v81 offset:16384
    v_mfma_f32_16x16x32_bf16 v[152:155], v[28:31], v[16:19], v[152:155]
    ds_read_b64_tr_b16 v[62:63], v81 offset:17408
    v_mfma_f32_16x16x32_bf16 v[148:151], v[28:31], v[12:15], v[148:151]
    ds_read_b128 v[48:51], v73 offset:16896
    v_mfma_f32_16x16x32_bf16 v[144:147], v[28:31], v[8:11], v[144:147]
    ds_read_b64_tr_b16 v[64:65], v82 offset:16384
    v_mfma_f32_16x16x32_bf16 v[160:163], v[32:35], v[8:11], v[160:163]
    ds_read_b64_tr_b16 v[66:67], v82 offset:17408
    v_mfma_f32_16x16x32_bf16 v[164:167], v[32:35], v[12:15], v[164:167]
    ds_read_b128 v[52:55], v73 offset:17152
    v_mfma_f32_16x16x32_bf16 v[168:171], v[32:35], v[16:19], v[168:171]
    ds_read_b64_tr_b16 v[68:69], v83 offset:16384
    v_mfma_f32_16x16x32_bf16 v[172:175], v[32:35], v[20:23], v[172:175]
    ds_read_b64_tr_b16 v[70:71], v83 offset:17408
    v_mfma_f32_16x16x32_bf16 v[188:191], v[36:39], v[20:23], v[188:191]
    v_mfma_f32_16x16x32_bf16 v[184:187], v[36:39], v[16:19], v[184:187]
    v_mfma_f32_16x16x32_bf16 v[180:183], v[36:39], v[12:15], v[180:183]
    v_mfma_f32_16x16x32_bf16 v[176:179], v[36:39], v[8:11], v[176:179]
    s_waitcnt lgkmcnt(0)
    s_nop 0
    v_mfma_f32_16x16x32_bf16 v[128:131], v[56:59], v[40:43], v[128:131]
    ds_read_b128 v[8:11], v73 offset:32768
    v_mfma_f32_16x16x32_bf16 v[132:135], v[56:59], v[44:47], v[132:135]
    ds_read_b64_tr_b16 v[24:25], v80 offset:32768
    v_mfma_f32_16x16x32_bf16 v[136:139], v[56:59], v[48:51], v[136:139]
    ds_read_b64_tr_b16 v[26:27], v80 offset:33792
    v_mfma_f32_16x16x32_bf16 v[140:143], v[56:59], v[52:55], v[140:143]
    ds_read_b128 v[12:15], v73 offset:33024
    v_mfma_f32_16x16x32_bf16 v[156:159], v[60:63], v[52:55], v[156:159]
    ds_read_b64_tr_b16 v[28:29], v81 offset:32768
    v_mfma_f32_16x16x32_bf16 v[152:155], v[60:63], v[48:51], v[152:155]
    ds_read_b64_tr_b16 v[30:31], v81 offset:33792
    v_mfma_f32_16x16x32_bf16 v[148:151], v[60:63], v[44:47], v[148:151]
    ds_read_b128 v[16:19], v73 offset:33280
    v_mfma_f32_16x16x32_bf16 v[144:147], v[60:63], v[40:43], v[144:147]
    ds_read_b64_tr_b16 v[32:33], v82 offset:32768
    v_mfma_f32_16x16x32_bf16 v[160:163], v[64:67], v[40:43], v[160:163]
    ds_read_b64_tr_b16 v[34:35], v82 offset:33792
    v_mfma_f32_16x16x32_bf16 v[164:167], v[64:67], v[44:47], v[164:167]
    ds_read_b128 v[20:23], v73 offset:33536
    v_mfma_f32_16x16x32_bf16 v[168:171], v[64:67], v[48:51], v[168:171]
    ds_read_b64_tr_b16 v[36:37], v83 offset:32768
    v_mfma_f32_16x16x32_bf16 v[172:175], v[64:67], v[52:55], v[172:175]
    ds_read_b64_tr_b16 v[38:39], v83 offset:33792
    v_mfma_f32_16x16x32_bf16 v[188:191], v[68:71], v[52:55], v[188:191]
    v_mfma_f32_16x16x32_bf16 v[184:187], v[68:71], v[48:51], v[184:187]
    v_mfma_f32_16x16x32_bf16 v[180:183], v[68:71], v[44:47], v[180:183]
    v_mfma_f32_16x16x32_bf16 v[176:179], v[68:71], v[40:43], v[176:179]
    s_waitcnt lgkmcnt(0)
    s_barrier
    v_mfma_f32_16x16x32_bf16 v[128:131], v[24:27], v[8:11], v[128:131]
    ds_read_b128 v[40:43], v73 offset:49152
    v_mfma_f32_16x16x32_bf16 v[132:135], v[24:27], v[12:15], v[132:135]
    ds_read_b64_tr_b16 v[56:57], v80 offset:49152
    v_mfma_f32_16x16x32_bf16 v[136:139], v[24:27], v[16:19], v[136:139]
    ds_read_b64_tr_b16 v[58:59], v80 offset:50176
    v_mfma_f32_16x16x32_bf16 v[140:143], v[24:27], v[20:23], v[140:143]
    ds_read_b128 v[44:47], v73 offset:49408
    v_mfma_f32_16x16x32_bf16 v[156:159], v[28:31], v[20:23], v[156:159]
    ds_read_b64_tr_b16 v[60:61], v81 offset:49152
    v_mfma_f32_16x16x32_bf16 v[152:155], v[28:31], v[16:19], v[152:155]
    ds_read_b64_tr_b16 v[62:63], v81 offset:50176
    v_mfma_f32_16x16x32_bf16 v[148:151], v[28:31], v[12:15], v[148:151]
    ds_read_b128 v[48:51], v73 offset:49664
    v_mfma_f32_16x16x32_bf16 v[144:147], v[28:31], v[8:11], v[144:147]
    ds_read_b64_tr_b16 v[64:65], v82 offset:49152
    v_mfma_f32_16x16x32_bf16 v[160:163], v[32:35], v[8:11], v[160:163]
    ds_read_b64_tr_b16 v[66:67], v82 offset:50176
    v_mfma_f32_16x16x32_bf16 v[164:167], v[32:35], v[12:15], v[164:167]
    ds_read_b128 v[52:55], v73 offset:49920
    v_mfma_f32_16x16x32_bf16 v[168:171], v[32:35], v[16:19], v[168:171]
    ds_read_b64_tr_b16 v[68:69], v83 offset:49152
    v_mfma_f32_16x16x32_bf16 v[172:175], v[32:35], v[20:23], v[172:175]
    ds_read_b64_tr_b16 v[70:71], v83 offset:50176
    v_mfma_f32_16x16x32_bf16 v[188:191], v[36:39], v[20:23], v[188:191]
    v_mfma_f32_16x16x32_bf16 v[184:187], v[36:39], v[16:19], v[184:187]
    v_mfma_f32_16x16x32_bf16 v[180:183], v[36:39], v[12:15], v[180:183]
    v_mfma_f32_16x16x32_bf16 v[176:179], v[36:39], v[8:11], v[176:179]
    s_waitcnt lgkmcnt(0)
    s_nop 0
    v_mfma_f32_16x16x32_bf16 v[128:131], v[56:59], v[40:43], v[128:131]
    ds_read_b128 v[8:11], v72 offset:0
    v_mfma_f32_16x16x32_bf16 v[132:135], v[56:59], v[44:47], v[132:135]
    ds_read_b64_tr_b16 v[24:25], v76 offset:0
    v_mfma_f32_16x16x32_bf16 v[136:139], v[56:59], v[48:51], v[136:139]
    ds_read_b64_tr_b16 v[26:27], v76 offset:1024
    v_mfma_f32_16x16x32_bf16 v[140:143], v[56:59], v[52:55], v[140:143]
    ds_read_b128 v[12:15], v72 offset:256
    v_mfma_f32_16x16x32_bf16 v[156:159], v[60:63], v[52:55], v[156:159]
    ds_read_b64_tr_b16 v[28:29], v77 offset:0
    v_mfma_f32_16x16x32_bf16 v[152:155], v[60:63], v[48:51], v[152:155]
    ds_read_b64_tr_b16 v[30:31], v77 offset:1024
    v_mfma_f32_16x16x32_bf16 v[148:151], v[60:63], v[44:47], v[148:151]
    ds_read_b128 v[16:19], v72 offset:512
    v_mfma_f32_16x16x32_bf16 v[144:147], v[60:63], v[40:43], v[144:147]
    ds_read_b64_tr_b16 v[32:33], v78 offset:0
    v_mfma_f32_16x16x32_bf16 v[160:163], v[64:67], v[40:43], v[160:163]
    ds_read_b64_tr_b16 v[34:35], v78 offset:1024
    v_mfma_f32_16x16x32_bf16 v[164:167], v[64:67], v[44:47], v[164:167]
    ds_read_b128 v[20:23], v72 offset:768
    v_mfma_f32_16x16x32_bf16 v[168:171], v[64:67], v[48:51], v[168:171]
    ds_read_b64_tr_b16 v[36:37], v79 offset:0
    v_mfma_f32_16x16x32_bf16 v[172:175], v[64:67], v[52:55], v[172:175]
    ds_read_b64_tr_b16 v[38:39], v79 offset:1024
    v_mfma_f32_16x16x32_bf16 v[188:191], v[68:71], v[52:55], v[188:191]
    v_mfma_f32_16x16x32_bf16 v[184:187], v[68:71], v[48:51], v[184:187]
    v_mfma_f32_16x16x32_bf16 v[180:183], v[68:71], v[44:47], v[180:183]
    v_mfma_f32_16x16x32_bf16 v[176:179], v[68:71], v[40:43], v[176:179]
    s_sub_u32 s30, s30, 1
    s_cmp_lg_u32 s30, 0
    s_nop 0
    s_cbranch_scc1 L_fc0_35
    s_waitcnt lgkmcnt(0)
    s_barrier
    v_mfma_f32_16x16x32_bf16 v[128:131], v[24:27], v[8:11], v[128:131]
    ds_read_b128 v[40:43], v72 offset:16384
    v_mfma_f32_16x16x32_bf16 v[132:135], v[24:27], v[12:15], v[132:135]
    ds_read_b64_tr_b16 v[56:57], v76 offset:16384
    v_mfma_f32_16x16x32_bf16 v[136:139], v[24:27], v[16:19], v[136:139]
    ds_read_b64_tr_b16 v[58:59], v76 offset:17408
    v_mfma_f32_16x16x32_bf16 v[140:143], v[24:27], v[20:23], v[140:143]
    ds_read_b128 v[44:47], v72 offset:16640
    v_mfma_f32_16x16x32_bf16 v[156:159], v[28:31], v[20:23], v[156:159]
    ds_read_b64_tr_b16 v[60:61], v77 offset:16384
    v_mfma_f32_16x16x32_bf16 v[152:155], v[28:31], v[16:19], v[152:155]
    ds_read_b64_tr_b16 v[62:63], v77 offset:17408
    v_mfma_f32_16x16x32_bf16 v[148:151], v[28:31], v[12:15], v[148:151]
    ds_read_b128 v[48:51], v72 offset:16896
    v_mfma_f32_16x16x32_bf16 v[144:147], v[28:31], v[8:11], v[144:147]
    ds_read_b64_tr_b16 v[64:65], v78 offset:16384
    v_mfma_f32_16x16x32_bf16 v[160:163], v[32:35], v[8:11], v[160:163]
    ds_read_b64_tr_b16 v[66:67], v78 offset:17408
    v_mfma_f32_16x16x32_bf16 v[164:167], v[32:35], v[12:15], v[164:167]
    ds_read_b128 v[52:55], v72 offset:17152
    v_mfma_f32_16x16x32_bf16 v[168:171], v[32:35], v[16:19], v[168:171]
    ds_read_b64_tr_b16 v[68:69], v79 offset:16384
    v_mfma_f32_16x16x32_bf16 v[172:175], v[32:35], v[20:23], v[172:175]
    ds_read_b64_tr_b16 v[70:71], v79 offset:17408
    v_mfma_f32_16x16x32_bf16 v[188:191], v[36:39], v[20:23], v[188:191]
    v_mfma_f32_16x16x32_bf16 v[184:187], v[36:39], v[16:19], v[184:187]
    v_mfma_f32_16x16x32_bf16 v[180:183], v[36:39], v[12:15], v[180:183]
    v_mfma_f32_16x16x32_bf16 v[176:179], v[36:39], v[8:11], v[176:179]
    s_waitcnt lgkmcnt(0)
    s_nop 0
    v_mfma_f32_16x16x32_bf16 v[128:131], v[56:59], v[40:43], v[128:131]
    ds_read_b128 v[8:11], v72 offset:32768
    v_mfma_f32_16x16x32_bf16 v[132:135], v[56:59], v[44:47], v[132:135]
    ds_read_b64_tr_b16 v[24:25], v76 offset:32768
    v_mfma_f32_16x16x32_bf16 v[136:139], v[56:59], v[48:51], v[136:139]
    ds_read_b64_tr_b16 v[26:27], v76 offset:33792
    v_mfma_f32_16x16x32_bf16 v[140:143], v[56:59], v[52:55], v[140:143]
    ds_read_b128 v[12:15], v72 offset:33024
    v_mfma_f32_16x16x32_bf16 v[156:159], v[60:63], v[52:55], v[156:159]
    ds_read_b64_tr_b16 v[28:29], v77 offset:32768
    v_mfma_f32_16x16x32_bf16 v[152:155], v[60:63], v[48:51], v[152:155]
    ds_read_b64_tr_b16 v[30:31], v77 offset:33792
    v_mfma_f32_16x16x32_bf16 v[148:151], v[60:63], v[44:47], v[148:151]
    ds_read_b128 v[16:19], v72 offset:33280
    v_mfma_f32_16x16x32_bf16 v[144:147], v[60:63], v[40:43], v[144:147]
    ds_read_b64_tr_b16 v[32:33], v78 offset:32768
    v_mfma_f32_16x16x32_bf16 v[160:163], v[64:67], v[40:43], v[160:163]
    ds_read_b64_tr_b16 v[34:35], v78 offset:33792
    v_mfma_f32_16x16x32_bf16 v[164:167], v[64:67], v[44:47], v[164:167]
    ds_read_b128 v[20:23], v72 offset:33536
    v_mfma_f32_16x16x32_bf16 v[168:171], v[64:67], v[48:51], v[168:171]
    ds_read_b64_tr_b16 v[36:37], v79 offset:32768
    v_mfma_f32_16x16x32_bf16 v[172:175], v[64:67], v[52:55], v[172:175]
    ds_read_b64_tr_b16 v[38:39], v79 offset:33792
    v_mfma_f32_16x16x32_bf16 v[188:191], v[68:71], v[52:55], v[188:191]
    v_mfma_f32_16x16x32_bf16 v[184:187], v[68:71], v[48:51], v[184:187]
    v_mfma_f32_16x16x32_bf16 v[180:183], v[68:71], v[44:47], v[180:183]
    v_mfma_f32_16x16x32_bf16 v[176:179], v[68:71], v[40:43], v[176:179]
    s_waitcnt lgkmcnt(0)
    s_barrier
    v_mfma_f32_16x16x32_bf16 v[128:131], v[24:27], v[8:11], v[128:131]
    ds_read_b128 v[40:43], v72 offset:49152
    v_mfma_f32_16x16x32_bf16 v[132:135], v[24:27], v[12:15], v[132:135]
    ds_read_b64_tr_b16 v[56:57], v76 offset:49152
    v_mfma_f32_16x16x32_bf16 v[136:139], v[24:27], v[16:19], v[136:139]
    ds_read_b64_tr_b16 v[58:59], v76 offset:50176
    v_mfma_f32_16x16x32_bf16 v[140:143], v[24:27], v[20:23], v[140:143]
    ds_read_b128 v[44:47], v72 offset:49408
    v_mfma_f32_16x16x32_bf16 v[156:159], v[28:31], v[20:23], v[156:159]
    ds_read_b64_tr_b16 v[60:61], v77 offset:49152
    v_mfma_f32_16x16x32_bf16 v[152:155], v[28:31], v[16:19], v[152:155]
    ds_read_b64_tr_b16 v[62:63], v77 offset:50176
    v_mfma_f32_16x16x32_bf16 v[148:151], v[28:31], v[12:15], v[148:151]
    ds_read_b128 v[48:51], v72 offset:49664
    v_mfma_f32_16x16x32_bf16 v[144:147], v[28:31], v[8:11], v[144:147]
    ds_read_b64_tr_b16 v[64:65], v78 offset:49152
    v_mfma_f32_16x16x32_bf16 v[160:163], v[32:35], v[8:11], v[160:163]
    ds_read_b64_tr_b16 v[66:67], v78 offset:50176
    v_mfma_f32_16x16x32_bf16 v[164:167], v[32:35], v[12:15], v[164:167]
    ds_read_b128 v[52:55], v72 offset:49920
    v_mfma_f32_16x16x32_bf16 v[168:171], v[32:35], v[16:19], v[168:171]
    ds_read_b64_tr_b16 v[68:69], v79 offset:49152
    v_mfma_f32_16x16x32_bf16 v[172:175], v[32:35], v[20:23], v[172:175]
    ds_read_b64_tr_b16 v[70:71], v79 offset:50176
    v_mfma_f32_16x16x32_bf16 v[188:191], v[36:39], v[20:23], v[188:191]
    v_mfma_f32_16x16x32_bf16 v[184:187], v[36:39], v[16:19], v[184:187]
    v_mfma_f32_16x16x32_bf16 v[180:183], v[36:39], v[12:15], v[180:183]
    v_mfma_f32_16x16x32_bf16 v[176:179], v[36:39], v[8:11], v[176:179]
    s_waitcnt lgkmcnt(0)
    s_nop 0
    v_mfma_f32_16x16x32_bf16 v[128:131], v[56:59], v[40:43], v[128:131]
    ds_read_b128 v[8:11], v73 offset:0
    v_mfma_f32_16x16x32_bf16 v[132:135], v[56:59], v[44:47], v[132:135]
    ds_read_b64_tr_b16 v[24:25], v80 offset:0
    v_mfma_f32_16x16x32_bf16 v[136:139], v[56:59], v[48:51], v[136:139]
    ds_read_b64_tr_b16 v[26:27], v80 offset:1024
    v_mfma_f32_16x16x32_bf16 v[140:143], v[56:59], v[52:55], v[140:143]
    ds_read_b128 v[12:15], v73 offset:256
    v_mfma_f32_16x16x32_bf16 v[156:159], v[60:63], v[52:55], v[156:159]
    ds_read_b64_tr_b16 v[28:29], v81 offset:0
    v_mfma_f32_16x16x32_bf16 v[152:155], v[60:63], v[48:51], v[152:155]
    ds_read_b64_tr_b16 v[30:31], v81 offset:1024
    v_mfma_f32_16x16x32_bf16 v[148:151], v[60:63], v[44:47], v[148:151]
    ds_read_b128 v[16:19], v73 offset:512
    v_mfma_f32_16x16x32_bf16 v[144:147], v[60:63], v[40:43], v[144:147]
    ds_read_b64_tr_b16 v[32:33], v82 offset:0
    v_mfma_f32_16x16x32_bf16 v[160:163], v[64:67], v[40:43], v[160:163]
    ds_read_b64_tr_b16 v[34:35], v82 offset:1024
    v_mfma_f32_16x16x32_bf16 v[164:167], v[64:67], v[44:47], v[164:167]
    ds_read_b128 v[20:23], v73 offset:768
    v_mfma_f32_16x16x32_bf16 v[168:171], v[64:67], v[48:51], v[168:171]
    ds_read_b64_tr_b16 v[36:37], v83 offset:0
    v_mfma_f32_16x16x32_bf16 v[172:175], v[64:67], v[52:55], v[172:175]
    ds_read_b64_tr_b16 v[38:39], v83 offset:1024
    v_mfma_f32_16x16x32_bf16 v[188:191], v[68:71], v[52:55], v[188:191]
    v_mfma_f32_16x16x32_bf16 v[184:187], v[68:71], v[48:51], v[184:187]
    v_mfma_f32_16x16x32_bf16 v[180:183], v[68:71], v[44:47], v[180:183]
    v_mfma_f32_16x16x32_bf16 v[176:179], v[68:71], v[40:43], v[176:179]
    s_waitcnt lgkmcnt(0)
    s_barrier
    v_mfma_f32_16x16x32_bf16 v[128:131], v[24:27], v[8:11], v[128:131]
    ds_read_b128 v[40:43], v73 offset:16384
    v_mfma_f32_16x16x32_bf16 v[132:135], v[24:27], v[12:15], v[132:135]
    ds_read_b64_tr_b16 v[56:57], v80 offset:16384
    v_mfma_f32_16x16x32_bf16 v[136:139], v[24:27], v[16:19], v[136:139]
    ds_read_b64_tr_b16 v[58:59], v80 offset:17408
    v_mfma_f32_16x16x32_bf16 v[140:143], v[24:27], v[20:23], v[140:143]
    ds_read_b128 v[44:47], v73 offset:16640
    v_mfma_f32_16x16x32_bf16 v[156:159], v[28:31], v[20:23], v[156:159]
    ds_read_b64_tr_b16 v[60:61], v81 offset:16384
    v_mfma_f32_16x16x32_bf16 v[152:155], v[28:31], v[16:19], v[152:155]
    ds_read_b64_tr_b16 v[62:63], v81 offset:17408
    v_mfma_f32_16x16x32_bf16 v[148:151], v[28:31], v[12:15], v[148:151]
    ds_read_b128 v[48:51], v73 offset:16896
    v_mfma_f32_16x16x32_bf16 v[144:147], v[28:31], v[8:11], v[144:147]
    ds_read_b64_tr_b16 v[64:65], v82 offset:16384
    v_mfma_f32_16x16x32_bf16 v[160:163], v[32:35], v[8:11], v[160:163]
    ds_read_b64_tr_b16 v[66:67], v82 offset:17408
    v_mfma_f32_16x16x32_bf16 v[164:167], v[32:35], v[12:15], v[164:167]
    ds_read_b128 v[52:55], v73 offset:17152
    v_mfma_f32_16x16x32_bf16 v[168:171], v[32:35], v[16:19], v[168:171]
    ds_read_b64_tr_b16 v[68:69], v83 offset:16384
    v_mfma_f32_16x16x32_bf16 v[172:175], v[32:35], v[20:23], v[172:175]
    ds_read_b64_tr_b16 v[70:71], v83 offset:17408
    v_mfma_f32_16x16x32_bf16 v[188:191], v[36:39], v[20:23], v[188:191]
    v_mfma_f32_16x16x32_bf16 v[184:187], v[36:39], v[16:19], v[184:187]
    v_mfma_f32_16x16x32_bf16 v[180:183], v[36:39], v[12:15], v[180:183]
    v_mfma_f32_16x16x32_bf16 v[176:179], v[36:39], v[8:11], v[176:179]
    s_waitcnt lgkmcnt(0)
    s_nop 0
    v_mfma_f32_16x16x32_bf16 v[128:131], v[56:59], v[40:43], v[128:131]
    ds_read_b128 v[8:11], v73 offset:32768
    v_mfma_f32_16x16x32_bf16 v[132:135], v[56:59], v[44:47], v[132:135]
    ds_read_b64_tr_b16 v[24:25], v80 offset:32768
    v_mfma_f32_16x16x32_bf16 v[136:139], v[56:59], v[48:51], v[136:139]
    ds_read_b64_tr_b16 v[26:27], v80 offset:33792
    v_mfma_f32_16x16x32_bf16 v[140:143], v[56:59], v[52:55], v[140:143]
    ds_read_b128 v[12:15], v73 offset:33024
    v_mfma_f32_16x16x32_bf16 v[156:159], v[60:63], v[52:55], v[156:159]
    ds_read_b64_tr_b16 v[28:29], v81 offset:32768
    v_mfma_f32_16x16x32_bf16 v[152:155], v[60:63], v[48:51], v[152:155]
    ds_read_b64_tr_b16 v[30:31], v81 offset:33792
    v_mfma_f32_16x16x32_bf16 v[148:151], v[60:63], v[44:47], v[148:151]
    ds_read_b128 v[16:19], v73 offset:33280
    v_mfma_f32_16x16x32_bf16 v[144:147], v[60:63], v[40:43], v[144:147]
    ds_read_b64_tr_b16 v[32:33], v82 offset:32768
    v_mfma_f32_16x16x32_bf16 v[160:163], v[64:67], v[40:43], v[160:163]
    ds_read_b64_tr_b16 v[34:35], v82 offset:33792
    v_mfma_f32_16x16x32_bf16 v[164:167], v[64:67], v[44:47], v[164:167]
    ds_read_b128 v[20:23], v73 offset:33536
    v_mfma_f32_16x16x32_bf16 v[168:171], v[64:67], v[48:51], v[168:171]
    ds_read_b64_tr_b16 v[36:37], v83 offset:32768
    v_mfma_f32_16x16x32_bf16 v[172:175], v[64:67], v[52:55], v[172:175]
    ds_read_b64_tr_b16 v[38:39], v83 offset:33792
    v_mfma_f32_16x16x32_bf16 v[188:191], v[68:71], v[52:55], v[188:191]
    v_mfma_f32_16x16x32_bf16 v[184:187], v[68:71], v[48:51], v[184:187]
    v_mfma_f32_16x16x32_bf16 v[180:183], v[68:71], v[44:47], v[180:183]
    v_mfma_f32_16x16x32_bf16 v[176:179], v[68:71], v[40:43], v[176:179]
    s_waitcnt lgkmcnt(0)
    s_barrier
    v_mfma_f32_16x16x32_bf16 v[128:131], v[24:27], v[8:11], v[128:131]
    ds_read_b128 v[40:43], v73 offset:49152
    v_mfma_f32_16x16x32_bf16 v[132:135], v[24:27], v[12:15], v[132:135]
    ds_read_b64_tr_b16 v[56:57], v80 offset:49152
    v_mfma_f32_16x16x32_bf16 v[136:139], v[24:27], v[16:19], v[136:139]
    ds_read_b64_tr_b16 v[58:59], v80 offset:50176
    v_mfma_f32_16x16x32_bf16 v[140:143], v[24:27], v[20:23], v[140:143]
    ds_read_b128 v[44:47], v73 offset:49408
    v_mfma_f32_16x16x32_bf16 v[156:159], v[28:31], v[20:23], v[156:159]
    ds_read_b64_tr_b16 v[60:61], v81 offset:49152
    v_mfma_f32_16x16x32_bf16 v[152:155], v[28:31], v[16:19], v[152:155]
    ds_read_b64_tr_b16 v[62:63], v81 offset:50176
    v_mfma_f32_16x16x32_bf16 v[148:151], v[28:31], v[12:15], v[148:151]
    ds_read_b128 v[48:51], v73 offset:49664
    v_mfma_f32_16x16x32_bf16 v[144:147], v[28:31], v[8:11], v[144:147]
    ds_read_b64_tr_b16 v[64:65], v82 offset:49152
    v_mfma_f32_16x16x32_bf16 v[160:163], v[32:35], v[8:11], v[160:163]
    ds_read_b64_tr_b16 v[66:67], v82 offset:50176
    v_mfma_f32_16x16x32_bf16 v[164:167], v[32:35], v[12:15], v[164:167]
    ds_read_b128 v[52:55], v73 offset:49920
    v_mfma_f32_16x16x32_bf16 v[168:171], v[32:35], v[16:19], v[168:171]
    ds_read_b64_tr_b16 v[68:69], v83 offset:49152
    v_mfma_f32_16x16x32_bf16 v[172:175], v[32:35], v[20:23], v[172:175]
    ds_read_b64_tr_b16 v[70:71], v83 offset:50176
    v_mfma_f32_16x16x32_bf16 v[188:191], v[36:39], v[20:23], v[188:191]
    v_mfma_f32_16x16x32_bf16 v[184:187], v[36:39], v[16:19], v[184:187]
    v_mfma_f32_16x16x32_bf16 v[180:183], v[36:39], v[12:15], v[180:183]
    v_mfma_f32_16x16x32_bf16 v[176:179], v[36:39], v[8:11], v[176:179]
    s_waitcnt lgkmcnt(0)
    s_nop 0
    v_mfma_f32_16x16x32_bf16 v[128:131], v[56:59], v[40:43], v[128:131]
    ds_read_b128 v[8:11], v74 offset:0
    v_mfma_f32_16x16x32_bf16 v[132:135], v[56:59], v[44:47], v[132:135]
    ds_read_b64_tr_b16 v[24:25], v84 offset:0
    v_mfma_f32_16x16x32_bf16 v[136:139], v[56:59], v[48:51], v[136:139]
    ds_read_b64_tr_b16 v[26:27], v84 offset:1024
    v_mfma_f32_16x16x32_bf16 v[140:143], v[56:59], v[52:55], v[140:143]
    ds_read_b128 v[12:15], v74 offset:256
    v_mfma_f32_16x16x32_bf16 v[156:159], v[60:63], v[52:55], v[156:159]
    ds_read_b64_tr_b16 v[28:29], v85 offset:0
    v_mfma_f32_16x16x32_bf16 v[152:155], v[60:63], v[48:51], v[152:155]
    ds_read_b64_tr_b16 v[30:31], v85 offset:1024
    v_mfma_f32_16x16x32_bf16 v[148:151], v[60:63], v[44:47], v[148:151]
    ds_read_b128 v[16:19], v74 offset:512
    v_mfma_f32_16x16x32_bf16 v[144:147], v[60:63], v[40:43], v[144:147]
    ds_read_b64_tr_b16 v[32:33], v86 offset:0
    v_mfma_f32_16x16x32_bf16 v[160:163], v[64:67], v[40:43], v[160:163]
    ds_read_b64_tr_b16 v[34:35], v86 offset:1024
    v_mfma_f32_16x16x32_bf16 v[164:167], v[64:67], v[44:47], v[164:167]
    ds_read_b128 v[20:23], v74 offset:768
    v_mfma_f32_16x16x32_bf16 v[168:171], v[64:67], v[48:51], v[168:171]
    ds_read_b64_tr_b16 v[36:37], v87 offset:0
    v_mfma_f32_16x16x32_bf16 v[172:175], v[64:67], v[52:55], v[172:175]
    ds_read_b64_tr_b16 v[38:39], v87 offset:1024
    v_mfma_f32_16x16x32_bf16 v[188:191], v[68:71], v[52:55], v[188:191]
    v_mfma_f32_16x16x32_bf16 v[184:187], v[68:71], v[48:51], v[184:187]
    v_mfma_f32_16x16x32_bf16 v[180:183], v[68:71], v[44:47], v[180:183]
    v_mfma_f32_16x16x32_bf16 v[176:179], v[68:71], v[40:43], v[176:179]
    s_mov_b32 s30, 5
    s_nop 0
L_fc0_36:
    s_waitcnt lgkmcnt(0)
    s_barrier
    v_mfma_f32_16x16x32_bf16 v[192:195], v[8:11], v[24:27], v[192:195]
    ds_read_b128 v[40:43], v74 offset:16384
    v_mfma_f32_16x16x32_bf16 v[196:199], v[8:11], v[28:31], v[196:199]
    ds_read_b64_tr_b16 v[56:57], v84 offset:16384
    v_mfma_f32_16x16x32_bf16 v[200:203], v[8:11], v[32:35], v[200:203]
    ds_read_b64_tr_b16 v[58:59], v84 offset:17408
    v_mfma_f32_16x16x32_bf16 v[204:207], v[8:11], v[36:39], v[204:207]
    ds_read_b128 v[44:47], v74 offset:16640
    v_mfma_f32_16x16x32_bf16 v[220:223], v[12:15], v[36:39], v[220:223]
    ds_read_b64_tr_b16 v[60:61], v85 offset:16384
    v_mfma_f32_16x16x32_bf16 v[216:219], v[12:15], v[32:35], v[216:219]
    ds_read_b64_tr_b16 v[62:63], v85 offset:17408
    v_mfma_f32_16x16x32_bf16 v[212:215], v[12:15], v[28:31], v[212:215]
    ds_read_b128 v[48:51], v74 offset:16896
    v_mfma_f32_16x16x32_bf16 v[208:211], v[12:15], v[24:27], v[208:211]
    ds_read_b64_tr_b16 v[64:65], v86 offset:16384
    v_mfma_f32_16x16x32_bf16 v[224:227], v[16:19], v[24:27], v[224:227]
    ds_read_b64_tr_b16 v[66:67], v86 offset:17408
    v_mfma_f32_16x16x32_bf16 v[228:231], v[16:19], v[28:31], v[228:231]
    ds_read_b128 v[52:55], v74 offset:17152
    v_mfma_f32_16x16x32_bf16 v[232:235], v[16:19], v[32:35], v[232:235]
    ds_read_b64_tr_b16 v[68:69], v87 offset:16384
    v_mfma_f32_16x16x32_bf16 v[236:239], v[16:19], v[36:39], v[236:239]
    ds_read_b64_tr_b16 v[70:71], v87 offset:17408
    v_mfma_f32_16x16x32_bf16 v[252:255], v[20:23], v[36:39], v[252:255]
    v_mfma_f32_16x16x32_bf16 v[248:251], v[20:23], v[32:35], v[248:251]
    v_mfma_f32_16x16x32_bf16 v[244:247], v[20:23], v[28:31], v[244:247]
    v_mfma_f32_16x16x32_bf16 v[240:243], v[20:23], v[24:27], v[240:243]
    s_waitcnt lgkmcnt(0)
    s_nop 0
    v_mfma_f32_16x16x32_bf16 v[192:195], v[40:43], v[56:59], v[192:195]
    ds_read_b128 v[8:11], v74 offset:32768
    v_mfma_f32_16x16x32_bf16 v[196:199], v[40:43], v[60:63], v[196:199]
    ds_read_b64_tr_b16 v[24:25], v84 offset:32768
    v_mfma_f32_16x16x32_bf16 v[200:203], v[40:43], v[64:67], v[200:203]
    ds_read_b64_tr_b16 v[26:27], v84 offset:33792
    v_mfma_f32_16x16x32_bf16 v[204:207], v[40:43], v[68:71], v[204:207]
    ds_read_b128 v[12:15], v74 offset:33024
    v_mfma_f32_16x16x32_bf16 v[220:223], v[44:47], v[68:71], v[220:223]
    ds_read_b64_tr_b16 v[28:29], v85 offset:32768
    v_mfma_f32_16x16x32_bf16 v[216:219], v[44:47], v[64:67], v[216:219]
    ds_read_b64_tr_b16 v[30:31], v85 offset:33792
    v_mfma_f32_16x16x32_bf16 v[212:215], v[44:47], v[60:63], v[212:215]
    ds_read_b128 v[16:19], v74 offset:33280
    v_mfma_f32_16x16x32_bf16 v[208:211], v[44:47], v[56:59], v[208:211]
    ds_read_b64_tr_b16 v[32:33], v86 offset:32768
    v_mfma_f32_16x16x32_bf16 v[224:227], v[48:51], v[56:59], v[224:227]
    ds_read_b64_tr_b16 v[34:35], v86 offset:33792
    v_mfma_f32_16x16x32_bf16 v[228:231], v[48:51], v[60:63], v[228:231]
    ds_read_b128 v[20:23], v74 offset:33536
    v_mfma_f32_16x16x32_bf16 v[232:235], v[48:51], v[64:67], v[232:235]
    ds_read_b64_tr_b16 v[36:37], v87 offset:32768
    v_mfma_f32_16x16x32_bf16 v[236:239], v[48:51], v[68:71], v[236:239]
    ds_read_b64_tr_b16 v[38:39], v87 offset:33792
    v_mfma_f32_16x16x32_bf16 v[252:255], v[52:55], v[68:71], v[252:255]
    v_mfma_f32_16x16x32_bf16 v[248:251], v[52:55], v[64:67], v[248:251]
    v_mfma_f32_16x16x32_bf16 v[244:247], v[52:55], v[60:63], v[244:247]
    v_mfma_f32_16x16x32_bf16 v[240:243], v[52:55], v[56:59], v[240:243]
    s_waitcnt lgkmcnt(0)
    s_barrier
    v_mfma_f32_16x16x32_bf16 v[192:195], v[8:11], v[24:27], v[192:195]
    ds_read_b128 v[40:43], v74 offset:49152
    v_mfma_f32_16x16x32_bf16 v[196:199], v[8:11], v[28:31], v[196:199]
    ds_read_b64_tr_b16 v[56:57], v84 offset:49152
    v_mfma_f32_16x16x32_bf16 v[200:203], v[8:11], v[32:35], v[200:203]
    ds_read_b64_tr_b16 v[58:59], v84 offset:50176
    v_mfma_f32_16x16x32_bf16 v[204:207], v[8:11], v[36:39], v[204:207]
    ds_read_b128 v[44:47], v74 offset:49408
    v_mfma_f32_16x16x32_bf16 v[220:223], v[12:15], v[36:39], v[220:223]
    ds_read_b64_tr_b16 v[60:61], v85 offset:49152
    v_mfma_f32_16x16x32_bf16 v[216:219], v[12:15], v[32:35], v[216:219]
    ds_read_b64_tr_b16 v[62:63], v85 offset:50176
    v_mfma_f32_16x16x32_bf16 v[212:215], v[12:15], v[28:31], v[212:215]
    ds_read_b128 v[48:51], v74 offset:49664
    v_mfma_f32_16x16x32_bf16 v[208:211], v[12:15], v[24:27], v[208:211]
    ds_read_b64_tr_b16 v[64:65], v86 offset:49152
    v_mfma_f32_16x16x32_bf16 v[224:227], v[16:19], v[24:27], v[224:227]
    ds_read_b64_tr_b16 v[66:67], v86 offset:50176
    v_mfma_f32_16x16x32_bf16 v[228:231], v[16:19], v[28:31], v[228:231]
    ds_read_b128 v[52:55], v74 offset:49920
    v_mfma_f32_16x16x32_bf16 v[232:235], v[16:19], v[32:35], v[232:235]
    ds_read_b64_tr_b16 v[68:69], v87 offset:49152
    v_mfma_f32_16x16x32_bf16 v[236:239], v[16:19], v[36:39], v[236:239]
    ds_read_b64_tr_b16 v[70:71], v87 offset:50176
    v_mfma_f32_16x16x32_bf16 v[252:255], v[20:23], v[36:39], v[252:255]
    v_mfma_f32_16x16x32_bf16 v[248:251], v[20:23], v[32:35], v[248:251]
    v_mfma_f32_16x16x32_bf16 v[244:247], v[20:23], v[28:31], v[244:247]
    v_mfma_f32_16x16x32_bf16 v[240:243], v[20:23], v[24:27], v[240:243]
    s_waitcnt lgkmcnt(0)
    s_nop 0
    v_mfma_f32_16x16x32_bf16 v[192:195], v[40:43], v[56:59], v[192:195]
    ds_read_b128 v[8:11], v75 offset:0
    v_mfma_f32_16x16x32_bf16 v[196:199], v[40:43], v[60:63], v[196:199]
    ds_read_b64_tr_b16 v[24:25], v88 offset:0
    v_mfma_f32_16x16x32_bf16 v[200:203], v[40:43], v[64:67], v[200:203]
    ds_read_b64_tr_b16 v[26:27], v88 offset:1024
    v_mfma_f32_16x16x32_bf16 v[204:207], v[40:43], v[68:71], v[204:207]
    ds_read_b128 v[12:15], v75 offset:256
    v_mfma_f32_16x16x32_bf16 v[220:223], v[44:47], v[68:71], v[220:223]
    ds_read_b64_tr_b16 v[28:29], v89 offset:0
    v_mfma_f32_16x16x32_bf16 v[216:219], v[44:47], v[64:67], v[216:219]
    ds_read_b64_tr_b16 v[30:31], v89 offset:1024
    v_mfma_f32_16x16x32_bf16 v[212:215], v[44:47], v[60:63], v[212:215]
    ds_read_b128 v[16:19], v75 offset:512
    v_mfma_f32_16x16x32_bf16 v[208:211], v[44:47], v[56:59], v[208:211]
    ds_read_b64_tr_b16 v[32:33], v90 offset:0
    v_mfma_f32_16x16x32_bf16 v[224:227], v[48:51], v[56:59], v[224:227]
    ds_read_b64_tr_b16 v[34:35], v90 offset:1024
    v_mfma_f32_16x16x32_bf16 v[228:231], v[48:51], v[60:63], v[228:231]
    ds_read_b128 v[20:23], v75 offset:768
    v_mfma_f32_16x16x32_bf16 v[232:235], v[48:51], v[64:67], v[232:235]
    ds_read_b64_tr_b16 v[36:37], v91 offset:0
    v_mfma_f32_16x16x32_bf16 v[236:239], v[48:51], v[68:71], v[236:239]
    ds_read_b64_tr_b16 v[38:39], v91 offset:1024
    v_mfma_f32_16x16x32_bf16 v[252:255], v[52:55], v[68:71], v[252:255]
    v_mfma_f32_16x16x32_bf16 v[248:251], v[52:55], v[64:67], v[248:251]
    v_mfma_f32_16x16x32_bf16 v[244:247], v[52:55], v[60:63], v[244:247]
    v_mfma_f32_16x16x32_bf16 v[240:243], v[52:55], v[56:59], v[240:243]
    s_waitcnt lgkmcnt(0)
    s_barrier
    v_mfma_f32_16x16x32_bf16 v[192:195], v[8:11], v[24:27], v[192:195]
    ds_read_b128 v[40:43], v75 offset:16384
    v_mfma_f32_16x16x32_bf16 v[196:199], v[8:11], v[28:31], v[196:199]
    ds_read_b64_tr_b16 v[56:57], v88 offset:16384
    v_mfma_f32_16x16x32_bf16 v[200:203], v[8:11], v[32:35], v[200:203]
    ds_read_b64_tr_b16 v[58:59], v88 offset:17408
    v_mfma_f32_16x16x32_bf16 v[204:207], v[8:11], v[36:39], v[204:207]
    ds_read_b128 v[44:47], v75 offset:16640
    v_mfma_f32_16x16x32_bf16 v[220:223], v[12:15], v[36:39], v[220:223]
    ds_read_b64_tr_b16 v[60:61], v89 offset:16384
    v_mfma_f32_16x16x32_bf16 v[216:219], v[12:15], v[32:35], v[216:219]
    ds_read_b64_tr_b16 v[62:63], v89 offset:17408
    v_mfma_f32_16x16x32_bf16 v[212:215], v[12:15], v[28:31], v[212:215]
    ds_read_b128 v[48:51], v75 offset:16896
    v_mfma_f32_16x16x32_bf16 v[208:211], v[12:15], v[24:27], v[208:211]
    ds_read_b64_tr_b16 v[64:65], v90 offset:16384
    v_mfma_f32_16x16x32_bf16 v[224:227], v[16:19], v[24:27], v[224:227]
    ds_read_b64_tr_b16 v[66:67], v90 offset:17408
    v_mfma_f32_16x16x32_bf16 v[228:231], v[16:19], v[28:31], v[228:231]
    ds_read_b128 v[52:55], v75 offset:17152
    v_mfma_f32_16x16x32_bf16 v[232:235], v[16:19], v[32:35], v[232:235]
    ds_read_b64_tr_b16 v[68:69], v91 offset:16384
    v_mfma_f32_16x16x32_bf16 v[236:239], v[16:19], v[36:39], v[236:239]
    ds_read_b64_tr_b16 v[70:71], v91 offset:17408
    v_mfma_f32_16x16x32_bf16 v[252:255], v[20:23], v[36:39], v[252:255]
    v_mfma_f32_16x16x32_bf16 v[248:251], v[20:23], v[32:35], v[248:251]
    v_mfma_f32_16x16x32_bf16 v[244:247], v[20:23], v[28:31], v[244:247]
    v_mfma_f32_16x16x32_bf16 v[240:243], v[20:23], v[24:27], v[240:243]
    s_waitcnt lgkmcnt(0)
    s_nop 0
    v_mfma_f32_16x16x32_bf16 v[192:195], v[40:43], v[56:59], v[192:195]
    ds_read_b128 v[8:11], v75 offset:32768
    v_mfma_f32_16x16x32_bf16 v[196:199], v[40:43], v[60:63], v[196:199]
    ds_read_b64_tr_b16 v[24:25], v88 offset:32768
    v_mfma_f32_16x16x32_bf16 v[200:203], v[40:43], v[64:67], v[200:203]
    ds_read_b64_tr_b16 v[26:27], v88 offset:33792
    v_mfma_f32_16x16x32_bf16 v[204:207], v[40:43], v[68:71], v[204:207]
    ds_read_b128 v[12:15], v75 offset:33024
    v_mfma_f32_16x16x32_bf16 v[220:223], v[44:47], v[68:71], v[220:223]
    ds_read_b64_tr_b16 v[28:29], v89 offset:32768
    v_mfma_f32_16x16x32_bf16 v[216:219], v[44:47], v[64:67], v[216:219]
    ds_read_b64_tr_b16 v[30:31], v89 offset:33792
    v_mfma_f32_16x16x32_bf16 v[212:215], v[44:47], v[60:63], v[212:215]
    ds_read_b128 v[16:19], v75 offset:33280
    v_mfma_f32_16x16x32_bf16 v[208:211], v[44:47], v[56:59], v[208:211]
    ds_read_b64_tr_b16 v[32:33], v90 offset:32768
    v_mfma_f32_16x16x32_bf16 v[224:227], v[48:51], v[56:59], v[224:227]
    ds_read_b64_tr_b16 v[34:35], v90 offset:33792
    v_mfma_f32_16x16x32_bf16 v[228:231], v[48:51], v[60:63], v[228:231]
    ds_read_b128 v[20:23], v75 offset:33536
    v_mfma_f32_16x16x32_bf16 v[232:235], v[48:51], v[64:67], v[232:235]
    ds_read_b64_tr_b16 v[36:37], v91 offset:32768
    v_mfma_f32_16x16x32_bf16 v[236:239], v[48:51], v[68:71], v[236:239]
    ds_read_b64_tr_b16 v[38:39], v91 offset:33792
    v_mfma_f32_16x16x32_bf16 v[252:255], v[52:55], v[68:71], v[252:255]
    v_mfma_f32_16x16x32_bf16 v[248:251], v[52:55], v[64:67], v[248:251]
    v_mfma_f32_16x16x32_bf16 v[244:247], v[52:55], v[60:63], v[244:247]
    v_mfma_f32_16x16x32_bf16 v[240:243], v[52:55], v[56:59], v[240:243]
    s_waitcnt lgkmcnt(0)
    s_barrier
    v_mfma_f32_16x16x32_bf16 v[192:195], v[8:11], v[24:27], v[192:195]
    ds_read_b128 v[40:43], v75 offset:49152
    v_mfma_f32_16x16x32_bf16 v[196:199], v[8:11], v[28:31], v[196:199]
    ds_read_b64_tr_b16 v[56:57], v88 offset:49152
    v_mfma_f32_16x16x32_bf16 v[200:203], v[8:11], v[32:35], v[200:203]
    ds_read_b64_tr_b16 v[58:59], v88 offset:50176
    v_mfma_f32_16x16x32_bf16 v[204:207], v[8:11], v[36:39], v[204:207]
    ds_read_b128 v[44:47], v75 offset:49408
    v_mfma_f32_16x16x32_bf16 v[220:223], v[12:15], v[36:39], v[220:223]
    ds_read_b64_tr_b16 v[60:61], v89 offset:49152
    v_mfma_f32_16x16x32_bf16 v[216:219], v[12:15], v[32:35], v[216:219]
    ds_read_b64_tr_b16 v[62:63], v89 offset:50176
    v_mfma_f32_16x16x32_bf16 v[212:215], v[12:15], v[28:31], v[212:215]
    ds_read_b128 v[48:51], v75 offset:49664
    v_mfma_f32_16x16x32_bf16 v[208:211], v[12:15], v[24:27], v[208:211]
    ds_read_b64_tr_b16 v[64:65], v90 offset:49152
    v_mfma_f32_16x16x32_bf16 v[224:227], v[16:19], v[24:27], v[224:227]
    ds_read_b64_tr_b16 v[66:67], v90 offset:50176
    v_mfma_f32_16x16x32_bf16 v[228:231], v[16:19], v[28:31], v[228:231]
    ds_read_b128 v[52:55], v75 offset:49920
    v_mfma_f32_16x16x32_bf16 v[232:235], v[16:19], v[32:35], v[232:235]
    ds_read_b64_tr_b16 v[68:69], v91 offset:49152
    v_mfma_f32_16x16x32_bf16 v[236:239], v[16:19], v[36:39], v[236:239]
    ds_read_b64_tr_b16 v[70:71], v91 offset:50176
    v_mfma_f32_16x16x32_bf16 v[252:255], v[20:23], v[36:39], v[252:255]
    v_mfma_f32_16x16x32_bf16 v[248:251], v[20:23], v[32:35], v[248:251]
    v_mfma_f32_16x16x32_bf16 v[244:247], v[20:23], v[28:31], v[244:247]
    v_mfma_f32_16x16x32_bf16 v[240:243], v[20:23], v[24:27], v[240:243]
    s_waitcnt lgkmcnt(0)
    s_nop 0
    v_mfma_f32_16x16x32_bf16 v[192:195], v[40:43], v[56:59], v[192:195]
    ds_read_b128 v[8:11], v74 offset:0
    v_mfma_f32_16x16x32_bf16 v[196:199], v[40:43], v[60:63], v[196:199]
    ds_read_b64_tr_b16 v[24:25], v84 offset:0
    v_mfma_f32_16x16x32_bf16 v[200:203], v[40:43], v[64:67], v[200:203]
    ds_read_b64_tr_b16 v[26:27], v84 offset:1024
    v_mfma_f32_16x16x32_bf16 v[204:207], v[40:43], v[68:71], v[204:207]
    ds_read_b128 v[12:15], v74 offset:256
    v_mfma_f32_16x16x32_bf16 v[220:223], v[44:47], v[68:71], v[220:223]
    ds_read_b64_tr_b16 v[28:29], v85 offset:0
    v_mfma_f32_16x16x32_bf16 v[216:219], v[44:47], v[64:67], v[216:219]
    ds_read_b64_tr_b16 v[30:31], v85 offset:1024
    v_mfma_f32_16x16x32_bf16 v[212:215], v[44:47], v[60:63], v[212:215]
    ds_read_b128 v[16:19], v74 offset:512
    v_mfma_f32_16x16x32_bf16 v[208:211], v[44:47], v[56:59], v[208:211]
    ds_read_b64_tr_b16 v[32:33], v86 offset:0
    v_mfma_f32_16x16x32_bf16 v[224:227], v[48:51], v[56:59], v[224:227]
    ds_read_b64_tr_b16 v[34:35], v86 offset:1024
    v_mfma_f32_16x16x32_bf16 v[228:231], v[48:51], v[60:63], v[228:231]
    ds_read_b128 v[20:23], v74 offset:768
    v_mfma_f32_16x16x32_bf16 v[232:235], v[48:51], v[64:67], v[232:235]
    ds_read_b64_tr_b16 v[36:37], v87 offset:0
    v_mfma_f32_16x16x32_bf16 v[236:239], v[48:51], v[68:71], v[236:239]
    ds_read_b64_tr_b16 v[38:39], v87 offset:1024
    v_mfma_f32_16x16x32_bf16 v[252:255], v[52:55], v[68:71], v[252:255]
    v_mfma_f32_16x16x32_bf16 v[248:251], v[52:55], v[64:67], v[248:251]
    v_mfma_f32_16x16x32_bf16 v[244:247], v[52:55], v[60:63], v[244:247]
    v_mfma_f32_16x16x32_bf16 v[240:243], v[52:55], v[56:59], v[240:243]
    s_sub_u32 s30, s30, 1
    s_cmp_lg_u32 s30, 0
    s_nop 0
    s_cbranch_scc1 L_fc0_36
    s_waitcnt lgkmcnt(0)
    s_barrier
    v_mfma_f32_16x16x32_bf16 v[192:195], v[8:11], v[24:27], v[192:195]
    ds_read_b128 v[40:43], v74 offset:16384
    v_mfma_f32_16x16x32_bf16 v[196:199], v[8:11], v[28:31], v[196:199]
    ds_read_b64_tr_b16 v[56:57], v84 offset:16384
    v_mfma_f32_16x16x32_bf16 v[200:203], v[8:11], v[32:35], v[200:203]
    ds_read_b64_tr_b16 v[58:59], v84 offset:17408
    v_mfma_f32_16x16x32_bf16 v[204:207], v[8:11], v[36:39], v[204:207]
    ds_read_b128 v[44:47], v74 offset:16640
    v_mfma_f32_16x16x32_bf16 v[220:223], v[12:15], v[36:39], v[220:223]
    ds_read_b64_tr_b16 v[60:61], v85 offset:16384
    v_mfma_f32_16x16x32_bf16 v[216:219], v[12:15], v[32:35], v[216:219]
    ds_read_b64_tr_b16 v[62:63], v85 offset:17408
    v_mfma_f32_16x16x32_bf16 v[212:215], v[12:15], v[28:31], v[212:215]
    ds_read_b128 v[48:51], v74 offset:16896
    v_mfma_f32_16x16x32_bf16 v[208:211], v[12:15], v[24:27], v[208:211]
    ds_read_b64_tr_b16 v[64:65], v86 offset:16384
    v_mfma_f32_16x16x32_bf16 v[224:227], v[16:19], v[24:27], v[224:227]
    ds_read_b64_tr_b16 v[66:67], v86 offset:17408
    v_mfma_f32_16x16x32_bf16 v[228:231], v[16:19], v[28:31], v[228:231]
    ds_read_b128 v[52:55], v74 offset:17152
    v_mfma_f32_16x16x32_bf16 v[232:235], v[16:19], v[32:35], v[232:235]
    ds_read_b64_tr_b16 v[68:69], v87 offset:16384
    v_mfma_f32_16x16x32_bf16 v[236:239], v[16:19], v[36:39], v[236:239]
    ds_read_b64_tr_b16 v[70:71], v87 offset:17408
    v_mfma_f32_16x16x32_bf16 v[252:255], v[20:23], v[36:39], v[252:255]
    v_mfma_f32_16x16x32_bf16 v[248:251], v[20:23], v[32:35], v[248:251]
    v_mfma_f32_16x16x32_bf16 v[244:247], v[20:23], v[28:31], v[244:247]
    v_mfma_f32_16x16x32_bf16 v[240:243], v[20:23], v[24:27], v[240:243]
    s_waitcnt lgkmcnt(0)
    s_nop 0
    v_mfma_f32_16x16x32_bf16 v[192:195], v[40:43], v[56:59], v[192:195]
    ds_read_b128 v[8:11], v74 offset:32768
    v_mfma_f32_16x16x32_bf16 v[196:199], v[40:43], v[60:63], v[196:199]
    ds_read_b64_tr_b16 v[24:25], v84 offset:32768
    v_mfma_f32_16x16x32_bf16 v[200:203], v[40:43], v[64:67], v[200:203]
    ds_read_b64_tr_b16 v[26:27], v84 offset:33792
    v_mfma_f32_16x16x32_bf16 v[204:207], v[40:43], v[68:71], v[204:207]
    ds_read_b128 v[12:15], v74 offset:33024
    v_mfma_f32_16x16x32_bf16 v[220:223], v[44:47], v[68:71], v[220:223]
    ds_read_b64_tr_b16 v[28:29], v85 offset:32768
    v_mfma_f32_16x16x32_bf16 v[216:219], v[44:47], v[64:67], v[216:219]
    ds_read_b64_tr_b16 v[30:31], v85 offset:33792
    v_mfma_f32_16x16x32_bf16 v[212:215], v[44:47], v[60:63], v[212:215]
    ds_read_b128 v[16:19], v74 offset:33280
    v_mfma_f32_16x16x32_bf16 v[208:211], v[44:47], v[56:59], v[208:211]
    ds_read_b64_tr_b16 v[32:33], v86 offset:32768
    v_mfma_f32_16x16x32_bf16 v[224:227], v[48:51], v[56:59], v[224:227]
    ds_read_b64_tr_b16 v[34:35], v86 offset:33792
    v_mfma_f32_16x16x32_bf16 v[228:231], v[48:51], v[60:63], v[228:231]
    ds_read_b128 v[20:23], v74 offset:33536
    v_mfma_f32_16x16x32_bf16 v[232:235], v[48:51], v[64:67], v[232:235]
    ds_read_b64_tr_b16 v[36:37], v87 offset:32768
    v_mfma_f32_16x16x32_bf16 v[236:239], v[48:51], v[68:71], v[236:239]
    ds_read_b64_tr_b16 v[38:39], v87 offset:33792
    v_mfma_f32_16x16x32_bf16 v[252:255], v[52:55], v[68:71], v[252:255]
    v_mfma_f32_16x16x32_bf16 v[248:251], v[52:55], v[64:67], v[248:251]
    v_mfma_f32_16x16x32_bf16 v[244:247], v[52:55], v[60:63], v[244:247]
    v_mfma_f32_16x16x32_bf16 v[240:243], v[52:55], v[56:59], v[240:243]
    s_waitcnt lgkmcnt(0)
    s_barrier
    v_mfma_f32_16x16x32_bf16 v[192:195], v[8:11], v[24:27], v[192:195]
    ds_read_b128 v[40:43], v74 offset:49152
    v_mfma_f32_16x16x32_bf16 v[196:199], v[8:11], v[28:31], v[196:199]
    ds_read_b64_tr_b16 v[56:57], v84 offset:49152
    v_mfma_f32_16x16x32_bf16 v[200:203], v[8:11], v[32:35], v[200:203]
    ds_read_b64_tr_b16 v[58:59], v84 offset:50176
    v_mfma_f32_16x16x32_bf16 v[204:207], v[8:11], v[36:39], v[204:207]
    ds_read_b128 v[44:47], v74 offset:49408
    v_mfma_f32_16x16x32_bf16 v[220:223], v[12:15], v[36:39], v[220:223]
    ds_read_b64_tr_b16 v[60:61], v85 offset:49152
    v_mfma_f32_16x16x32_bf16 v[216:219], v[12:15], v[32:35], v[216:219]
    ds_read_b64_tr_b16 v[62:63], v85 offset:50176
    v_mfma_f32_16x16x32_bf16 v[212:215], v[12:15], v[28:31], v[212:215]
    ds_read_b128 v[48:51], v74 offset:49664
    v_mfma_f32_16x16x32_bf16 v[208:211], v[12:15], v[24:27], v[208:211]
    ds_read_b64_tr_b16 v[64:65], v86 offset:49152
    v_mfma_f32_16x16x32_bf16 v[224:227], v[16:19], v[24:27], v[224:227]
    ds_read_b64_tr_b16 v[66:67], v86 offset:50176
    v_mfma_f32_16x16x32_bf16 v[228:231], v[16:19], v[28:31], v[228:231]
    ds_read_b128 v[52:55], v74 offset:49920
    v_mfma_f32_16x16x32_bf16 v[232:235], v[16:19], v[32:35], v[232:235]
    ds_read_b64_tr_b16 v[68:69], v87 offset:49152
    v_mfma_f32_16x16x32_bf16 v[236:239], v[16:19], v[36:39], v[236:239]
    ds_read_b64_tr_b16 v[70:71], v87 offset:50176
    v_mfma_f32_16x16x32_bf16 v[252:255], v[20:23], v[36:39], v[252:255]
    v_mfma_f32_16x16x32_bf16 v[248:251], v[20:23], v[32:35], v[248:251]
    v_mfma_f32_16x16x32_bf16 v[244:247], v[20:23], v[28:31], v[244:247]
    v_mfma_f32_16x16x32_bf16 v[240:243], v[20:23], v[24:27], v[240:243]
    s_waitcnt lgkmcnt(0)
    s_nop 0
    v_mfma_f32_16x16x32_bf16 v[192:195], v[40:43], v[56:59], v[192:195]
    v_mfma_f32_16x16x32_bf16 v[196:199], v[40:43], v[60:63], v[196:199]
    v_mfma_f32_16x16x32_bf16 v[200:203], v[40:43], v[64:67], v[200:203]
    v_mfma_f32_16x16x32_bf16 v[204:207], v[40:43], v[68:71], v[204:207]
    v_mfma_f32_16x16x32_bf16 v[220:223], v[44:47], v[68:71], v[220:223]
    v_mfma_f32_16x16x32_bf16 v[216:219], v[44:47], v[64:67], v[216:219]
    v_mfma_f32_16x16x32_bf16 v[212:215], v[44:47], v[60:63], v[212:215]
    v_mfma_f32_16x16x32_bf16 v[208:211], v[44:47], v[56:59], v[208:211]
    v_mfma_f32_16x16x32_bf16 v[224:227], v[48:51], v[56:59], v[224:227]
    v_mfma_f32_16x16x32_bf16 v[228:231], v[48:51], v[60:63], v[228:231]
    v_mfma_f32_16x16x32_bf16 v[232:235], v[48:51], v[64:67], v[232:235]
    v_mfma_f32_16x16x32_bf16 v[236:239], v[48:51], v[68:71], v[236:239]
    v_mfma_f32_16x16x32_bf16 v[252:255], v[52:55], v[68:71], v[252:255]
    v_mfma_f32_16x16x32_bf16 v[248:251], v[52:55], v[64:67], v[248:251]
    v_mfma_f32_16x16x32_bf16 v[244:247], v[52:55], v[60:63], v[244:247]
    v_mfma_f32_16x16x32_bf16 v[240:243], v[52:55], v[56:59], v[240:243]
    s_setprio 0
    buffer_load_dwordx2 v[92:93], v5, s[24:27], 0 offen offset:0 sc1
    buffer_load_ushort v94, v6, s[52:55], 0 offen offset:0
    buffer_load_dwordx2 v[96:97], v5, s[24:27], 0 offen offset:128 sc1
    buffer_load_ushort v98, v6, s[52:55], 0 offen offset:32
    buffer_load_dwordx2 v[100:101], v5, s[24:27], 0 offen offset:256 sc1
    buffer_load_ushort v102, v6, s[52:55], 0 offen offset:64
    buffer_load_dwordx2 v[104:105], v5, s[24:27], 0 offen offset:384 sc1
    buffer_load_ushort v106, v6, s[52:55], 0 offen offset:96
    v_and_b32 v5, 1, v2
    v_lshlrev_b32 v5, 8, v5
    v_lshlrev_b32 v7, 4, v2
    s_mov_b32 s87, 0x40000
L_fx_37:
    buffer_load_dword v6, v5, s[24:27], s50 offen sc1
    s_waitcnt vmcnt(0)
    v_cmp_ne_u32 vcc, s3, v6
    s_sub_u32 s87, s87, 1
    s_cbranch_scc1 L_fxd_38
    s_cbranch_vccz L_fxd_38
    s_sleep 2
    s_branch L_fx_37
L_fxd_38:
    v_lshlrev_b32 v94, 16, v94
    v_lshlrev_b32 v98, 16, v98
    v_lshlrev_b32 v102, 16, v102
    v_lshlrev_b32 v106, 16, v106
    s_add_u32 s39, s51, 32768
    s_add_u32 s40, s51, 4096
    s_add_u32 s41, s51, 36864
    buffer_load_dwordx4 v[8:11], v7, s[60:63], s51 offen offset:0 sc1
    buffer_load_dwordx4 v[12:15], v7, s[60:63], s39 offen offset:0 sc1
    buffer_load_dwordx4 v[16:19], v7, s[60:63], s51 offen offset:1024 sc1
    buffer_load_dwordx4 v[20:23], v7, s[60:63], s39 offen offset:1024 sc1
    buffer_load_dwordx4 v[24:27], v7, s[60:63], s51 offen offset:2048 sc1
    buffer_load_dwordx4 v[28:31], v7, s[60:63], s39 offen offset:2048 sc1
    buffer_load_dwordx4 v[32:35], v7, s[60:63], s51 offen offset:3072 sc1
    buffer_load_dwordx4 v[36:39], v7, s[60:63], s39 offen offset:3072 sc1
    buffer_load_dwordx4 v[40:43], v7, s[60:63], s40 offen offset:0 sc1
    buffer_load_dwordx4 v[44:47], v7, s[60:63], s41 offen offset:0 sc1
    buffer_load_dwordx4 v[48:51], v7, s[60:63], s40 offen offset:1024 sc1
    buffer_load_dwordx4 v[52:55], v7, s[60:63], s41 offen offset:1024 sc1
    buffer_load_dwordx4 v[56:59], v7, s[60:63], s40 offen offset:2048 sc1
    buffer_load_dwordx4 v[60:63], v7, s[60:63], s41 offen offset:2048 sc1
    buffer_load_dwordx4 v[64:67], v7, s[60:63], s40 offen offset:3072 sc1
    buffer_load_dwordx4 v[68:71], v7, s[60:63], s41 offen offset:3072 sc1
    v_pk_add_f32 v[192:193], v[192:193], v[94:95] op_sel_hi:[1,0]
    v_pk_add_f32 v[194:195], v[194:195], v[94:95] op_sel_hi:[1,0]
    v_pk_mul_f32 v[128:129], v[128:129], v[92:93] op_sel_hi:[1,0]
    v_pk_mul_f32 v[130:131], v[130:131], v[92:93] op_sel_hi:[1,0]
    v_pk_add_f32 v[208:209], v[208:209], v[94:95] op_sel_hi:[1,0]
    v_pk_add_f32 v[210:211], v[210:211], v[94:95] op_sel_hi:[1,0]
    v_pk_mul_f32 v[144:145], v[144:145], v[92:93] op_sel_hi:[1,0]
    v_pk_mul_f32 v[146:147], v[146:147], v[92:93] op_sel_hi:[1,0]
    v_pk_add_f32 v[196:197], v[196:197], v[98:99] op_sel_hi:[1,0]
    v_pk_add_f32 v[198:199], v[198:199], v[98:99] op_sel_hi:[1,0]
    v_pk_mul_f32 v[132:133], v[132:133], v[96:97] op_sel_hi:[1,0]
    v_pk_mul_f32 v[134:135], v[134:135], v[96:97] op_sel_hi:[1,0]
    v_pk_add_f32 v[212:213], v[212:213], v[98:99] op_sel_hi:[1,0]
    v_pk_add_f32 v[214:215], v[214:215], v[98:99] op_sel_hi:[1,0]
    v_pk_mul_f32 v[148:149], v[148:149], v[96:97] op_sel_hi:[1,0]
    v_pk_mul_f32 v[150:151], v[150:151], v[96:97] op_sel_hi:[1,0]
    v_pk_add_f32 v[200:201], v[200:201], v[102:103] op_sel_hi:[1,0]
    v_pk_add_f32 v[202:203], v[202:203], v[102:103] op_sel_hi:[1,0]
    v_pk_mul_f32 v[136:137], v[136:137], v[100:101] op_sel_hi:[1,0]
    v_pk_mul_f32 v[138:139], v[138:139], v[100:101] op_sel_hi:[1,0]
    v_pk_add_f32 v[216:217], v[216:217], v[102:103] op_sel_hi:[1,0]
    v_pk_add_f32 v[218:219], v[218:219], v[102:103] op_sel_hi:[1,0]
    v_pk_mul_f32 v[152:153], v[152:153], v[100:101] op_sel_hi:[1,0]
    v_pk_mul_f32 v[154:155], v[154:155], v[100:101] op_sel_hi:[1,0]
    v_pk_add_f32 v[204:205], v[204:205], v[106:107] op_sel_hi:[1,0]
    v_pk_add_f32 v[206:207], v[206:207], v[106:107] op_sel_hi:[1,0]
    v_pk_mul_f32 v[140:141], v[140:141], v[104:105] op_sel_hi:[1,0]
    v_pk_mul_f32 v[142:143], v[142:143], v[104:105] op_sel_hi:[1,0]
    v_pk_add_f32 v[220:221], v[220:221], v[106:107] op_sel_hi:[1,0]
    v_pk_add_f32 v[222:223], v[222:223], v[106:107] op_sel_hi:[1,0]
    v_pk_mul_f32 v[156:157], v[156:157], v[104:105] op_sel_hi:[1,0]
    v_pk_mul_f32 v[158:159], v[158:159], v[104:105] op_sel_hi:[1,0]
    v_pk_add_f32 v[224:225], v[224:225], v[94:95] op_sel_hi:[1,0]
    v_pk_add_f32 v[226:227], v[226:227], v[94:95] op_sel_hi:[1,0]
    v_pk_mul_f32 v[160:161], v[160:161], v[92:93] op_sel_hi:[1,0]
    v_pk_mul_f32 v[162:163], v[162:163], v[92:93] op_sel_hi:[1,0]
    v_pk_add_f32 v[240:241], v[240:241], v[94:95] op_sel_hi:[1,0]
    v_pk_add_f32 v[242:243], v[242:243], v[94:95] op_sel_hi:[1,0]
    v_pk_mul_f32 v[176:177], v[176:177], v[92:93] op_sel_hi:[1,0]
    v_pk_mul_f32 v[178:179], v[178:179], v[92:93] op_sel_hi:[1,0]
    v_pk_add_f32 v[228:229], v[228:229], v[98:99] op_sel_hi:[1,0]
    v_pk_add_f32 v[230:231], v[230:231], v[98:99] op_sel_hi:[1,0]
    v_pk_mul_f32 v[164:165], v[164:165], v[96:97] op_sel_hi:[1,0]
    v_pk_mul_f32 v[166:167], v[166:167], v[96:97] op_sel_hi:[1,0]
    v_pk_add_f32 v[244:245], v[244:245], v[98:99] op_sel_hi:[1,0]
    v_pk_add_f32 v[246:247], v[246:247], v[98:99] op_sel_hi:[1,0]
    v_pk_mul_f32 v[180:181], v[180:181], v[96:97] op_sel_hi:[1,0]
    v_pk_mul_f32 v[182:183], v[182:183], v[96:97] op_sel_hi:[1,0]
    v_pk_add_f32 v[232:233], v[232:233], v[102:103] op_sel_hi:[1,0]
    v_pk_add_f32 v[234:235], v[234:235], v[102:103] op_sel_hi:[1,0]
    v_pk_mul_f32 v[168:169], v[168:169], v[100:101] op_sel_hi:[1,0]
    v_pk_mul_f32 v[170:171], v[170:171], v[100:101] op_sel_hi:[1,0]
    v_pk_add_f32 v[248:249], v[248:249], v[102:103] op_sel_hi:[1,0]
    v_pk_add_f32 v[250:251], v[250:251], v[102:103] op_sel_hi:[1,0]
    v_pk_mul_f32 v[184:185], v[184:185], v[100:101] op_sel_hi:[1,0]
    v_pk_mul_f32 v[186:187], v[186:187], v[100:101] op_sel_hi:[1,0]
    v_pk_add_f32 v[236:237], v[236:237], v[106:107] op_sel_hi:[1,0]
    v_pk_add_f32 v[238:239], v[238:239], v[106:107] op_sel_hi:[1,0]
    v_pk_mul_f32 v[172:173], v[172:173], v[104:105] op_sel_hi:[1,0]
    v_pk_mul_f32 v[174:175], v[174:175], v[104:105] op_sel_hi:[1,0]
    v_pk_add_f32 v[252:253], v[252:253], v[106:107] op_sel_hi:[1,0]
    v_pk_add_f32 v[254:255], v[254:255], v[106:107] op_sel_hi:[1,0]
    v_pk_mul_f32 v[188:189], v[188:189], v[104:105] op_sel_hi:[1,0]
    v_pk_mul_f32 v[190:191], v[190:191], v[104:105] op_sel_hi:[1,0]
    s_waitcnt vmcnt(14)
    v_lshlrev_b32 v72, 16, v8
    v_lshlrev_b32 v80, 16, v10
    v_and_b32 v73, s66, v8
    v_and_b32 v81, s66, v10
    v_lshlrev_b32 v74, 16, v9
    v_lshlrev_b32 v82, 16, v11
    v_and_b32 v75, s66, v9
    v_and_b32 v83, s66, v11
    v_lshlrev_b32 v76, 16, v12
    v_lshlrev_b32 v84, 16, v14
    v_and_b32 v77, s66, v12
    v_and_b32 v85, s66, v14
    v_lshlrev_b32 v78, 16, v13
    v_lshlrev_b32 v86, 16, v15
    v_and_b32 v79, s66, v13
    v_and_b32 v87, s66, v15
    v_pk_add_f32 v[192:193], v[192:193], v[72:73]
    v_pk_add_f32 v[208:209], v[208:209], v[80:81]
    v_pk_add_f32 v[194:195], v[194:195], v[74:75]
    v_pk_add_f32 v[210:211], v[210:211], v[82:83]
    v_pk_add_f32 v[192:193], v[192:193], v[76:77]
    v_pk_add_f32 v[208:209], v[208:209], v[84:85]
    v_pk_add_f32 v[194:195], v[194:195], v[78:79]
    v_pk_add_f32 v[210:211], v[210:211], v[86:87]
    v_pk_fma_f32 v[192:193], v[192:193], v[92:93], v[128:129] op_sel:[0,1,0] op_sel_hi:[1,1,1]
    v_pk_fma_f32 v[208:209], v[208:209], v[92:93], v[144:145] op_sel:[0,1,0] op_sel_hi:[1,1,1]
    v_pk_fma_f32 v[194:195], v[194:195], v[92:93], v[130:131] op_sel:[0,1,0] op_sel_hi:[1,1,1]
    v_pk_fma_f32 v[210:211], v[210:211], v[92:93], v[146:147] op_sel:[0,1,0] op_sel_hi:[1,1,1]
    v_cvt_pk_bf16_f32 v108, v192, v193
    v_cvt_pk_bf16_f32 v110, v208, v209
    v_cvt_pk_bf16_f32 v109, v194, v195
    v_cvt_pk_bf16_f32 v111, v210, v211
    s_nop 1
    v_permlane16_swap_b32 v108, v110
    v_permlane16_swap_b32 v109, v111
    s_add_u32 s38, s67, 0
    buffer_store_dwordx4 v[108:111], v1, s[56:59], s38 offen offset:0
    s_waitcnt vmcnt(13)
    v_lshlrev_b32 v72, 16, v16
    v_lshlrev_b32 v80, 16, v18
    v_and_b32 v73, s66, v16
    v_and_b32 v81, s66, v18
    v_lshlrev_b32 v74, 16, v17
    v_lshlrev_b32 v82, 16, v19
    v_and_b32 v75, s66, v17
    v_and_b32 v83, s66, v19
    v_lshlrev_b32 v76, 16, v20
    v_lshlrev_b32 v84, 16, v22
    v_and_b32 v77, s66, v20
    v_and_b32 v85, s66, v22
    v_lshlrev_b32 v78, 16, v21
    v_lshlrev_b32 v86, 16, v23
    v_and_b32 v79, s66, v21
    v_and_b32 v87, s66, v23
    v_pk_add_f32 v[196:197], v[196:197], v[72:73]
    v_pk_add_f32 v[212:213], v[212:213], v[80:81]
    v_pk_add_f32 v[198:199], v[198:199], v[74:75]
    v_pk_add_f32 v[214:215], v[214:215], v[82:83]
    v_pk_add_f32 v[196:197], v[196:197], v[76:77]
    v_pk_add_f32 v[212:213], v[212:213], v[84:85]
    v_pk_add_f32 v[198:199], v[198:199], v[78:79]
    v_pk_add_f32 v[214:215], v[214:215], v[86:87]
    v_pk_fma_f32 v[196:197], v[196:197], v[96:97], v[132:133] op_sel:[0,1,0] op_sel_hi:[1,1,1]
    v_pk_fma_f32 v[212:213], v[212:213], v[96:97], v[148:149] op_sel:[0,1,0] op_sel_hi:[1,1,1]
    v_pk_fma_f32 v[198:199], v[198:199], v[96:97], v[134:135] op_sel:[0,1,0] op_sel_hi:[1,1,1]
    v_pk_fma_f32 v[214:215], v[214:215], v[96:97], v[150:151] op_sel:[0,1,0] op_sel_hi:[1,1,1]
    v_cvt_pk_bf16_f32 v112, v196, v197
    v_cvt_pk_bf16_f32 v114, v212, v213
    v_cvt_pk_bf16_f32 v113, v198, v199
    v_cvt_pk_bf16_f32 v115, v214, v215
    s_nop 1
    v_permlane16_swap_b32 v112, v114
    v_permlane16_swap_b32 v113, v115
    s_add_u32 s38, s67, 32768
    buffer_store_dwordx4 v[112:115], v1, s[56:59], s38 offen offset:0
    s_waitcnt vmcnt(12)
    v_lshlrev_b32 v72, 16, v24
    v_lshlrev_b32 v80, 16, v26
    v_and_b32 v73, s66, v24
    v_and_b32 v81, s66, v26
    v_lshlrev_b32 v74, 16, v25
    v_lshlrev_b32 v82, 16, v27
    v_and_b32 v75, s66, v25
    v_and_b32 v83, s66, v27
    v_lshlrev_b32 v76, 16, v28
    v_lshlrev_b32 v84, 16, v30
    v_and_b32 v77, s66, v28
    v_and_b32 v85, s66, v30
    v_lshlrev_b32 v78, 16, v29
    v_lshlrev_b32 v86, 16, v31
    v_and_b32 v79, s66, v29
    v_and_b32 v87, s66, v31
    v_pk_add_f32 v[200:201], v[200:201], v[72:73]
    v_pk_add_f32 v[216:217], v[216:217], v[80:81]
    v_pk_add_f32 v[202:203], v[202:203], v[74:75]
    v_pk_add_f32 v[218:219], v[218:219], v[82:83]
    v_pk_add_f32 v[200:201], v[200:201], v[76:77]
    v_pk_add_f32 v[216:217], v[216:217], v[84:85]
    v_pk_add_f32 v[202:203], v[202:203], v[78:79]
    v_pk_add_f32 v[218:219], v[218:219], v[86:87]
    v_pk_fma_f32 v[200:201], v[200:201], v[100:101], v[136:137] op_sel:[0,1,0] op_sel_hi:[1,1,1]
    v_pk_fma_f32 v[216:217], v[216:217], v[100:101], v[152:153] op_sel:[0,1,0] op_sel_hi:[1,1,1]
    v_pk_fma_f32 v[202:203], v[202:203], v[100:101], v[138:139] op_sel:[0,1,0] op_sel_hi:[1,1,1]
    v_pk_fma_f32 v[218:219], v[218:219], v[100:101], v[154:155] op_sel:[0,1,0] op_sel_hi:[1,1,1]
    v_cvt_pk_bf16_f32 v108, v200, v201
    v_cvt_pk_bf16_f32 v110, v216, v217
    v_cvt_pk_bf16_f32 v109, v202, v203
    v_cvt_pk_bf16_f32 v111, v218, v219
    s_nop 1
    v_permlane16_swap_b32 v108, v110
    v_permlane16_swap_b32 v109, v111
    s_add_u32 s38, s67, 65536
    buffer_store_dwordx4 v[108:111], v1, s[56:59], s38 offen offset:0
    s_waitcnt vmcnt(11)
    v_lshlrev_b32 v72, 16, v32
    v_lshlrev_b32 v80, 16, v34
    v_and_b32 v73, s66, v32
    v_and_b32 v81, s66, v34
    v_lshlrev_b32 v74, 16, v33
    v_lshlrev_b32 v82, 16, v35
    v_and_b32 v75, s66, v33
    v_and_b32 v83, s66, v35
    v_lshlrev_b32 v76, 16, v36
    v_lshlrev_b32 v84, 16, v38
    v_and_b32 v77, s66, v36
    v_and_b32 v85, s66, v38
    v_lshlrev_b32 v78, 16, v37
    v_lshlrev_b32 v86, 16, v39
    v_and_b32 v79, s66, v37
    v_and_b32 v87, s66, v39
    v_pk_add_f32 v[204:205], v[204:205], v[72:73]
    v_pk_add_f32 v[220:221], v[220:221], v[80:81]
    v_pk_add_f32 v[206:207], v[206:207], v[74:75]
    v_pk_add_f32 v[222:223], v[222:223], v[82:83]
    v_pk_add_f32 v[204:205], v[204:205], v[76:77]
    v_pk_add_f32 v[220:221], v[220:221], v[84:85]
    v_pk_add_f32 v[206:207], v[206:207], v[78:79]
    v_pk_add_f32 v[222:223], v[222:223], v[86:87]
    v_pk_fma_f32 v[204:205], v[204:205], v[104:105], v[140:141] op_sel:[0,1,0] op_sel_hi:[1,1,1]
    v_pk_fma_f32 v[220:221], v[220:221], v[104:105], v[156:157] op_sel:[0,1,0] op_sel_hi:[1,1,1]
    v_pk_fma_f32 v[206:207], v[206:207], v[104:105], v[142:143] op_sel:[0,1,0] op_sel_hi:[1,1,1]
    v_pk_fma_f32 v[222:223], v[222:223], v[104:105], v[158:159] op_sel:[0,1,0] op_sel_hi:[1,1,1]
    v_cvt_pk_bf16_f32 v112, v204, v205
    v_cvt_pk_bf16_f32 v114, v220, v221
    v_cvt_pk_bf16_f32 v113, v206, v207
    v_cvt_pk_bf16_f32 v115, v222, v223
    s_nop 1
    v_permlane16_swap_b32 v112, v114
    v_permlane16_swap_b32 v113, v115
    s_add_u32 s38, s67, 98304
    buffer_store_dwordx4 v[112:115], v1, s[56:59], s38 offen offset:0
    s_waitcnt vmcnt(10)
    v_lshlrev_b32 v72, 16, v40
    v_lshlrev_b32 v80, 16, v42
    v_and_b32 v73, s66, v40
    v_and_b32 v81, s66, v42
    v_lshlrev_b32 v74, 16, v41
    v_lshlrev_b32 v82, 16, v43
    v_and_b32 v75, s66, v41
    v_and_b32 v83, s66, v43
    v_lshlrev_b32 v76, 16, v44
    v_lshlrev_b32 v84, 16, v46
    v_and_b32 v77, s66, v44
    v_and_b32 v85, s66, v46
    v_lshlrev_b32 v78, 16, v45
    v_lshlrev_b32 v86, 16, v47
    v_and_b32 v79, s66, v45
    v_and_b32 v87, s66, v47
    v_pk_add_f32 v[224:225], v[224:225], v[72:73]
    v_pk_add_f32 v[240:241], v[240:241], v[80:81]
    v_pk_add_f32 v[226:227], v[226:227], v[74:75]
    v_pk_add_f32 v[242:243], v[242:243], v[82:83]
    v_pk_add_f32 v[224:225], v[224:225], v[76:77]
    v_pk_add_f32 v[240:241], v[240:241], v[84:85]
    v_pk_add_f32 v[226:227], v[226:227], v[78:79]
    v_pk_add_f32 v[242:243], v[242:243], v[86:87]
    v_pk_fma_f32 v[224:225], v[224:225], v[92:93], v[160:161] op_sel:[0,1,0] op_sel_hi:[1,1,1]
    v_pk_fma_f32 v[240:241], v[240:241], v[92:93], v[176:177] op_sel:[0,1,0] op_sel_hi:[1,1,1]
    v_pk_fma_f32 v[226:227], v[226:227], v[92:93], v[162:163] op_sel:[0,1,0] op_sel_hi:[1,1,1]
    v_pk_fma_f32 v[242:243], v[242:243], v[92:93], v[178:179] op_sel:[0,1,0] op_sel_hi:[1,1,1]
    v_cvt_pk_bf16_f32 v108, v224, v225
    v_cvt_pk_bf16_f32 v110, v240, v241
    v_cvt_pk_bf16_f32 v109, v226, v227
    v_cvt_pk_bf16_f32 v111, v242, v243
    s_nop 1
    v_permlane16_swap_b32 v108, v110
    v_permlane16_swap_b32 v109, v111
    s_add_u32 s38, s67, 0
    buffer_store_dwordx4 v[108:111], v1, s[56:59], s38 offen offset:64
    s_waitcnt vmcnt(9)
    v_lshlrev_b32 v72, 16, v48
    v_lshlrev_b32 v80, 16, v50
    v_and_b32 v73, s66, v48
    v_and_b32 v81, s66, v50
    v_lshlrev_b32 v74, 16, v49
    v_lshlrev_b32 v82, 16, v51
    v_and_b32 v75, s66, v49
    v_and_b32 v83, s66, v51
    v_lshlrev_b32 v76, 16, v52
    v_lshlrev_b32 v84, 16, v54
    v_and_b32 v77, s66, v52
    v_and_b32 v85, s66, v54
    v_lshlrev_b32 v78, 16, v53
    v_lshlrev_b32 v86, 16, v55
    v_and_b32 v79, s66, v53
    v_and_b32 v87, s66, v55
    v_pk_add_f32 v[228:229], v[228:229], v[72:73]
    v_pk_add_f32 v[244:245], v[244:245], v[80:81]
    v_pk_add_f32 v[230:231], v[230:231], v[74:75]
    v_pk_add_f32 v[246:247], v[246:247], v[82:83]
    v_pk_add_f32 v[228:229], v[228:229], v[76:77]
    v_pk_add_f32 v[244:245], v[244:245], v[84:85]
    v_pk_add_f32 v[230:231], v[230:231], v[78:79]
    v_pk_add_f32 v[246:247], v[246:247], v[86:87]
    v_pk_fma_f32 v[228:229], v[228:229], v[96:97], v[164:165] op_sel:[0,1,0] op_sel_hi:[1,1,1]
    v_pk_fma_f32 v[244:245], v[244:245], v[96:97], v[180:181] op_sel:[0,1,0] op_sel_hi:[1,1,1]
    v_pk_fma_f32 v[230:231], v[230:231], v[96:97], v[166:167] op_sel:[0,1,0] op_sel_hi:[1,1,1]
    v_pk_fma_f32 v[246:247], v[246:247], v[96:97], v[182:183] op_sel:[0,1,0] op_sel_hi:[1,1,1]
    v_cvt_pk_bf16_f32 v112, v228, v229
    v_cvt_pk_bf16_f32 v114, v244, v245
    v_cvt_pk_bf16_f32 v113, v230, v231
    v_cvt_pk_bf16_f32 v115, v246, v247
    s_nop 1
    v_permlane16_swap_b32 v112, v114
    v_permlane16_swap_b32 v113, v115
    s_add_u32 s38, s67, 32768
    buffer_store_dwordx4 v[112:115], v1, s[56:59], s38 offen offset:64
    s_waitcnt vmcnt(8)
    v_lshlrev_b32 v72, 16, v56
    v_lshlrev_b32 v80, 16, v58
    v_and_b32 v73, s66, v56
    v_and_b32 v81, s66, v58
    v_lshlrev_b32 v74, 16, v57
    v_lshlrev_b32 v82, 16, v59
    v_and_b32 v75, s66, v57
    v_and_b32 v83, s66, v59
    v_lshlrev_b32 v76, 16, v60
    v_lshlrev_b32 v84, 16, v62
    v_and_b32 v77, s66, v60
    v_and_b32 v85, s66, v62
    v_lshlrev_b32 v78, 16, v61
    v_lshlrev_b32 v86, 16, v63
    v_and_b32 v79, s66, v61
    v_and_b32 v87, s66, v63
    v_pk_add_f32 v[232:233], v[232:233], v[72:73]
    v_pk_add_f32 v[248:249], v[248:249], v[80:81]
    v_pk_add_f32 v[234:235], v[234:235], v[74:75]
    v_pk_add_f32 v[250:251], v[250:251], v[82:83]
    v_pk_add_f32 v[232:233], v[232:233], v[76:77]
    v_pk_add_f32 v[248:249], v[248:249], v[84:85]
    v_pk_add_f32 v[234:235], v[234:235], v[78:79]
    v_pk_add_f32 v[250:251], v[250:251], v[86:87]
    v_pk_fma_f32 v[232:233], v[232:233], v[100:101], v[168:169] op_sel:[0,1,0] op_sel_hi:[1,1,1]
    v_pk_fma_f32 v[248:249], v[248:249], v[100:101], v[184:185] op_sel:[0,1,0] op_sel_hi:[1,1,1]
    v_pk_fma_f32 v[234:235], v[234:235], v[100:101], v[170:171] op_sel:[0,1,0] op_sel_hi:[1,1,1]
    v_pk_fma_f32 v[250:251], v[250:251], v[100:101], v[186:187] op_sel:[0,1,0] op_sel_hi:[1,1,1]
    v_cvt_pk_bf16_f32 v108, v232, v233
    v_cvt_pk_bf16_f32 v110, v248, v249
    v_cvt_pk_bf16_f32 v109, v234, v235
    v_cvt_pk_bf16_f32 v111, v250, v251
    s_nop 1
    v_permlane16_swap_b32 v108, v110
    v_permlane16_swap_b32 v109, v111
    s_add_u32 s38, s67, 65536
    buffer_store_dwordx4 v[108:111], v1, s[56:59], s38 offen offset:64
    s_waitcnt vmcnt(7)
    v_lshlrev_b32 v72, 16, v64
    v_lshlrev_b32 v80, 16, v66
    v_and_b32 v73, s66, v64
    v_and_b32 v81, s66, v66
    v_lshlrev_b32 v74, 16, v65
    v_lshlrev_b32 v82, 16, v67
    v_and_b32 v75, s66, v65
    v_and_b32 v83, s66, v67
    v_lshlrev_b32 v76, 16, v68
    v_lshlrev_b32 v84, 16, v70
    v_and_b32 v77, s66, v68
    v_and_b32 v85, s66, v70
    v_lshlrev_b32 v78, 16, v69
    v_lshlrev_b32 v86, 16, v71
    v_and_b32 v79, s66, v69
    v_and_b32 v87, s66, v71
    v_pk_add_f32 v[236:237], v[236:237], v[72:73]
    v_pk_add_f32 v[252:253], v[252:253], v[80:81]
    v_pk_add_f32 v[238:239], v[238:239], v[74:75]
    v_pk_add_f32 v[254:255], v[254:255], v[82:83]
    v_pk_add_f32 v[236:237], v[236:237], v[76:77]
    v_pk_add_f32 v[252:253], v[252:253], v[84:85]
    v_pk_add_f32 v[238:239], v[238:239], v[78:79]
    v_pk_add_f32 v[254:255], v[254:255], v[86:87]
    v_pk_fma_f32 v[236:237], v[236:237], v[104:105], v[172:173] op_sel:[0,1,0] op_sel_hi:[1,1,1]
    v_pk_fma_f32 v[252:253], v[252:253], v[104:105], v[188:189] op_sel:[0,1,0] op_sel_hi:[1,1,1]
    v_pk_fma_f32 v[238:239], v[238:239], v[104:105], v[174:175] op_sel:[0,1,0] op_sel_hi:[1,1,1]
    v_pk_fma_f32 v[254:255], v[254:255], v[104:105], v[190:191] op_sel:[0,1,0] op_sel_hi:[1,1,1]
    v_cvt_pk_bf16_f32 v112, v236, v237
    v_cvt_pk_bf16_f32 v114, v252, v253
    v_cvt_pk_bf16_f32 v113, v238, v239
    v_cvt_pk_bf16_f32 v115, v254, v255
    s_nop 1
    v_permlane16_swap_b32 v112, v114
    v_permlane16_swap_b32 v113, v115
    s_add_u32 s38, s67, 98304
    buffer_store_dwordx4 v[112:115], v1, s[56:59], s38 offen offset:64
    s_endpgm
L_end:
    s_endpgm
L_code_end:
.set CODE_BYTES, L_code_end - gated_mix__sliding_local_dilated__mixer_token_mlp__prompt_kernel - 256
.section .rodata,"a"
.p2align 6
.amdhsa_kernel gated_mix__sliding_local_dilated__mixer_token_mlp__prompt_kernel
  .amdhsa_next_free_vgpr 256
  .amdhsa_next_free_sgpr 102
  .amdhsa_accum_offset 256
  .amdhsa_group_segment_fixed_size 0
  .amdhsa_kernarg_size 96
  .amdhsa_user_sgpr_count 2
  .amdhsa_user_sgpr_kernarg_segment_ptr 1
  .amdhsa_system_sgpr_workgroup_id_x 1
.end_amdhsa_kernel
```
